```python
import torch

def _softmax(x, axis=-1):
    return torch.softmax(x, dim=axis)

def _gelu(x):
    return torch.nn.functional.gelu(x, approximate='tanh')

def _silu(x):
    return torch.nn.functional.silu(x)

def _sigmoid(x):
    return torch.sigmoid(x)

def _layernorm(x, axis=-1, eps=1e-05):
    m = x.mean(dim=axis, keepdim=True)
    v = x.var(dim=axis, keepdim=True, unbiased=False)
    return (x - m) / torch.sqrt(v + eps)

def _scatter_add(tgt, idx, src, axis=0):
    return tgt.clone().index_add_(axis, idx, src)

def _segment_sum(src, seg, n):
    out = torch.zeros((n,) + src.shape[1:], dtype=src.dtype)
    return out.index_add_(0, seg, src)

def _pad(x, pw):
    flat = tuple((v for pair in reversed(pw) for v in pair))
    return torch.nn.functional.pad(x, flat)
kernel_name = 'adaLN_cond__grouped_kv_mqa__mixer_channel_mlp__prompt'

def setup_inputs():

    _w = lambda a: (lambda t: t.to(torch.bfloat16) if t.is_floating_point() else t)(torch.as_tensor(a))

    def _A_setup():
        B, S, D, H = (1, 2048, 1024, 32)
        Dh = D // H
        return {'x': _w((lambda *s: torch.randn(*s, dtype=torch.bfloat16) * 0.05)(B, S, D)), 'wq': _w((lambda *s: torch.randn(*s, dtype=torch.bfloat16) * 0.05)(D, H * Dh)), 'wk': _w((lambda *s: torch.randn(*s, dtype=torch.bfloat16) * 0.05)(D, Dh)), 'wv': _w((lambda *s: torch.randn(*s, dtype=torch.bfloat16) * 0.05)(D, Dh)), 'wo': _w((lambda *s: torch.randn(*s, dtype=torch.bfloat16) * 0.05)(H * Dh, D))}
    _A_in = _A_setup()

    def _B_setup():
        B, S, D, F = (1, 2048, 1024, 3584)
        return {'x': _w((lambda *s: torch.randn(*s, dtype=torch.bfloat16) * 0.05)(B, S, D)), 'w1': _w((lambda *s: torch.randn(*s, dtype=torch.bfloat16) * 12.8)(D, F) * D ** (-0.5)), 'b1': _w((lambda *s: torch.randn(*s, dtype=torch.bfloat16) * 6.4)(F)), 'w2': _w((lambda *s: torch.randn(*s, dtype=torch.bfloat16) * 0.2)(F, D) * F ** (-0.5)), 'b2': _w((lambda *s: torch.randn(*s, dtype=torch.bfloat16) * 1.6)(D))}
    _B_in = _B_setup()
    return {'A_x': _A_in['x'], 'A_wq': _A_in['wq'], 'A_wk': _A_in['wk'], 'A_wv': _A_in['wv'], 'A_wo': _A_in['wo'], 'B_x': _B_in['x'], 'B_w1': _B_in['w1'], 'B_b1': _B_in['b1'], 'B_w2': _B_in['w2'], 'B_b2': _B_in['b2'], 'c': _w((lambda *s: torch.randn(*s, dtype=torch.bfloat16) * 0.1)(1, 1024) * 8.0), 'w_mod': _w((lambda *s: torch.randn(*s, dtype=torch.bfloat16) * 0.1)(1024, 6 * 1024) * 1024 ** (-0.5) * 8.0)}

def reference(A_x, A_wq, A_wk, A_wv, A_wo, B_x, B_w1, B_b1, B_w2, B_b2, c, w_mod):

    def _A_ref(x, wq, wk, wv, wo):
        B, S, D = x.shape
        H = 32
        Dh = D // H
        q = (lambda x, *d: x.permute(*d))((x @ wq).reshape(B, S, H, Dh), 0, 2, 1, 3)
        k = x @ wk
        v = x @ wv
        scores = torch.einsum('bhqd,bkd->bhqk', q, k) * Dh ** (-0.5)
        p = _softmax(scores, axis=-1)
        o = torch.einsum('bhqk,bkd->bhqd', p, v)
        return (lambda x, *d: x.permute(*d))(o, 0, 2, 1, 3).reshape(B, S, H * Dh) @ wo

    def _B_ref(x, w1, b1, w2, b2):
        y = _layernorm(x, axis=-1)
        h = _gelu(torch.einsum('bsd,df->bsf', y, w1) + b1)
        return torch.einsum('bsf,fd->bsd', h, w2) + b2
    x = A_x
    mod = (_silu(c) @ w_mod).reshape(c.shape[0], 6, 1, -1)
    sa, ca, ga, sb, cb, gb = (mod[:, 0].clone(), mod[:, 1].clone(), mod[:, 2].clone(), mod[:, 3].clone(), mod[:, 4].clone(), mod[:, 5].clone())
    h = _layernorm(x, axis=-1) * (1 + ca) + sa
    x = x + ga * _A_ref(h, A_wq, A_wk, A_wv, A_wo)
    h = _layernorm(x, axis=-1) * (1 + cb) + sb
    x = x + gb * _B_ref(h, B_w1, B_b1, B_w2, B_b2)
    return x
```

```asm
; @launch grid=(256,1,1) block=(512,1,1) lds=163840
.amdgcn_target "amdgcn-amd-amdhsa--gfx950"
.text
.globl adaLN_cond__grouped_kv_mqa__mixer_channel_mlp__prompt_kernel
.p2align 8
.type adaLN_cond__grouped_kv_mqa__mixer_channel_mlp__prompt_kernel,@function
adaLN_cond__grouped_kv_mqa__mixer_channel_mlp__prompt_kernel:
    s_getpc_b64 s[62:63]
MEGA_PC:
    s_cmp_ge_u32 s2, 256
    s_cbranch_scc1 MEGA_END
    s_load_dwordx16 s[64:79], s[0:1], 0
    s_load_dwordx8 s[80:87], s[0:1], 64
    s_load_dwordx2 s[88:89], s[0:1], 96
    s_load_dwordx2 s[94:95], s[0:1], 104
    s_load_dwordx2 s[20:21], s[0:1], 112
    s_memrealtime s[90:91]
    v_and_b32 v1, 63, v0
    v_lshrrev_b32 v5, 6, v0
    v_lshlrev_b32 v2, 4, v1
    v_readfirstlane_b32 s30, v5
    s_nop 3
    s_and_b32 s31, s30, 3
    s_lshr_b32 s32, s30, 2
    s_waitcnt lgkmcnt(0)
    s_or_b32 s100, s90, 1
    s_add_u32 s96, s20, 0x2400000
    s_addc_u32 s97, s21, 0
    s_mov_b32 s98, 0x3a000
    s_mov_b32 s99, 0x00020000
    s_cmp_eq_u32 s30, 6
    s_cbranch_scc0 CPF_SKIP
    s_lshr_b32 s36, s2, 3
    s_lshl_b32 s36, s36, 4
    v_and_b32 v5, 15, v1
    v_add_u32 v5, s36, v5
    v_lshlrev_b32 v5, 7, v5
    s_mov_b32 s37, MEGA_CODE_END-MEGA_PC-8
    v_min_u32 v5, s37, v5
    v_and_b32 v5, -4, v5
    global_load_dword v254, v5, s[62:63]
CPF_SKIP:
    s_mov_b32 s8, s94
    s_mov_b32 s9, s95
    s_mov_b32 s10, 256
    s_mov_b32 s11, 0x00020000
    v_mov_b32 v251, 0
    s_cmp_eq_u32 s2, 0
    s_cbranch_scc0 P0_NOTOK
    s_cmp_eq_u32 s30, 0
    s_cbranch_scc0 P0_NOTOK
    v_mov_b32 v250, s100
    v_cmp_eq_u32 vcc, 0, v1
    s_and_saveexec_b64 s[54:55], vcc
    buffer_store_dword v250, v251, s[8:11], 0 offen sc0 sc1
    s_mov_b64 exec, s[54:55]
P0_NOTOK:
    s_cmp_ge_u32 s2, 128
    s_cbranch_scc1 P0_MOD
    v_lshlrev_b32 v7, 4, v1
    v_and_b32 v3, 31, v0
    v_bfe_u32 v4, v0, 5, 1
    s_lshr_b32 s36, s2, 3
    s_and_b32 s32, s36, 1
    s_lshr_b32 s36, s36, 1
    s_lshl_b32 s36, s36, 3
    s_and_b32 s31, s2, 7
    s_add_u32 s31, s31, s36
    s_mov_b32 s40, s64
    s_mov_b32 s41, s65
    s_mov_b32 s42, 0x400000
    s_mov_b32 s43, 0x00020000
    v_lshrrev_b32 v5, 4, v1
    v_and_b32 v6, 15, v1
    v_xor_b32 v6, v6, v5
    v_lshlrev_b32 v6, 4, v6
    v_lshl_add_u32 v5, v5, 11, v6
    s_lshl_b32 s33, s31, 16
    s_lshl_b32 s34, s30, 8
    s_add_u32 s33, s33, s34
    s_lshl_b32 s35, s30, 13
    v_xor_b32 v6, 0, v5
    s_add_u32 m0, s35, 0
    s_add_u32 s36, s33, 0
    buffer_load_dwordx4 v6, s[40:43], s36 offen lds
    v_xor_b32 v6, 64, v5
    s_add_u32 m0, s35, 1024
    s_add_u32 s36, s33, 8192
    buffer_load_dwordx4 v6, s[40:43], s36 offen lds
    v_xor_b32 v6, 128, v5
    s_add_u32 m0, s35, 2048
    s_add_u32 s36, s33, 16384
    buffer_load_dwordx4 v6, s[40:43], s36 offen lds
    v_xor_b32 v6, 192, v5
    s_add_u32 m0, s35, 3072
    s_add_u32 s36, s33, 24576
    buffer_load_dwordx4 v6, s[40:43], s36 offen lds
    v_xor_b32 v6, 0, v5
    s_add_u32 m0, s35, 4096
    s_add_u32 s36, s33, 32768
    buffer_load_dwordx4 v6, s[40:43], s36 offen lds
    v_xor_b32 v6, 64, v5
    s_add_u32 m0, s35, 5120
    s_add_u32 s36, s33, 40960
    buffer_load_dwordx4 v6, s[40:43], s36 offen lds
    v_xor_b32 v6, 128, v5
    s_add_u32 m0, s35, 6144
    s_add_u32 s36, s33, 49152
    buffer_load_dwordx4 v6, s[40:43], s36 offen lds
    v_xor_b32 v6, 192, v5
    s_add_u32 m0, s35, 7168
    s_add_u32 s36, s33, 57344
    buffer_load_dwordx4 v6, s[40:43], s36 offen lds
    buffer_load_dword v250, v251, s[8:11], 0 offen sc0 sc1
    s_cmp_eq_u32 s32, 0
    s_cselect_b32 s12, s68, s70
    s_cselect_b32 s13, s69, s71
    s_mov_b32 s14, 65536
    s_mov_b32 s15, 0x00020000
    s_mov_b32 s16, s20
    s_mov_b32 s17, s21
    s_mov_b32 s18, 0x10000
    s_mov_b32 s19, 0x00020000
    s_add_u32 s24, s20, 0x100000
    s_addc_u32 s25, s21, 0
    s_mov_b32 s26, 0x400000
    s_mov_b32 s27, 0x00020000
    s_cmp_eq_u32 s32, 0
    s_cselect_b32 s26, s26, 0
    s_add_u32 s44, s20, 0x40000
    s_addc_u32 s45, s21, 0
    s_mov_b32 s46, 0x40000
    s_mov_b32 s47, 0x00020000
    v_and_b32 v9, 15, v3
    v_xor_b32 v9, v9, v4
    v_lshlrev_b32 v9, 4, v9
    v_lshl_add_u32 v9, v3, 8, v9
    v_add_u32 v9, s35, v9
    v_mov_b32 v12, 0
    v_mov_b32 v13, 0
    v_mov_b32 v14, 0x3f803f80
    v_mov_b32 v11, 0
    v_mov_b32 v15, 0
    s_mov_b32 s57, 0
TOKWLN:
    s_waitcnt vmcnt(0)
    v_readfirstlane_b32 s100, v250
    s_add_u32 s57, s57, 1
    s_cmp_gt_u32 s57, 400000
    s_cbranch_scc1 TOKDLN
    s_cmp_eq_u32 s100, 0
    s_cbranch_scc0 TOKDLN
    s_sleep 1
    buffer_load_dword v250, v251, s[8:11], 0 offen sc0 sc1
    s_branch TOKWLN
TOKDLN:
    s_add_u32 m0, s35, 65536
    s_add_u32 s38, s35, 0
    buffer_load_dwordx4 v7, s[12:15], s38 offen lds
    s_add_u32 m0, s35, 66560
    s_add_u32 s38, s35, 1024
    buffer_load_dwordx4 v7, s[12:15], s38 offen lds
    s_add_u32 m0, s35, 67584
    s_add_u32 s38, s35, 2048
    buffer_load_dwordx4 v7, s[12:15], s38 offen lds
    s_add_u32 m0, s35, 68608
    s_add_u32 s38, s35, 3072
    buffer_load_dwordx4 v7, s[12:15], s38 offen lds
    s_add_u32 m0, s35, 69632
    s_add_u32 s38, s35, 4096
    buffer_load_dwordx4 v7, s[12:15], s38 offen lds
    s_add_u32 m0, s35, 70656
    s_add_u32 s38, s35, 5120
    buffer_load_dwordx4 v7, s[12:15], s38 offen lds
    s_add_u32 m0, s35, 71680
    s_add_u32 s38, s35, 6144
    buffer_load_dwordx4 v7, s[12:15], s38 offen lds
    s_add_u32 m0, s35, 72704
    s_add_u32 s38, s35, 7168
    buffer_load_dwordx4 v7, s[12:15], s38 offen lds
    v_xor_b32 v10, 0, v9
    ds_read_b128 v[64:67], v10
    v_xor_b32 v10, 32, v9
    ds_read_b128 v[68:71], v10
    v_xor_b32 v10, 64, v9
    ds_read_b128 v[72:75], v10
    v_xor_b32 v10, 96, v9
    ds_read_b128 v[76:79], v10
    v_xor_b32 v10, 128, v9
    ds_read_b128 v[80:83], v10
    v_xor_b32 v10, 160, v9
    ds_read_b128 v[84:87], v10
    v_xor_b32 v10, 192, v9
    ds_read_b128 v[88:91], v10
    v_xor_b32 v10, 224, v9
    ds_read_b128 v[92:95], v10
    s_waitcnt lgkmcnt(7)
    v_dot2_f32_bf16 v12, v64, v14, v12
    v_dot2_f32_bf16 v13, v64, v64, v13
    v_dot2_f32_bf16 v11, v65, v14, v11
    v_dot2_f32_bf16 v15, v65, v65, v15
    v_dot2_f32_bf16 v12, v66, v14, v12
    v_dot2_f32_bf16 v13, v66, v66, v13
    v_dot2_f32_bf16 v11, v67, v14, v11
    v_dot2_f32_bf16 v15, v67, v67, v15
    s_waitcnt lgkmcnt(6)
    v_dot2_f32_bf16 v12, v68, v14, v12
    v_dot2_f32_bf16 v13, v68, v68, v13
    v_dot2_f32_bf16 v11, v69, v14, v11
    v_dot2_f32_bf16 v15, v69, v69, v15
    v_dot2_f32_bf16 v12, v70, v14, v12
    v_dot2_f32_bf16 v13, v70, v70, v13
    v_dot2_f32_bf16 v11, v71, v14, v11
    v_dot2_f32_bf16 v15, v71, v71, v15
    s_waitcnt lgkmcnt(5)
    v_dot2_f32_bf16 v12, v72, v14, v12
    v_dot2_f32_bf16 v13, v72, v72, v13
    v_dot2_f32_bf16 v11, v73, v14, v11
    v_dot2_f32_bf16 v15, v73, v73, v15
    v_dot2_f32_bf16 v12, v74, v14, v12
    v_dot2_f32_bf16 v13, v74, v74, v13
    v_dot2_f32_bf16 v11, v75, v14, v11
    v_dot2_f32_bf16 v15, v75, v75, v15
    s_waitcnt lgkmcnt(4)
    v_dot2_f32_bf16 v12, v76, v14, v12
    v_dot2_f32_bf16 v13, v76, v76, v13
    v_dot2_f32_bf16 v11, v77, v14, v11
    v_dot2_f32_bf16 v15, v77, v77, v15
    v_dot2_f32_bf16 v12, v78, v14, v12
    v_dot2_f32_bf16 v13, v78, v78, v13
    v_dot2_f32_bf16 v11, v79, v14, v11
    v_dot2_f32_bf16 v15, v79, v79, v15
    s_waitcnt lgkmcnt(3)
    v_dot2_f32_bf16 v12, v80, v14, v12
    v_dot2_f32_bf16 v13, v80, v80, v13
    v_dot2_f32_bf16 v11, v81, v14, v11
    v_dot2_f32_bf16 v15, v81, v81, v15
    v_dot2_f32_bf16 v12, v82, v14, v12
    v_dot2_f32_bf16 v13, v82, v82, v13
    v_dot2_f32_bf16 v11, v83, v14, v11
    v_dot2_f32_bf16 v15, v83, v83, v15
    s_waitcnt lgkmcnt(2)
    v_dot2_f32_bf16 v12, v84, v14, v12
    v_dot2_f32_bf16 v13, v84, v84, v13
    v_dot2_f32_bf16 v11, v85, v14, v11
    v_dot2_f32_bf16 v15, v85, v85, v15
    v_dot2_f32_bf16 v12, v86, v14, v12
    v_dot2_f32_bf16 v13, v86, v86, v13
    v_dot2_f32_bf16 v11, v87, v14, v11
    v_dot2_f32_bf16 v15, v87, v87, v15
    s_waitcnt lgkmcnt(1)
    v_dot2_f32_bf16 v12, v88, v14, v12
    v_dot2_f32_bf16 v13, v88, v88, v13
    v_dot2_f32_bf16 v11, v89, v14, v11
    v_dot2_f32_bf16 v15, v89, v89, v15
    v_dot2_f32_bf16 v12, v90, v14, v12
    v_dot2_f32_bf16 v13, v90, v90, v13
    v_dot2_f32_bf16 v11, v91, v14, v11
    v_dot2_f32_bf16 v15, v91, v91, v15
    s_waitcnt lgkmcnt(0)
    v_dot2_f32_bf16 v12, v92, v14, v12
    v_dot2_f32_bf16 v13, v92, v92, v13
    v_dot2_f32_bf16 v11, v93, v14, v11
    v_dot2_f32_bf16 v15, v93, v93, v15
    v_dot2_f32_bf16 v12, v94, v14, v12
    v_dot2_f32_bf16 v13, v94, v94, v13
    v_dot2_f32_bf16 v11, v95, v14, v11
    v_dot2_f32_bf16 v15, v95, v95, v15
    s_nop 2
    v_add_f32 v12, v12, v11
    v_add_f32 v13, v13, v15
    v_mov_b32 v10, v12
    v_mov_b32 v11, v13
    s_nop 1
    v_permlane32_swap_b32 v12, v10
    v_permlane32_swap_b32 v13, v11
    s_nop 1
    v_add_f32 v12, v12, v10
    v_add_f32 v13, v13, v11
    v_lshlrev_b32 v10, 3, v3
    s_lshl_b32 s36, s30, 8
    v_add_u32 v11, s36, v10
    v_add_u32 v11, 139264, v11
    ds_write_b64 v11, v[12:13]
    s_waitcnt lgkmcnt(0)
    s_barrier
    v_add_u32 v10, 139264, v10
    ds_read_b64 v[16:17], v10 offset:0
    ds_read_b64 v[18:19], v10 offset:256
    ds_read_b64 v[20:21], v10 offset:512
    ds_read_b64 v[22:23], v10 offset:768
    ds_read_b64 v[24:25], v10 offset:1024
    ds_read_b64 v[26:27], v10 offset:1280
    ds_read_b64 v[28:29], v10 offset:1536
    ds_read_b64 v[30:31], v10 offset:1792
    s_waitcnt lgkmcnt(0)
    v_add_f32 v16, v16, v24
    v_add_f32 v17, v17, v25
    v_add_f32 v18, v18, v26
    v_add_f32 v19, v19, v27
    v_add_f32 v20, v20, v28
    v_add_f32 v21, v21, v29
    v_add_f32 v22, v22, v30
    v_add_f32 v23, v23, v31
    v_add_f32 v16, v16, v20
    v_add_f32 v17, v17, v21
    v_add_f32 v18, v18, v22
    v_add_f32 v19, v19, v23
    v_add_f32 v16, v16, v18
    v_add_f32 v17, v17, v19
    v_mul_f32 v16, 0x3a800000, v16
    v_mul_f32 v17, 0x3a800000, v17
    v_fma_f32 v17, -v16, v16, v17
    v_add_f32 v17, 0x3727c5ac, v17
    v_rsq_f32 v12, v17
    s_nop 0
    v_mul_f32 v13, v16, v12
    v_sub_f32 v13, 0, v13
    v_lshlrev_b32 v128, 16, v64
    v_and_b32 v129, 0xffff0000, v64
    v_fma_f32 v128, v128, v12, v13
    v_fma_f32 v129, v129, v12, v13
    v_lshlrev_b32 v130, 16, v65
    v_and_b32 v131, 0xffff0000, v65
    v_fma_f32 v130, v130, v12, v13
    v_fma_f32 v131, v131, v12, v13
    v_lshlrev_b32 v132, 16, v66
    v_and_b32 v133, 0xffff0000, v66
    v_fma_f32 v132, v132, v12, v13
    v_fma_f32 v133, v133, v12, v13
    v_lshlrev_b32 v134, 16, v67
    v_and_b32 v135, 0xffff0000, v67
    v_fma_f32 v134, v134, v12, v13
    v_fma_f32 v135, v135, v12, v13
    v_lshlrev_b32 v136, 16, v68
    v_and_b32 v137, 0xffff0000, v68
    v_fma_f32 v136, v136, v12, v13
    v_fma_f32 v137, v137, v12, v13
    v_lshlrev_b32 v138, 16, v69
    v_and_b32 v139, 0xffff0000, v69
    v_fma_f32 v138, v138, v12, v13
    v_fma_f32 v139, v139, v12, v13
    v_lshlrev_b32 v140, 16, v70
    v_and_b32 v141, 0xffff0000, v70
    v_fma_f32 v140, v140, v12, v13
    v_fma_f32 v141, v141, v12, v13
    v_lshlrev_b32 v142, 16, v71
    v_and_b32 v143, 0xffff0000, v71
    v_fma_f32 v142, v142, v12, v13
    v_fma_f32 v143, v143, v12, v13
    v_lshlrev_b32 v144, 16, v72
    v_and_b32 v145, 0xffff0000, v72
    v_fma_f32 v144, v144, v12, v13
    v_fma_f32 v145, v145, v12, v13
    v_lshlrev_b32 v146, 16, v73
    v_and_b32 v147, 0xffff0000, v73
    v_fma_f32 v146, v146, v12, v13
    v_fma_f32 v147, v147, v12, v13
    v_lshlrev_b32 v148, 16, v74
    v_and_b32 v149, 0xffff0000, v74
    v_fma_f32 v148, v148, v12, v13
    v_fma_f32 v149, v149, v12, v13
    v_lshlrev_b32 v150, 16, v75
    v_and_b32 v151, 0xffff0000, v75
    v_fma_f32 v150, v150, v12, v13
    v_fma_f32 v151, v151, v12, v13
    v_lshlrev_b32 v152, 16, v76
    v_and_b32 v153, 0xffff0000, v76
    v_fma_f32 v152, v152, v12, v13
    v_fma_f32 v153, v153, v12, v13
    v_lshlrev_b32 v154, 16, v77
    v_and_b32 v155, 0xffff0000, v77
    v_fma_f32 v154, v154, v12, v13
    v_fma_f32 v155, v155, v12, v13
    v_lshlrev_b32 v156, 16, v78
    v_and_b32 v157, 0xffff0000, v78
    v_fma_f32 v156, v156, v12, v13
    v_fma_f32 v157, v157, v12, v13
    v_lshlrev_b32 v158, 16, v79
    v_and_b32 v159, 0xffff0000, v79
    v_fma_f32 v158, v158, v12, v13
    v_fma_f32 v159, v159, v12, v13
    v_lshlrev_b32 v160, 16, v80
    v_and_b32 v161, 0xffff0000, v80
    v_fma_f32 v160, v160, v12, v13
    v_fma_f32 v161, v161, v12, v13
    v_lshlrev_b32 v162, 16, v81
    v_and_b32 v163, 0xffff0000, v81
    v_fma_f32 v162, v162, v12, v13
    v_fma_f32 v163, v163, v12, v13
    v_lshlrev_b32 v164, 16, v82
    v_and_b32 v165, 0xffff0000, v82
    v_fma_f32 v164, v164, v12, v13
    v_fma_f32 v165, v165, v12, v13
    v_lshlrev_b32 v166, 16, v83
    v_and_b32 v167, 0xffff0000, v83
    v_fma_f32 v166, v166, v12, v13
    v_fma_f32 v167, v167, v12, v13
    v_lshlrev_b32 v168, 16, v84
    v_and_b32 v169, 0xffff0000, v84
    v_fma_f32 v168, v168, v12, v13
    v_fma_f32 v169, v169, v12, v13
    v_lshlrev_b32 v170, 16, v85
    v_and_b32 v171, 0xffff0000, v85
    v_fma_f32 v170, v170, v12, v13
    v_fma_f32 v171, v171, v12, v13
    v_lshlrev_b32 v172, 16, v86
    v_and_b32 v173, 0xffff0000, v86
    v_fma_f32 v172, v172, v12, v13
    v_fma_f32 v173, v173, v12, v13
    v_lshlrev_b32 v174, 16, v87
    v_and_b32 v175, 0xffff0000, v87
    v_fma_f32 v174, v174, v12, v13
    v_fma_f32 v175, v175, v12, v13
    v_lshlrev_b32 v176, 16, v88
    v_and_b32 v177, 0xffff0000, v88
    v_fma_f32 v176, v176, v12, v13
    v_fma_f32 v177, v177, v12, v13
    v_lshlrev_b32 v178, 16, v89
    v_and_b32 v179, 0xffff0000, v89
    v_fma_f32 v178, v178, v12, v13
    v_fma_f32 v179, v179, v12, v13
    v_lshlrev_b32 v180, 16, v90
    v_and_b32 v181, 0xffff0000, v90
    v_fma_f32 v180, v180, v12, v13
    v_fma_f32 v181, v181, v12, v13
    v_lshlrev_b32 v182, 16, v91
    v_and_b32 v183, 0xffff0000, v91
    v_fma_f32 v182, v182, v12, v13
    v_fma_f32 v183, v183, v12, v13
    v_lshlrev_b32 v184, 16, v92
    v_and_b32 v185, 0xffff0000, v92
    v_fma_f32 v184, v184, v12, v13
    v_fma_f32 v185, v185, v12, v13
    v_lshlrev_b32 v186, 16, v93
    v_and_b32 v187, 0xffff0000, v93
    v_fma_f32 v186, v186, v12, v13
    v_fma_f32 v187, v187, v12, v13
    v_lshlrev_b32 v188, 16, v94
    v_and_b32 v189, 0xffff0000, v94
    v_fma_f32 v188, v188, v12, v13
    v_fma_f32 v189, v189, v12, v13
    v_lshlrev_b32 v190, 16, v95
    v_and_b32 v191, 0xffff0000, v95
    v_fma_f32 v190, v190, v12, v13
    v_fma_f32 v191, v191, v12, v13
    s_cmp_eq_u32 s30, 7
    s_cbranch_scc0 PB1
    s_mov_b32 s56, 40960
    s_mov_b32 s55, 49152
    s_mov_b32 s57, 0
POLL2:
    v_min_u32 v248, 63, v1
    v_lshlrev_b32 v248, 7, v248
    buffer_load_dword v248, v248, s[96:99], s56 offen sc1
    v_min_u32 v249, 63, v1
    v_lshlrev_b32 v249, 7, v249
    buffer_load_dword v249, v249, s[96:99], s55 offen sc1
    s_waitcnt vmcnt(0)
    s_mov_b64 s[58:59], -1
    v_cmp_eq_u32 vcc, s100, v248
    s_and_b64 s[58:59], s[58:59], vcc
    v_cmp_eq_u32 vcc, s100, v249
    s_and_b64 s[58:59], s[58:59], vcc
    s_cmp_eq_u64 s[58:59], -1
    s_cbranch_scc1 POLLD2
    s_add_u32 s57, s57, 1
    s_cmp_gt_u32 s57, 400000
    s_cbranch_scc1 POLLD2
    s_sleep 1
    s_branch POLL2
POLLD2:
PB1:
    s_barrier
    v_lshlrev_b32 v8, 4, v3
    v_lshl_add_u32 v8, v4, 12, v8
    s_lshl_b32 s37, s30, 9
    s_add_u32 s36, s37, 0
    buffer_load_dwordx4 v[16:19], v8, s[16:19], s36 offen sc1
    s_add_u32 s36, s37, 16384
    buffer_load_dwordx4 v[20:23], v8, s[16:19], s36 offen sc1
    s_add_u32 s36, s37, 32768
    buffer_load_dwordx4 v[24:27], v8, s[16:19], s36 offen sc1
    s_add_u32 s36, s37, 49152
    buffer_load_dwordx4 v[28:31], v8, s[16:19], s36 offen sc1
    v_xor_b32 v32, 1, v4
    v_lshlrev_b32 v32, 12, v32
    v_lshl_add_u32 v32, v3, 4, v32
    s_lshl_b32 s36, s30, 9
    v_add_u32 v32, s36, v32
    v_add_u32 v32, 131072, v32
    v_lshlrev_b32 v10, 5, v4
    v_add_u32 v10, s36, v10
    v_add_u32 v10, 131072, v10
    v_cvt_f32_u32 v33, v4
    s_lshl_b32 s36, s31, 16
    s_lshl_b32 s37, s30, 13
    s_add_u32 s36, s36, s37
    s_add_u32 s37, s36, 4096
    s_waitcnt vmcnt(0)
    v_add_f32 v16, v16, v20
    v_add_f32 v24, v24, v28
    v_add_f32 v17, v17, v21
    v_add_f32 v25, v25, v29
    v_add_f32 v18, v18, v22
    v_add_f32 v26, v26, v30
    v_add_f32 v19, v19, v23
    v_add_f32 v27, v27, v31
    v_add_f32 v16, v16, v24
    v_add_f32 v17, v17, v25
    v_add_f32 v18, v18, v26
    v_add_f32 v19, v19, v27
    v_cvt_pk_bf16_f32 v20, v16, v17
    v_lshlrev_b32 v16, 16, v20
    v_and_b32 v17, 0xffff0000, v20
    v_cvt_pk_bf16_f32 v20, v18, v19
    v_lshlrev_b32 v18, 16, v20
    v_and_b32 v19, 0xffff0000, v20
    v_add_f32 v16, v33, v16
    v_add_f32 v17, v33, v17
    v_add_f32 v18, v33, v18
    v_add_f32 v19, v33, v19
    v_cvt_pk_bf16_f32 v20, v16, v17
    v_lshlrev_b32 v16, 16, v20
    v_and_b32 v17, 0xffff0000, v20
    v_cvt_pk_bf16_f32 v20, v18, v19
    v_lshlrev_b32 v18, 16, v20
    v_and_b32 v19, 0xffff0000, v20
    ds_write_b128 v32, v[16:19]
    s_waitcnt lgkmcnt(0)
    ds_read_b128 v[16:19], v10 offset:0
    ds_read_b128 v[20:23], v10 offset:16
    ds_read_b128 v[24:27], v10 offset:4096
    ds_read_b128 v[28:31], v10 offset:4112
    ds_read_b128 v[32:35], v10 offset:64
    ds_read_b128 v[36:39], v10 offset:80
    ds_read_b128 v[40:43], v10 offset:4160
    ds_read_b128 v[44:47], v10 offset:4176
    s_waitcnt lgkmcnt(4)
    v_fma_f32 v128, v128, v16, v24
    v_fma_f32 v129, v129, v17, v25
    v_fma_f32 v130, v130, v18, v26
    v_fma_f32 v131, v131, v19, v27
    v_fma_f32 v132, v132, v20, v28
    v_fma_f32 v133, v133, v21, v29
    v_fma_f32 v134, v134, v22, v30
    v_fma_f32 v135, v135, v23, v31
    v_cvt_pk_bf16_f32 v64, v128, v129
    v_cvt_pk_bf16_f32 v65, v130, v131
    v_cvt_pk_bf16_f32 v66, v132, v133
    v_cvt_pk_bf16_f32 v67, v134, v135
    buffer_store_dwordx4 v[64:67], v7, s[24:27], s36 offen offset:0 sc1
    ds_read_b128 v[16:19], v10 offset:128
    ds_read_b128 v[20:23], v10 offset:144
    ds_read_b128 v[24:27], v10 offset:4224
    ds_read_b128 v[28:31], v10 offset:4240
    s_waitcnt lgkmcnt(4)
    v_fma_f32 v136, v136, v32, v40
    v_fma_f32 v137, v137, v33, v41
    v_fma_f32 v138, v138, v34, v42
    v_fma_f32 v139, v139, v35, v43
    v_fma_f32 v140, v140, v36, v44
    v_fma_f32 v141, v141, v37, v45
    v_fma_f32 v142, v142, v38, v46
    v_fma_f32 v143, v143, v39, v47
    v_cvt_pk_bf16_f32 v68, v136, v137
    v_cvt_pk_bf16_f32 v69, v138, v139
    v_cvt_pk_bf16_f32 v70, v140, v141
    v_cvt_pk_bf16_f32 v71, v142, v143
    buffer_store_dwordx4 v[68:71], v7, s[24:27], s36 offen offset:1024 sc1
    ds_read_b128 v[32:35], v10 offset:192
    ds_read_b128 v[36:39], v10 offset:208
    ds_read_b128 v[40:43], v10 offset:4288
    ds_read_b128 v[44:47], v10 offset:4304
    s_waitcnt lgkmcnt(4)
    v_fma_f32 v144, v144, v16, v24
    v_fma_f32 v145, v145, v17, v25
    v_fma_f32 v146, v146, v18, v26
    v_fma_f32 v147, v147, v19, v27
    v_fma_f32 v148, v148, v20, v28
    v_fma_f32 v149, v149, v21, v29
    v_fma_f32 v150, v150, v22, v30
    v_fma_f32 v151, v151, v23, v31
    v_cvt_pk_bf16_f32 v72, v144, v145
    v_cvt_pk_bf16_f32 v73, v146, v147
    v_cvt_pk_bf16_f32 v74, v148, v149
    v_cvt_pk_bf16_f32 v75, v150, v151
    buffer_store_dwordx4 v[72:75], v7, s[24:27], s36 offen offset:2048 sc1
    ds_read_b128 v[16:19], v10 offset:256
    ds_read_b128 v[20:23], v10 offset:272
    ds_read_b128 v[24:27], v10 offset:4352
    ds_read_b128 v[28:31], v10 offset:4368
    s_waitcnt lgkmcnt(4)
    v_fma_f32 v152, v152, v32, v40
    v_fma_f32 v153, v153, v33, v41
    v_fma_f32 v154, v154, v34, v42
    v_fma_f32 v155, v155, v35, v43
    v_fma_f32 v156, v156, v36, v44
    v_fma_f32 v157, v157, v37, v45
    v_fma_f32 v158, v158, v38, v46
    v_fma_f32 v159, v159, v39, v47
    v_cvt_pk_bf16_f32 v76, v152, v153
    v_cvt_pk_bf16_f32 v77, v154, v155
    v_cvt_pk_bf16_f32 v78, v156, v157
    v_cvt_pk_bf16_f32 v79, v158, v159
    buffer_store_dwordx4 v[76:79], v7, s[24:27], s36 offen offset:3072 sc1
    ds_read_b128 v[32:35], v10 offset:320
    ds_read_b128 v[36:39], v10 offset:336
    ds_read_b128 v[40:43], v10 offset:4416
    ds_read_b128 v[44:47], v10 offset:4432
    s_waitcnt lgkmcnt(4)
    v_fma_f32 v160, v160, v16, v24
    v_fma_f32 v161, v161, v17, v25
    v_fma_f32 v162, v162, v18, v26
    v_fma_f32 v163, v163, v19, v27
    v_fma_f32 v164, v164, v20, v28
    v_fma_f32 v165, v165, v21, v29
    v_fma_f32 v166, v166, v22, v30
    v_fma_f32 v167, v167, v23, v31
    v_cvt_pk_bf16_f32 v80, v160, v161
    v_cvt_pk_bf16_f32 v81, v162, v163
    v_cvt_pk_bf16_f32 v82, v164, v165
    v_cvt_pk_bf16_f32 v83, v166, v167
    buffer_store_dwordx4 v[80:83], v7, s[24:27], s37 offen offset:0 sc1
    ds_read_b128 v[16:19], v10 offset:384
    ds_read_b128 v[20:23], v10 offset:400
    ds_read_b128 v[24:27], v10 offset:4480
    ds_read_b128 v[28:31], v10 offset:4496
    s_waitcnt lgkmcnt(4)
    v_fma_f32 v168, v168, v32, v40
    v_fma_f32 v169, v169, v33, v41
    v_fma_f32 v170, v170, v34, v42
    v_fma_f32 v171, v171, v35, v43
    v_fma_f32 v172, v172, v36, v44
    v_fma_f32 v173, v173, v37, v45
    v_fma_f32 v174, v174, v38, v46
    v_fma_f32 v175, v175, v39, v47
    v_cvt_pk_bf16_f32 v84, v168, v169
    v_cvt_pk_bf16_f32 v85, v170, v171
    v_cvt_pk_bf16_f32 v86, v172, v173
    v_cvt_pk_bf16_f32 v87, v174, v175
    buffer_store_dwordx4 v[84:87], v7, s[24:27], s37 offen offset:1024 sc1
    ds_read_b128 v[32:35], v10 offset:448
    ds_read_b128 v[36:39], v10 offset:464
    ds_read_b128 v[40:43], v10 offset:4544
    ds_read_b128 v[44:47], v10 offset:4560
    s_waitcnt lgkmcnt(4)
    v_fma_f32 v176, v176, v16, v24
    v_fma_f32 v177, v177, v17, v25
    v_fma_f32 v178, v178, v18, v26
    v_fma_f32 v179, v179, v19, v27
    v_fma_f32 v180, v180, v20, v28
    v_fma_f32 v181, v181, v21, v29
    v_fma_f32 v182, v182, v22, v30
    v_fma_f32 v183, v183, v23, v31
    v_cvt_pk_bf16_f32 v88, v176, v177
    v_cvt_pk_bf16_f32 v89, v178, v179
    v_cvt_pk_bf16_f32 v90, v180, v181
    v_cvt_pk_bf16_f32 v91, v182, v183
    buffer_store_dwordx4 v[88:91], v7, s[24:27], s37 offen offset:2048 sc1
    s_waitcnt lgkmcnt(0)
    v_fma_f32 v184, v184, v32, v40
    v_fma_f32 v185, v185, v33, v41
    v_fma_f32 v186, v186, v34, v42
    v_fma_f32 v187, v187, v35, v43
    v_fma_f32 v188, v188, v36, v44
    v_fma_f32 v189, v189, v37, v45
    v_fma_f32 v190, v190, v38, v46
    v_fma_f32 v191, v191, v39, v47
    v_cvt_pk_bf16_f32 v92, v184, v185
    v_cvt_pk_bf16_f32 v93, v186, v187
    v_cvt_pk_bf16_f32 v94, v188, v189
    v_cvt_pk_bf16_f32 v95, v190, v191
    buffer_store_dwordx4 v[92:95], v7, s[24:27], s37 offen offset:3072 sc1
    v_bfe_u32 v10, v1, 2, 2
    v_lshlrev_b32 v10, 6, v10
    v_bfe_u32 v11, v1, 4, 1
    v_lshl_add_u32 v10, v11, 5, v10
    v_and_b32 v11, 3, v1
    v_lshl_add_u32 v10, v11, 3, v10
    v_lshl_add_u32 v10, v4, 9, v10
    v_add_u32 v10, s35, v10
    v_add_u32 v10, 65536, v10
    ds_read_b64_tr_b16 v[96:97], v10 offset:0
    ds_read_b64_tr_b16 v[98:99], v10 offset:256
    ds_read_b64_tr_b16 v[100:101], v10 offset:1024
    ds_read_b64_tr_b16 v[102:103], v10 offset:1280
    ds_read_b64_tr_b16 v[104:105], v10 offset:2048
    ds_read_b64_tr_b16 v[106:107], v10 offset:2304
    ds_read_b64_tr_b16 v[108:109], v10 offset:3072
    ds_read_b64_tr_b16 v[110:111], v10 offset:3328
    ds_read_b64_tr_b16 v[112:113], v10 offset:4096
    ds_read_b64_tr_b16 v[114:115], v10 offset:4352
    ds_read_b64_tr_b16 v[116:117], v10 offset:5120
    ds_read_b64_tr_b16 v[118:119], v10 offset:5376
    ds_read_b64_tr_b16 v[120:121], v10 offset:6144
    ds_read_b64_tr_b16 v[122:123], v10 offset:6400
    ds_read_b64_tr_b16 v[124:125], v10 offset:7168
    ds_read_b64_tr_b16 v[126:127], v10 offset:7424
    s_waitcnt lgkmcnt(0)
    s_cmp_eq_u32 s32, 0
    s_cbranch_scc0 K1_V
    v_mfma_f32_32x32x16_bf16 v[16:31], v[96:99], v[64:67], 0
    v_mfma_f32_32x32x16_bf16 v[16:31], v[100:103], v[68:71], v[16:31]
    v_mfma_f32_32x32x16_bf16 v[16:31], v[104:107], v[72:75], v[16:31]
    v_mfma_f32_32x32x16_bf16 v[16:31], v[108:111], v[76:79], v[16:31]
    v_mfma_f32_32x32x16_bf16 v[16:31], v[112:115], v[80:83], v[16:31]
    v_mfma_f32_32x32x16_bf16 v[16:31], v[116:119], v[84:87], v[16:31]
    v_mfma_f32_32x32x16_bf16 v[16:31], v[120:123], v[88:91], v[16:31]
    v_mfma_f32_32x32x16_bf16 v[16:31], v[124:127], v[92:95], v[16:31]
    s_branch K1_RED
K1_V:
    v_mfma_f32_32x32x16_bf16 v[16:31], v[64:67], v[96:99], 0
    v_mfma_f32_32x32x16_bf16 v[16:31], v[68:71], v[100:103], v[16:31]
    v_mfma_f32_32x32x16_bf16 v[16:31], v[72:75], v[104:107], v[16:31]
    v_mfma_f32_32x32x16_bf16 v[16:31], v[76:79], v[108:111], v[16:31]
    v_mfma_f32_32x32x16_bf16 v[16:31], v[80:83], v[112:115], v[16:31]
    v_mfma_f32_32x32x16_bf16 v[16:31], v[84:87], v[116:119], v[16:31]
    v_mfma_f32_32x32x16_bf16 v[16:31], v[88:91], v[120:123], v[16:31]
    v_mfma_f32_32x32x16_bf16 v[16:31], v[92:95], v[124:127], v[16:31]
K1_RED:
    s_nop 15
    v_add_u32 v10, s35, v7
    ds_write_b128 v10, v[16:19] offset:0
    ds_write_b128 v10, v[20:23] offset:1024
    ds_write_b128 v10, v[24:27] offset:2048
    ds_write_b128 v10, v[28:31] offset:3072
    s_waitcnt vmcnt(0) lgkmcnt(0)
    s_barrier
    s_cmp_eq_u32 s32, 0
    s_cbranch_scc0 P1NH3
    s_cmp_eq_u32 s30, 7
    s_cbranch_scc0 SIG4
    s_lshl_b32 s36, s31, 7
    s_add_u32 s36, s36, 0
    v_mov_b32 v250, s100
    v_mov_b32 v251, 0
    v_cmp_eq_u32 vcc, 0, v1
    s_and_saveexec_b64 s[54:55], vcc
    buffer_store_dword v250, v251, s[96:99], s36 offen sc1
    s_mov_b64 exec, s[54:55]
SIG4:
P1NH3:
    s_cmp_ge_u32 s30, 2
    s_cbranch_scc1 P1_KVSKIP
    s_lshl_b32 s36, s30, 11
    v_add_u32 v10, s36, v7
    ds_read_b128 v[32:35], v10 offset:0
    ds_read_b128 v[36:39], v10 offset:1024
    ds_read_b128 v[40:43], v10 offset:8192
    ds_read_b128 v[44:47], v10 offset:9216
    ds_read_b128 v[48:51], v10 offset:16384
    ds_read_b128 v[52:55], v10 offset:17408
    ds_read_b128 v[56:59], v10 offset:24576
    ds_read_b128 v[60:63], v10 offset:25600
    ds_read_b128 v[64:67], v10 offset:32768
    ds_read_b128 v[68:71], v10 offset:33792
    ds_read_b128 v[72:75], v10 offset:40960
    ds_read_b128 v[76:79], v10 offset:41984
    ds_read_b128 v[80:83], v10 offset:49152
    ds_read_b128 v[84:87], v10 offset:50176
    ds_read_b128 v[88:91], v10 offset:57344
    ds_read_b128 v[92:95], v10 offset:58368
    s_waitcnt lgkmcnt(0)
    v_add_f32 v32, v32, v64
    v_add_f32 v33, v33, v65
    v_add_f32 v34, v34, v66
    v_add_f32 v35, v35, v67
    v_add_f32 v36, v36, v68
    v_add_f32 v37, v37, v69
    v_add_f32 v38, v38, v70
    v_add_f32 v39, v39, v71
    v_add_f32 v40, v40, v72
    v_add_f32 v41, v41, v73
    v_add_f32 v42, v42, v74
    v_add_f32 v43, v43, v75
    v_add_f32 v44, v44, v76
    v_add_f32 v45, v45, v77
    v_add_f32 v46, v46, v78
    v_add_f32 v47, v47, v79
    v_add_f32 v48, v48, v80
    v_add_f32 v49, v49, v81
    v_add_f32 v50, v50, v82
    v_add_f32 v51, v51, v83
    v_add_f32 v52, v52, v84
    v_add_f32 v53, v53, v85
    v_add_f32 v54, v54, v86
    v_add_f32 v55, v55, v87
    v_add_f32 v56, v56, v88
    v_add_f32 v57, v57, v89
    v_add_f32 v58, v58, v90
    v_add_f32 v59, v59, v91
    v_add_f32 v60, v60, v92
    v_add_f32 v61, v61, v93
    v_add_f32 v62, v62, v94
    v_add_f32 v63, v63, v95
    v_add_f32 v32, v32, v48
    v_add_f32 v33, v33, v49
    v_add_f32 v34, v34, v50
    v_add_f32 v35, v35, v51
    v_add_f32 v36, v36, v52
    v_add_f32 v37, v37, v53
    v_add_f32 v38, v38, v54
    v_add_f32 v39, v39, v55
    v_add_f32 v40, v40, v56
    v_add_f32 v41, v41, v57
    v_add_f32 v42, v42, v58
    v_add_f32 v43, v43, v59
    v_add_f32 v44, v44, v60
    v_add_f32 v45, v45, v61
    v_add_f32 v46, v46, v62
    v_add_f32 v47, v47, v63
    v_add_f32 v32, v32, v40
    v_add_f32 v33, v33, v41
    v_add_f32 v34, v34, v42
    v_add_f32 v35, v35, v43
    v_add_f32 v36, v36, v44
    v_add_f32 v37, v37, v45
    v_add_f32 v38, v38, v46
    v_add_f32 v39, v39, v47
    v_cvt_pk_bf16_f32 v32, v32, v33
    v_cvt_pk_bf16_f32 v33, v34, v35
    v_cvt_pk_bf16_f32 v34, v36, v37
    v_cvt_pk_bf16_f32 v35, v38, v39
    s_lshl_b32 s36, s31, 12
    s_lshl_b32 s37, s32, 11
    s_add_u32 s36, s36, s37
    s_lshl_b32 s37, s30, 10
    s_add_u32 s36, s36, s37
    buffer_store_dwordx4 v[32:35], v7, s[44:47], s36 offen sc1
P1_KVSKIP:
    s_waitcnt vmcnt(0)
    s_barrier
    s_cmp_eq_u32 s30, 0
    s_cbranch_scc0 CSIG5
    s_mov_b32 s4, s94
    s_mov_b32 s5, s95
    s_mov_b32 s6, 256
    s_mov_b32 s7, 0x00020000
    v_mov_b32 v250, 1
    v_mov_b32 v251, 128
    v_cmp_eq_u32 vcc, 0, v1
    s_and_saveexec_b64 s[54:55], vcc
    buffer_atomic_add v250, v251, s[4:7], 0 offen sc1
    s_mov_b64 exec, s[54:55]
CSIG5:
    s_branch P1_DONE
P0_MOD:
    s_mov_b32 s12, s86
    s_mov_b32 s13, s87
    s_mov_b32 s14, 0xc00000
    s_mov_b32 s15, 0x00020000
    s_mov_b32 s16, s84
    s_mov_b32 s17, s85
    s_mov_b32 s18, 0x800
    s_mov_b32 s19, 0x00020000
    s_mov_b32 s24, s20
    s_mov_b32 s25, s21
    s_mov_b32 s26, 0x10000
    s_mov_b32 s27, 0x00020000
    s_sub_u32 s31, s2, 128
    s_lshr_b32 s22, s31, 2
    s_and_b32 s23, s31, 3
    v_lshrrev_b32 v8, 3, v0
    v_and_b32 v9, 7, v0
    v_mul_u32_u24 v3, 12288, v8
    v_lshl_add_u32 v3, v9, 4, v3
    v_lshlrev_b32 v4, 1, v8
    s_mul_i32 s33, s23, 3145728
    s_lshl_b32 s34, s22, 7
    s_add_u32 s33, s33, s34
    s_add_u32 s35, s33, 6144
    s_lshl_b32 s34, s23, 9
    buffer_load_ushort v12, v4, s[16:19], s34 offen offset:0
    buffer_load_ushort v13, v4, s[16:19], s34 offen offset:128
    buffer_load_ushort v14, v4, s[16:19], s34 offen offset:256
    buffer_load_ushort v15, v4, s[16:19], s34 offen offset:384
    buffer_load_dwordx4 v[16:19], v3, s[12:15], s33 offen nt
    s_add_u32 s33, s33, 786432
    buffer_load_dwordx4 v[20:23], v3, s[12:15], s33 offen nt
    s_add_u32 s33, s33, 786432
    buffer_load_dwordx4 v[24:27], v3, s[12:15], s33 offen nt
    s_add_u32 s33, s33, 786432
    buffer_load_dwordx4 v[28:31], v3, s[12:15], s33 offen nt
    buffer_load_dword v250, v251, s[8:11], 0 offen sc0 sc1
    s_add_u32 s44, s20, 0x2300000
    s_addc_u32 s45, s21, 0
    s_mov_b32 s46, 0x10000
    s_mov_b32 s47, 0x00020000
    v_mov_b32 v100, 0
    v_mov_b32 v101, 0
    v_mov_b32 v102, 0
    v_mov_b32 v103, 0
    v_and_b32 v104, 31, v1
    v_lshlrev_b32 v104, 4, v104
    s_lshl_b32 s36, s31, 9
    s_cmp_eq_u32 s30, 0
    s_cselect_b32 s36, s36, 0x7f000000
    buffer_store_dwordx4 v[100:103], v104, s[44:47], s36 offen sc1
    v_mov_b32 v48, 0
    v_mov_b32 v49, 0
    v_mov_b32 v50, 0
    v_mov_b32 v51, 0
    v_mov_b32 v52, 0
    v_mov_b32 v53, 0
    v_mov_b32 v54, 0
    v_mov_b32 v55, 0
    s_waitcnt vmcnt(6)
    v_lshlrev_b32 v12, 16, v12
    v_mul_f32 v56, 0xbfb8aa3b, v12
    v_lshlrev_b32 v13, 16, v13
    v_mul_f32 v57, 0xbfb8aa3b, v13
    v_lshlrev_b32 v14, 16, v14
    v_mul_f32 v58, 0xbfb8aa3b, v14
    v_lshlrev_b32 v15, 16, v15
    v_mul_f32 v59, 0xbfb8aa3b, v15
    v_exp_f32 v56, v56
    v_exp_f32 v57, v57
    v_exp_f32 v58, v58
    v_exp_f32 v59, v59
    v_add_f32 v56, 1.0, v56
    v_add_f32 v57, 1.0, v57
    v_add_f32 v58, 1.0, v58
    v_add_f32 v59, 1.0, v59
    v_rcp_f32 v56, v56
    v_rcp_f32 v57, v57
    v_rcp_f32 v58, v58
    v_rcp_f32 v59, v59
    v_mul_f32 v12, v12, v56
    v_mul_f32 v13, v13, v57
    v_mul_f32 v14, v14, v58
    v_mul_f32 v15, v15, v59
    v_cvt_pk_bf16_f32 v12, v12, 0
    v_cvt_pk_bf16_f32 v13, v13, 0
    v_cvt_pk_bf16_f32 v14, v14, 0
    v_cvt_pk_bf16_f32 v15, v15, 0
    v_lshlrev_b32 v12, 16, v12
    v_lshlrev_b32 v13, 16, v13
    v_lshlrev_b32 v14, 16, v14
    v_lshlrev_b32 v15, 16, v15
    s_waitcnt vmcnt(2)
    v_lshlrev_b32 v5, 16, v16
    v_and_b32 v6, 0xffff0000, v16
    v_fmac_f32 v48, v5, v12
    v_fmac_f32 v49, v6, v12
    v_lshlrev_b32 v5, 16, v17
    v_and_b32 v6, 0xffff0000, v17
    v_fmac_f32 v50, v5, v12
    v_fmac_f32 v51, v6, v12
    v_lshlrev_b32 v5, 16, v18
    v_and_b32 v6, 0xffff0000, v18
    v_fmac_f32 v52, v5, v12
    v_fmac_f32 v53, v6, v12
    v_lshlrev_b32 v5, 16, v19
    v_and_b32 v6, 0xffff0000, v19
    v_fmac_f32 v54, v5, v12
    v_fmac_f32 v55, v6, v12
    v_lshlrev_b32 v5, 16, v20
    v_and_b32 v6, 0xffff0000, v20
    v_fmac_f32 v48, v5, v13
    v_fmac_f32 v49, v6, v13
    v_lshlrev_b32 v5, 16, v21
    v_and_b32 v6, 0xffff0000, v21
    v_fmac_f32 v50, v5, v13
    v_fmac_f32 v51, v6, v13
    v_lshlrev_b32 v5, 16, v22
    v_and_b32 v6, 0xffff0000, v22
    v_fmac_f32 v52, v5, v13
    v_fmac_f32 v53, v6, v13
    v_lshlrev_b32 v5, 16, v23
    v_and_b32 v6, 0xffff0000, v23
    v_fmac_f32 v54, v5, v13
    v_fmac_f32 v55, v6, v13
    v_lshlrev_b32 v5, 16, v24
    v_and_b32 v6, 0xffff0000, v24
    v_fmac_f32 v48, v5, v14
    v_fmac_f32 v49, v6, v14
    v_lshlrev_b32 v5, 16, v25
    v_and_b32 v6, 0xffff0000, v25
    v_fmac_f32 v50, v5, v14
    v_fmac_f32 v51, v6, v14
    v_lshlrev_b32 v5, 16, v26
    v_and_b32 v6, 0xffff0000, v26
    v_fmac_f32 v52, v5, v14
    v_fmac_f32 v53, v6, v14
    v_lshlrev_b32 v5, 16, v27
    v_and_b32 v6, 0xffff0000, v27
    v_fmac_f32 v54, v5, v14
    v_fmac_f32 v55, v6, v14
    v_lshlrev_b32 v5, 16, v28
    v_and_b32 v6, 0xffff0000, v28
    v_fmac_f32 v48, v5, v15
    v_fmac_f32 v49, v6, v15
    v_lshlrev_b32 v5, 16, v29
    v_and_b32 v6, 0xffff0000, v29
    v_fmac_f32 v50, v5, v15
    v_fmac_f32 v51, v6, v15
    v_lshlrev_b32 v5, 16, v30
    v_and_b32 v6, 0xffff0000, v30
    v_fmac_f32 v52, v5, v15
    v_fmac_f32 v53, v6, v15
    v_lshlrev_b32 v5, 16, v31
    v_and_b32 v6, 0xffff0000, v31
    v_fmac_f32 v54, v5, v15
    v_fmac_f32 v55, v6, v15
    s_mov_b32 s57, 0
TOKWM:
    s_waitcnt vmcnt(0)
    v_readfirstlane_b32 s100, v250
    s_add_u32 s57, s57, 1
    s_cmp_gt_u32 s57, 400000
    s_cbranch_scc1 TOKDM
    s_cmp_eq_u32 s100, 0
    s_cbranch_scc0 TOKDM
    s_sleep 1
    buffer_load_dword v250, v251, s[8:11], 0 offen sc0 sc1
    s_branch TOKWM
TOKDM:
    s_cmp_eq_u32 s30, 0
    s_cbranch_scc1 MJB_LATE
    s_mov_b32 s36, s35
    buffer_load_dwordx4 v[32:35], v3, s[12:15], s36 offen nt
    s_add_u32 s36, s36, 786432
    buffer_load_dwordx4 v[36:39], v3, s[12:15], s36 offen nt
    s_add_u32 s36, s36, 786432
    buffer_load_dwordx4 v[40:43], v3, s[12:15], s36 offen nt
    s_add_u32 s36, s36, 786432
    buffer_load_dwordx4 v[44:47], v3, s[12:15], s36 offen nt
MJB_LATE:
    v_lshlrev_b32 v5, 5, v0
    v_add_u32 v5, 65536, v5
    ds_write_b128 v5, v[48:51]
    ds_write_b128 v5, v[52:55] offset:16
    s_waitcnt lgkmcnt(0)
    s_barrier
    v_and_b32 v6, 63, v0
    v_lshrrev_b32 v7, 6, v0
    v_lshlrev_b32 v5, 11, v7
    v_lshl_add_u32 v5, v6, 2, v5
    v_add_u32 v5, 65536, v5
    ds_read_b32 v56, v5 offset:0
    ds_read_b32 v57, v5 offset:256
    ds_read_b32 v58, v5 offset:512
    ds_read_b32 v59, v5 offset:768
    ds_read_b32 v60, v5 offset:1024
    ds_read_b32 v61, v5 offset:1280
    ds_read_b32 v62, v5 offset:1536
    ds_read_b32 v63, v5 offset:1792
    s_waitcnt lgkmcnt(0)
    v_add_f32 v56, v56, v60
    v_add_f32 v57, v57, v61
    v_add_f32 v58, v58, v62
    v_add_f32 v59, v59, v63
    v_add_f32 v56, v56, v58
    v_add_f32 v57, v57, v59
    v_add_f32 v56, v56, v57
    v_lshlrev_b32 v5, 2, v0
    v_add_u32 v6, 65536, v5
    ds_write_b32 v6, v56 offset:16384
    s_waitcnt lgkmcnt(0)
    s_barrier
    s_cmp_eq_u32 s30, 0
    s_cbranch_scc0 MJ_SKIPA
    ds_read_b32 v56, v6 offset:16384
    ds_read_b32 v57, v6 offset:16640
    ds_read_b32 v58, v6 offset:16896
    ds_read_b32 v59, v6 offset:17152
    ds_read_b32 v60, v6 offset:17408
    ds_read_b32 v61, v6 offset:17664
    ds_read_b32 v62, v6 offset:17920
    ds_read_b32 v63, v6 offset:18176
    s_waitcnt lgkmcnt(0)
    v_add_f32 v56, v56, v60
    v_add_f32 v57, v57, v61
    v_add_f32 v58, v58, v62
    v_add_f32 v59, v59, v63
    v_add_f32 v56, v56, v58
    v_add_f32 v57, v57, v59
    v_add_f32 v56, v56, v57
    s_lshl_b32 s33, s23, 14
    s_lshl_b32 s34, s22, 8
    s_add_u32 s33, s33, s34
    buffer_store_dword v56, v5, s[24:27], s33 offen sc1
    s_waitcnt vmcnt(0)
    s_cmp_eq_u32 s30, 0
    s_cbranch_scc0 SIG6
    s_lshl_b32 s36, s31, 7
    s_add_u32 s36, s36, 40960
    v_mov_b32 v250, s100
    v_mov_b32 v251, 0
    v_cmp_eq_u32 vcc, 0, v1
    s_and_saveexec_b64 s[54:55], vcc
    buffer_store_dword v250, v251, s[96:99], s36 offen sc1
    s_mov_b64 exec, s[54:55]
SIG6:
MJ_SKIPA:
    s_cmp_eq_u32 s30, 0
    s_cbranch_scc0 MJB_EARLY
    s_mov_b32 s36, s35
    buffer_load_dwordx4 v[32:35], v3, s[12:15], s36 offen nt
    s_add_u32 s36, s36, 786432
    buffer_load_dwordx4 v[36:39], v3, s[12:15], s36 offen nt
    s_add_u32 s36, s36, 786432
    buffer_load_dwordx4 v[40:43], v3, s[12:15], s36 offen nt
    s_add_u32 s36, s36, 786432
    buffer_load_dwordx4 v[44:47], v3, s[12:15], s36 offen nt
MJB_EARLY:
    s_mul_i32 s36, s23, 3145728
    s_lshl_b32 s37, s22, 7
    s_add_u32 s36, s36, s37
    s_mov_b32 s37, 4096
    s_cmp_ge_u32 s22, 16
    s_cselect_b32 s37, 8192, s37
    s_add_u32 s36, s36, s37
    buffer_load_dwordx4 v[64:67], v3, s[12:15], s36 offen nt
    s_add_u32 s36, s36, 786432
    buffer_load_dwordx4 v[68:71], v3, s[12:15], s36 offen nt
    s_add_u32 s36, s36, 786432
    buffer_load_dwordx4 v[72:75], v3, s[12:15], s36 offen nt
    s_add_u32 s36, s36, 786432
    buffer_load_dwordx4 v[76:79], v3, s[12:15], s36 offen nt
    v_mov_b32 v48, 0
    v_mov_b32 v49, 0
    v_mov_b32 v50, 0
    v_mov_b32 v51, 0
    v_mov_b32 v52, 0
    v_mov_b32 v53, 0
    v_mov_b32 v54, 0
    v_mov_b32 v55, 0
    s_waitcnt vmcnt(4)
    v_lshlrev_b32 v5, 16, v32
    v_and_b32 v6, 0xffff0000, v32
    v_fmac_f32 v48, v5, v12
    v_fmac_f32 v49, v6, v12
    v_lshlrev_b32 v5, 16, v33
    v_and_b32 v6, 0xffff0000, v33
    v_fmac_f32 v50, v5, v12
    v_fmac_f32 v51, v6, v12
    v_lshlrev_b32 v5, 16, v34
    v_and_b32 v6, 0xffff0000, v34
    v_fmac_f32 v52, v5, v12
    v_fmac_f32 v53, v6, v12
    v_lshlrev_b32 v5, 16, v35
    v_and_b32 v6, 0xffff0000, v35
    v_fmac_f32 v54, v5, v12
    v_fmac_f32 v55, v6, v12
    v_lshlrev_b32 v5, 16, v36
    v_and_b32 v6, 0xffff0000, v36
    v_fmac_f32 v48, v5, v13
    v_fmac_f32 v49, v6, v13
    v_lshlrev_b32 v5, 16, v37
    v_and_b32 v6, 0xffff0000, v37
    v_fmac_f32 v50, v5, v13
    v_fmac_f32 v51, v6, v13
    v_lshlrev_b32 v5, 16, v38
    v_and_b32 v6, 0xffff0000, v38
    v_fmac_f32 v52, v5, v13
    v_fmac_f32 v53, v6, v13
    v_lshlrev_b32 v5, 16, v39
    v_and_b32 v6, 0xffff0000, v39
    v_fmac_f32 v54, v5, v13
    v_fmac_f32 v55, v6, v13
    v_lshlrev_b32 v5, 16, v40
    v_and_b32 v6, 0xffff0000, v40
    v_fmac_f32 v48, v5, v14
    v_fmac_f32 v49, v6, v14
    v_lshlrev_b32 v5, 16, v41
    v_and_b32 v6, 0xffff0000, v41
    v_fmac_f32 v50, v5, v14
    v_fmac_f32 v51, v6, v14
    v_lshlrev_b32 v5, 16, v42
    v_and_b32 v6, 0xffff0000, v42
    v_fmac_f32 v52, v5, v14
    v_fmac_f32 v53, v6, v14
    v_lshlrev_b32 v5, 16, v43
    v_and_b32 v6, 0xffff0000, v43
    v_fmac_f32 v54, v5, v14
    v_fmac_f32 v55, v6, v14
    v_lshlrev_b32 v5, 16, v44
    v_and_b32 v6, 0xffff0000, v44
    v_fmac_f32 v48, v5, v15
    v_fmac_f32 v49, v6, v15
    v_lshlrev_b32 v5, 16, v45
    v_and_b32 v6, 0xffff0000, v45
    v_fmac_f32 v50, v5, v15
    v_fmac_f32 v51, v6, v15
    v_lshlrev_b32 v5, 16, v46
    v_and_b32 v6, 0xffff0000, v46
    v_fmac_f32 v52, v5, v15
    v_fmac_f32 v53, v6, v15
    v_lshlrev_b32 v5, 16, v47
    v_and_b32 v6, 0xffff0000, v47
    v_fmac_f32 v54, v5, v15
    v_fmac_f32 v55, v6, v15
    s_barrier
    s_add_u32 s38, s31, 128
    v_lshlrev_b32 v5, 5, v0
    v_add_u32 v5, 65536, v5
    ds_write_b128 v5, v[48:51]
    ds_write_b128 v5, v[52:55] offset:16
    s_waitcnt lgkmcnt(0)
    s_barrier
    v_and_b32 v6, 63, v0
    v_lshrrev_b32 v7, 6, v0
    v_lshlrev_b32 v5, 11, v7
    v_lshl_add_u32 v5, v6, 2, v5
    v_add_u32 v5, 65536, v5
    ds_read_b32 v56, v5 offset:0
    ds_read_b32 v57, v5 offset:256
    ds_read_b32 v58, v5 offset:512
    ds_read_b32 v59, v5 offset:768
    ds_read_b32 v60, v5 offset:1024
    ds_read_b32 v61, v5 offset:1280
    ds_read_b32 v62, v5 offset:1536
    ds_read_b32 v63, v5 offset:1792
    s_waitcnt lgkmcnt(0)
    v_add_f32 v56, v56, v60
    v_add_f32 v57, v57, v61
    v_add_f32 v58, v58, v62
    v_add_f32 v59, v59, v63
    v_add_f32 v56, v56, v58
    v_add_f32 v57, v57, v59
    v_add_f32 v56, v56, v57
    v_lshlrev_b32 v5, 2, v0
    v_add_u32 v6, 65536, v5
    ds_write_b32 v6, v56 offset:16384
    s_waitcnt lgkmcnt(0)
    s_barrier
    s_cmp_eq_u32 s30, 0
    s_cbranch_scc0 MJ_SKIPB
    ds_read_b32 v56, v6 offset:16384
    ds_read_b32 v57, v6 offset:16640
    ds_read_b32 v58, v6 offset:16896
    ds_read_b32 v59, v6 offset:17152
    ds_read_b32 v60, v6 offset:17408
    ds_read_b32 v61, v6 offset:17664
    ds_read_b32 v62, v6 offset:17920
    ds_read_b32 v63, v6 offset:18176
    s_waitcnt lgkmcnt(0)
    v_add_f32 v56, v56, v60
    v_add_f32 v57, v57, v61
    v_add_f32 v58, v58, v62
    v_add_f32 v59, v59, v63
    v_add_f32 v56, v56, v58
    v_add_f32 v57, v57, v59
    v_add_f32 v56, v56, v57
    s_lshl_b32 s33, s23, 14
    s_lshl_b32 s34, s22, 8
    s_add_u32 s33, s33, s34
    s_add_u32 s33, s33, 8192
    buffer_store_dword v56, v5, s[24:27], s33 offen sc1
    s_waitcnt vmcnt(0)
    s_cmp_eq_u32 s30, 0
    s_cbranch_scc0 CSIG7
    s_mov_b32 s4, s94
    s_mov_b32 s5, s95
    s_mov_b32 s6, 256
    s_mov_b32 s7, 0x00020000
    v_mov_b32 v250, 1
    v_mov_b32 v251, 32
    v_cmp_eq_u32 vcc, 0, v1
    s_and_saveexec_b64 s[54:55], vcc
    buffer_atomic_add v250, v251, s[4:7], 0 offen sc1
    s_mov_b64 exec, s[54:55]
CSIG7:
MJ_SKIPB:
    s_mov_b32 s56, s66
    s_mov_b32 s57, s67
    s_mov_b32 s58, 0x200000
    s_mov_b32 s59, 0x00020000
    s_add_u32 s44, s20, 0x10000
    s_addc_u32 s45, s21, 0
    s_mov_b32 s46, 0x8000
    s_mov_b32 s47, 0x00020000
    s_lshr_b32 s36, s31, 3
    s_lshl_b32 s36, s36, 6
    s_lshl_b32 s37, s30, 3
    s_add_u32 s36, s36, s37
    s_lshl_b32 s36, s36, 11
    s_and_b32 s37, s2, 7
    s_lshr_b32 s37, s37, 2
    s_lshl_b32 s37, s37, 10
    s_add_u32 s36, s36, s37
    v_and_b32 v5, 63, v0
    v_lshrrev_b32 v6, 3, v5
    v_lshlrev_b32 v6, 11, v6
    v_and_b32 v5, 7, v5
    v_lshl_add_u32 v5, v5, 7, v6
    buffer_load_dword v100, v5, s[56:59], s36 offen
    v_mov_b32 v48, 0
    v_mov_b32 v49, 0
    v_mov_b32 v50, 0
    v_mov_b32 v51, 0
    v_mov_b32 v52, 0
    v_mov_b32 v53, 0
    v_mov_b32 v54, 0
    v_mov_b32 v55, 0
    s_waitcnt vmcnt(1)
    v_lshlrev_b32 v5, 16, v64
    v_and_b32 v6, 0xffff0000, v64
    v_fmac_f32 v48, v5, v12
    v_fmac_f32 v49, v6, v12
    v_lshlrev_b32 v5, 16, v65
    v_and_b32 v6, 0xffff0000, v65
    v_fmac_f32 v50, v5, v12
    v_fmac_f32 v51, v6, v12
    v_lshlrev_b32 v5, 16, v66
    v_and_b32 v6, 0xffff0000, v66
    v_fmac_f32 v52, v5, v12
    v_fmac_f32 v53, v6, v12
    v_lshlrev_b32 v5, 16, v67
    v_and_b32 v6, 0xffff0000, v67
    v_fmac_f32 v54, v5, v12
    v_fmac_f32 v55, v6, v12
    v_lshlrev_b32 v5, 16, v68
    v_and_b32 v6, 0xffff0000, v68
    v_fmac_f32 v48, v5, v13
    v_fmac_f32 v49, v6, v13
    v_lshlrev_b32 v5, 16, v69
    v_and_b32 v6, 0xffff0000, v69
    v_fmac_f32 v50, v5, v13
    v_fmac_f32 v51, v6, v13
    v_lshlrev_b32 v5, 16, v70
    v_and_b32 v6, 0xffff0000, v70
    v_fmac_f32 v52, v5, v13
    v_fmac_f32 v53, v6, v13
    v_lshlrev_b32 v5, 16, v71
    v_and_b32 v6, 0xffff0000, v71
    v_fmac_f32 v54, v5, v13
    v_fmac_f32 v55, v6, v13
    v_lshlrev_b32 v5, 16, v72
    v_and_b32 v6, 0xffff0000, v72
    v_fmac_f32 v48, v5, v14
    v_fmac_f32 v49, v6, v14
    v_lshlrev_b32 v5, 16, v73
    v_and_b32 v6, 0xffff0000, v73
    v_fmac_f32 v50, v5, v14
    v_fmac_f32 v51, v6, v14
    v_lshlrev_b32 v5, 16, v74
    v_and_b32 v6, 0xffff0000, v74
    v_fmac_f32 v52, v5, v14
    v_fmac_f32 v53, v6, v14
    v_lshlrev_b32 v5, 16, v75
    v_and_b32 v6, 0xffff0000, v75
    v_fmac_f32 v54, v5, v14
    v_fmac_f32 v55, v6, v14
    v_lshlrev_b32 v5, 16, v76
    v_and_b32 v6, 0xffff0000, v76
    v_fmac_f32 v48, v5, v15
    v_fmac_f32 v49, v6, v15
    v_lshlrev_b32 v5, 16, v77
    v_and_b32 v6, 0xffff0000, v77
    v_fmac_f32 v50, v5, v15
    v_fmac_f32 v51, v6, v15
    v_lshlrev_b32 v5, 16, v78
    v_and_b32 v6, 0xffff0000, v78
    v_fmac_f32 v52, v5, v15
    v_fmac_f32 v53, v6, v15
    v_lshlrev_b32 v5, 16, v79
    v_and_b32 v6, 0xffff0000, v79
    v_fmac_f32 v54, v5, v15
    v_fmac_f32 v55, v6, v15
    s_barrier
    v_lshlrev_b32 v5, 5, v0
    v_add_u32 v5, 65536, v5
    ds_write_b128 v5, v[48:51]
    ds_write_b128 v5, v[52:55] offset:16
    s_waitcnt lgkmcnt(0)
    s_barrier
    v_and_b32 v6, 63, v0
    v_lshrrev_b32 v7, 6, v0
    v_lshlrev_b32 v5, 11, v7
    v_lshl_add_u32 v5, v6, 2, v5
    v_add_u32 v5, 65536, v5
    ds_read_b32 v56, v5 offset:0
    ds_read_b32 v57, v5 offset:256
    ds_read_b32 v58, v5 offset:512
    ds_read_b32 v59, v5 offset:768
    ds_read_b32 v60, v5 offset:1024
    ds_read_b32 v61, v5 offset:1280
    ds_read_b32 v62, v5 offset:1536
    ds_read_b32 v63, v5 offset:1792
    s_waitcnt lgkmcnt(0)
    v_add_f32 v56, v56, v60
    v_add_f32 v57, v57, v61
    v_add_f32 v58, v58, v62
    v_add_f32 v59, v59, v63
    v_add_f32 v56, v56, v58
    v_add_f32 v57, v57, v59
    v_add_f32 v56, v56, v57
    v_lshlrev_b32 v5, 2, v0
    v_add_u32 v6, 65536, v5
    ds_write_b32 v6, v56 offset:16384
    s_waitcnt lgkmcnt(0)
    s_barrier
    s_cmp_eq_u32 s30, 0
    s_cbranch_scc0 MJ_SKIPC
    ds_read_b32 v56, v6 offset:16384
    ds_read_b32 v57, v6 offset:16640
    ds_read_b32 v58, v6 offset:16896
    ds_read_b32 v59, v6 offset:17152
    ds_read_b32 v60, v6 offset:17408
    ds_read_b32 v61, v6 offset:17664
    ds_read_b32 v62, v6 offset:17920
    ds_read_b32 v63, v6 offset:18176
    s_waitcnt lgkmcnt(0)
    v_add_f32 v56, v56, v60
    v_add_f32 v57, v57, v61
    v_add_f32 v58, v58, v62
    v_add_f32 v59, v59, v63
    v_add_f32 v56, v56, v58
    v_add_f32 v57, v57, v59
    v_add_f32 v56, v56, v57
    s_lshl_b32 s33, s23, 13
    s_lshl_b32 s34, s22, 8
    s_add_u32 s33, s33, s34
    buffer_store_dword v56, v5, s[44:47], s33 offen sc1
    s_waitcnt vmcnt(0)
    s_cmp_eq_u32 s30, 0
    s_cbranch_scc0 CSIG8
    s_mov_b32 s4, s94
    s_mov_b32 s5, s95
    s_mov_b32 s6, 256
    s_mov_b32 s7, 0x00020000
    v_mov_b32 v250, 1
    v_mov_b32 v251, 160
    v_cmp_eq_u32 vcc, 0, v1
    s_and_saveexec_b64 s[54:55], vcc
    buffer_atomic_add v250, v251, s[4:7], 0 offen sc1
    s_mov_b64 exec, s[54:55]
CSIG8:
MJ_SKIPC:
    s_waitcnt vmcnt(0)
    s_barrier
P1_DONE:
    s_and_b32 s26, s2, 7
    s_lshr_b32 s27, s2, 3
    s_and_b32 s28, s26, 3
    s_lshl_b32 s28, s28, 2
    s_and_b32 s29, s27, 3
    s_add_u32 s28, s28, s29
    s_lshr_b32 s29, s26, 2
    s_lshl_b32 s29, s29, 3
    s_lshr_b32 s27, s27, 2
    s_add_u32 s29, s29, s27
    v_and_b32 v1, 63, v0
    v_lshrrev_b32 v5, 6, v0
    v_lshlrev_b32 v2, 4, v1
    v_readfirstlane_b32 s30, v5
    s_nop 3
    s_and_b32 s31, s30, 3
    s_lshr_b32 s32, s30, 2
    s_mov_b32 s8, s66
    s_mov_b32 s9, s67
    s_mov_b32 s10, 0x200000
    s_mov_b32 s11, 0x00020000
    s_add_u32 s12, s20, 0x100000
    s_addc_u32 s13, s21, 0
    s_mov_b32 s14, 0x400000
    s_mov_b32 s15, 0x00020000
    s_add_u32 s16, s20, 0x40000
    s_addc_u32 s17, s21, 0
    s_mov_b32 s18, 0x40000
    s_mov_b32 s19, 0x00020000
    s_add_u32 s24, s20, 0x500000
    s_addc_u32 s25, s21, 0
    s_mov_b32 s26, 0x400000
    s_mov_b32 s27, 0x00020000
    v_lshrrev_b32 v5, 5, v1
    v_bfe_u32 v6, v1, 2, 2
    v_lshl_add_u32 v5, v5, 2, v6
    v_mul_u32_u24 v3, 2048, v5
    v_bfe_u32 v5, v1, 4, 1
    v_lshl_add_u32 v3, v5, 6, v3
    v_and_b32 v7, 3, v1
    v_lshl_add_u32 v3, v7, 4, v3
    v_lshlrev_b32 v4, 6, v6
    v_lshl_add_u32 v4, v5, 5, v4
    v_lshl_add_u32 v4, v7, 3, v4
    v_lshrrev_b32 v5, 5, v1
    v_lshl_add_u32 v4, v5, 10, v4
    s_lshl_b32 s36, s32, 13
    v_add_u32 v4, s36, v4
    s_mul_i32 s33, s32, 512
    s_lshl_b32 s36, s31, 4
    s_add_u32 s33, s33, s36
    s_mul_i32 s33, s33, 2048
    s_lshl_b32 s36, s29, 7
    s_add_u32 s33, s33, s36
    s_lshl_b32 s34, s28, 2
    s_add_u32 s34, s34, s31
    s_mul_i32 s34, s34, 64
    s_mul_i32 s36, s32, 32
    s_add_u32 s34, s34, s36
    s_lshl_b32 s34, s34, 10
    s_lshl_b32 s39, s32, 13
    s_lshl_b32 s36, s31, 11
    s_add_u32 s39, s39, s36
    s_add_u32 s37, s33, 16384
    s_add_u32 m0, s39, 0
    s_nop 0
    buffer_load_dwordx4 v3, s[8:11], s33 offen lds
    s_add_u32 m0, s39, 1024
    s_nop 0
    buffer_load_dwordx4 v3, s[8:11], s37 offen lds
    s_add_u32 s33, s33, 131072
    s_add_u32 s37, s33, 16384
    s_add_u32 m0, s39, 16384
    s_nop 0
    buffer_load_dwordx4 v3, s[8:11], s33 offen lds
    s_add_u32 m0, s39, 17408
    s_nop 0
    buffer_load_dwordx4 v3, s[8:11], s37 offen lds
    s_add_u32 s33, s33, 131072
    s_add_u32 s37, s33, 16384
    s_add_u32 m0, s39, 32768
    s_nop 0
    buffer_load_dwordx4 v3, s[8:11], s33 offen lds
    s_add_u32 m0, s39, 33792
    s_nop 0
    buffer_load_dwordx4 v3, s[8:11], s37 offen lds
    s_add_u32 s33, s33, 131072
    v_mov_b32 v5, 131072
    v_mov_b32 v6, 0
    ds_write_b32 v5, v6
    s_lshl_b32 s42, s30, 12
    s_lshr_b32 s52, s2, 3
    s_and_b32 s53, s2, 7
    v_lshrrev_b32 v5, 3, v1
    v_lshlrev_b32 v5, 11, v5
    v_and_b32 v6, 7, v1
    v_lshl_add_u32 v5, v6, 7, v5
    s_lshl_b32 s36, s52, 5
    s_lshl_b32 s37, s30, 3
    s_add_u32 s36, s36, s37
    s_lshl_b32 s36, s36, 11
    s_lshr_b32 s37, s53, 2
    s_lshl_b32 s37, s37, 10
    s_add_u32 s36, s36, s37
    v_add_u32 v5, s36, v5
    v_lshrrev_b32 v6, 4, v1
    v_mul_u32_u24 v6, 7168, v6
    v_and_b32 v7, 15, v1
    v_min_u32 v7, 13, v7
    v_lshl_add_u32 v6, v7, 7, v6
    s_xor_b32 s37, s30, 4
    s_lshl_b32 s37, s37, 2
    s_lshl_b32 s36, s52, 5
    s_add_u32 s36, s36, s37
    s_mul_i32 s36, s36, 7168
    s_lshr_b32 s37, s53, 1
    s_mul_i32 s37, s37, 1792
    s_add_u32 s36, s36, s37
    v_add_u32 v6, s36, v6
    s_mul_i32 s36, s2, 224
    s_sub_u32 s37, s30, 4
    s_and_b32 s37, s37, 3
    s_lshl_b32 s37, s37, 6
    s_add_u32 s36, s36, s37
    v_add_u32 v7, s36, v1
    v_min_u32 v7, 57343, v7
    v_lshlrev_b32 v7, 7, v7
    s_cmp_lt_u32 s30, 4
    s_cselect_b32 s60, s72, s76
    s_cselect_b32 s61, s73, s77
    s_cselect_b32 s62, s76, s80
    s_cselect_b32 s63, s77, s81
    s_cselect_b64 vcc, -1, 0
    s_nop 1
    v_cndmask_b32 v168, v6, v5, vcc
    v_cndmask_b32 v169, v7, v6, vcc
    s_cmp_eq_u32 s30, 7
    s_cbranch_scc0 PB9
    s_lshl_b32 s56, s28, 9
    s_add_u32 s56, s56, 0
    s_mov_b32 s57, 0
POLL10:
    v_min_u32 v248, 3, v1
    v_lshlrev_b32 v248, 7, v248
    buffer_load_dword v248, v248, s[96:99], s56 offen sc1
    s_waitcnt vmcnt(0)
    s_mov_b64 s[58:59], -1
    v_cmp_eq_u32 vcc, s100, v248
    s_and_b64 s[58:59], s[58:59], vcc
    s_cmp_eq_u64 s[58:59], -1
    s_cbranch_scc1 POLLD10
    s_add_u32 s57, s57, 1
    s_cmp_gt_u32 s57, 400000
    s_cbranch_scc1 POLLD10
    s_sleep 1
    s_branch POLL10
POLLD10:
PB9:
    s_mov_b32 s4, s94
    s_mov_b32 s5, s95
    s_mov_b32 s6, 256
    s_mov_b32 s7, 0x00020000
    s_barrier
    buffer_load_dwordx4 v[80:83], v2, s[12:15], s34 offen offset:0 sc1
    buffer_load_dwordx4 v[84:87], v2, s[12:15], s34 offen offset:1024 sc1
    buffer_load_dwordx4 v[88:91], v2, s[12:15], s34 offen offset:2048 sc1
    buffer_load_dwordx4 v[92:95], v2, s[12:15], s34 offen offset:3072 sc1
    s_add_u32 s34, s34, 4096
    buffer_load_dwordx4 v[96:99], v2, s[12:15], s34 offen offset:0 sc1
    buffer_load_dwordx4 v[100:103], v2, s[12:15], s34 offen offset:1024 sc1
    buffer_load_dwordx4 v[104:107], v2, s[12:15], s34 offen offset:2048 sc1
    buffer_load_dwordx4 v[108:111], v2, s[12:15], s34 offen offset:3072 sc1
    s_add_u32 s34, s34, 4096
    buffer_load_dwordx4 v[112:115], v2, s[12:15], s34 offen offset:0 sc1
    buffer_load_dwordx4 v[116:119], v2, s[12:15], s34 offen offset:1024 sc1
    buffer_load_dwordx4 v[120:123], v2, s[12:15], s34 offen offset:2048 sc1
    buffer_load_dwordx4 v[124:127], v2, s[12:15], s34 offen offset:3072 sc1
    s_add_u32 s34, s34, 4096
    v_mov_b32 v16, 0
    v_mov_b32 v17, 0
    v_mov_b32 v18, 0
    v_mov_b32 v19, 0
    v_mov_b32 v20, 0
    v_mov_b32 v21, 0
    v_mov_b32 v22, 0
    v_mov_b32 v23, 0
    v_mov_b32 v24, 0
    v_mov_b32 v25, 0
    v_mov_b32 v26, 0
    v_mov_b32 v27, 0
    v_mov_b32 v28, 0
    v_mov_b32 v29, 0
    v_mov_b32 v30, 0
    v_mov_b32 v31, 0
    v_mov_b32 v32, 0
    v_mov_b32 v33, 0
    v_mov_b32 v34, 0
    v_mov_b32 v35, 0
    v_mov_b32 v36, 0
    v_mov_b32 v37, 0
    v_mov_b32 v38, 0
    v_mov_b32 v39, 0
    v_mov_b32 v40, 0
    v_mov_b32 v41, 0
    v_mov_b32 v42, 0
    v_mov_b32 v43, 0
    v_mov_b32 v44, 0
    v_mov_b32 v45, 0
    v_mov_b32 v46, 0
    v_mov_b32 v47, 0
    s_waitcnt vmcnt(8)
    s_barrier
    ds_read_b64_tr_b16 v[48:49], v4 offset:0
    ds_read_b64_tr_b16 v[50:51], v4 offset:512
    ds_read_b64_tr_b16 v[52:53], v4 offset:256
    ds_read_b64_tr_b16 v[54:55], v4 offset:768
    ds_read_b64_tr_b16 v[56:57], v4 offset:2048
    ds_read_b64_tr_b16 v[58:59], v4 offset:2560
    ds_read_b64_tr_b16 v[60:61], v4 offset:2304
    ds_read_b64_tr_b16 v[62:63], v4 offset:2816
    ds_read_b64_tr_b16 v[64:65], v4 offset:4096
    ds_read_b64_tr_b16 v[66:67], v4 offset:4608
    ds_read_b64_tr_b16 v[68:69], v4 offset:4352
    ds_read_b64_tr_b16 v[70:71], v4 offset:4864
    ds_read_b64_tr_b16 v[72:73], v4 offset:6144
    ds_read_b64_tr_b16 v[74:75], v4 offset:6656
    ds_read_b64_tr_b16 v[76:77], v4 offset:6400
    ds_read_b64_tr_b16 v[78:79], v4 offset:6912
    s_waitcnt lgkmcnt(12)
    v_mfma_f32_32x32x16_bf16 v[16:31], v[48:51], v[80:83], v[16:31]
    v_mfma_f32_32x32x16_bf16 v[32:47], v[52:55], v[80:83], v[32:47]
    s_add_u32 s37, s33, 16384
    s_add_u32 m0, s39, 49152
    s_nop 0
    buffer_load_dwordx4 v3, s[8:11], s33 offen lds
    s_waitcnt lgkmcnt(8)
    v_mfma_f32_32x32x16_bf16 v[16:31], v[56:59], v[84:87], v[16:31]
    v_mfma_f32_32x32x16_bf16 v[32:47], v[60:63], v[84:87], v[32:47]
    s_add_u32 m0, s39, 50176
    s_nop 0
    buffer_load_dwordx4 v3, s[8:11], s37 offen lds
    s_add_u32 s33, s33, 131072
    s_waitcnt lgkmcnt(4)
    v_mfma_f32_32x32x16_bf16 v[16:31], v[64:67], v[88:91], v[16:31]
    v_mfma_f32_32x32x16_bf16 v[32:47], v[68:71], v[88:91], v[32:47]
    buffer_load_dwordx4 v[128:131], v2, s[12:15], s34 offen offset:0 sc1
    buffer_load_dwordx4 v[132:135], v2, s[12:15], s34 offen offset:1024 sc1
    s_waitcnt lgkmcnt(0)
    v_mfma_f32_32x32x16_bf16 v[16:31], v[72:75], v[92:95], v[16:31]
    v_mfma_f32_32x32x16_bf16 v[32:47], v[76:79], v[92:95], v[32:47]
    buffer_load_dwordx4 v[136:139], v2, s[12:15], s34 offen offset:2048 sc1
    buffer_load_dwordx4 v[140:143], v2, s[12:15], s34 offen offset:3072 sc1
    s_add_u32 s34, s34, 4096
    s_waitcnt vmcnt(10)
    s_barrier
    ds_read_b64_tr_b16 v[48:49], v4 offset:16384
    ds_read_b64_tr_b16 v[50:51], v4 offset:16896
    ds_read_b64_tr_b16 v[52:53], v4 offset:16640
    ds_read_b64_tr_b16 v[54:55], v4 offset:17152
    ds_read_b64_tr_b16 v[56:57], v4 offset:18432
    ds_read_b64_tr_b16 v[58:59], v4 offset:18944
    ds_read_b64_tr_b16 v[60:61], v4 offset:18688
    ds_read_b64_tr_b16 v[62:63], v4 offset:19200
    ds_read_b64_tr_b16 v[64:65], v4 offset:20480
    ds_read_b64_tr_b16 v[66:67], v4 offset:20992
    ds_read_b64_tr_b16 v[68:69], v4 offset:20736
    ds_read_b64_tr_b16 v[70:71], v4 offset:21248
    ds_read_b64_tr_b16 v[72:73], v4 offset:22528
    ds_read_b64_tr_b16 v[74:75], v4 offset:23040
    ds_read_b64_tr_b16 v[76:77], v4 offset:22784
    ds_read_b64_tr_b16 v[78:79], v4 offset:23296
    s_waitcnt lgkmcnt(12)
    v_mfma_f32_32x32x16_bf16 v[16:31], v[48:51], v[96:99], v[16:31]
    v_mfma_f32_32x32x16_bf16 v[32:47], v[52:55], v[96:99], v[32:47]
    s_add_u32 s37, s33, 16384
    s_add_u32 m0, s39, 0
    s_nop 0
    buffer_load_dwordx4 v3, s[8:11], s33 offen lds
    s_waitcnt lgkmcnt(8)
    v_mfma_f32_32x32x16_bf16 v[16:31], v[56:59], v[100:103], v[16:31]
    v_mfma_f32_32x32x16_bf16 v[32:47], v[60:63], v[100:103], v[32:47]
    s_add_u32 m0, s39, 1024
    s_nop 0
    buffer_load_dwordx4 v3, s[8:11], s37 offen lds
    s_add_u32 s33, s33, 131072
    s_waitcnt lgkmcnt(4)
    v_mfma_f32_32x32x16_bf16 v[16:31], v[64:67], v[104:107], v[16:31]
    v_mfma_f32_32x32x16_bf16 v[32:47], v[68:71], v[104:107], v[32:47]
    buffer_load_dwordx4 v[80:83], v2, s[12:15], s34 offen offset:0 sc1
    buffer_load_dwordx4 v[84:87], v2, s[12:15], s34 offen offset:1024 sc1
    s_waitcnt lgkmcnt(0)
    v_mfma_f32_32x32x16_bf16 v[16:31], v[72:75], v[108:111], v[16:31]
    v_mfma_f32_32x32x16_bf16 v[32:47], v[76:79], v[108:111], v[32:47]
    buffer_load_dwordx4 v[88:91], v2, s[12:15], s34 offen offset:2048 sc1
    buffer_load_dwordx4 v[92:95], v2, s[12:15], s34 offen offset:3072 sc1
    s_add_u32 s34, s34, 4096
    s_waitcnt vmcnt(12)
    s_barrier
    ds_read_b64_tr_b16 v[48:49], v4 offset:32768
    ds_read_b64_tr_b16 v[50:51], v4 offset:33280
    ds_read_b64_tr_b16 v[52:53], v4 offset:33024
    ds_read_b64_tr_b16 v[54:55], v4 offset:33536
    ds_read_b64_tr_b16 v[56:57], v4 offset:34816
    ds_read_b64_tr_b16 v[58:59], v4 offset:35328
    ds_read_b64_tr_b16 v[60:61], v4 offset:35072
    ds_read_b64_tr_b16 v[62:63], v4 offset:35584
    ds_read_b64_tr_b16 v[64:65], v4 offset:36864
    ds_read_b64_tr_b16 v[66:67], v4 offset:37376
    ds_read_b64_tr_b16 v[68:69], v4 offset:37120
    ds_read_b64_tr_b16 v[70:71], v4 offset:37632
    ds_read_b64_tr_b16 v[72:73], v4 offset:38912
    ds_read_b64_tr_b16 v[74:75], v4 offset:39424
    ds_read_b64_tr_b16 v[76:77], v4 offset:39168
    ds_read_b64_tr_b16 v[78:79], v4 offset:39680
    s_waitcnt lgkmcnt(12)
    v_mfma_f32_32x32x16_bf16 v[16:31], v[48:51], v[112:115], v[16:31]
    v_mfma_f32_32x32x16_bf16 v[32:47], v[52:55], v[112:115], v[32:47]
    s_add_u32 s37, s33, 16384
    s_add_u32 m0, s39, 16384
    s_nop 0
    buffer_load_dwordx4 v3, s[8:11], s33 offen lds
    s_waitcnt lgkmcnt(8)
    v_mfma_f32_32x32x16_bf16 v[16:31], v[56:59], v[116:119], v[16:31]
    v_mfma_f32_32x32x16_bf16 v[32:47], v[60:63], v[116:119], v[32:47]
    s_add_u32 m0, s39, 17408
    s_nop 0
    buffer_load_dwordx4 v3, s[8:11], s37 offen lds
    s_add_u32 s33, s33, 131072
    s_waitcnt lgkmcnt(4)
    v_mfma_f32_32x32x16_bf16 v[16:31], v[64:67], v[120:123], v[16:31]
    v_mfma_f32_32x32x16_bf16 v[32:47], v[68:71], v[120:123], v[32:47]
    buffer_load_dwordx4 v[96:99], v2, s[12:15], s34 offen offset:0 sc1
    buffer_load_dwordx4 v[100:103], v2, s[12:15], s34 offen offset:1024 sc1
    s_waitcnt lgkmcnt(0)
    v_mfma_f32_32x32x16_bf16 v[16:31], v[72:75], v[124:127], v[16:31]
    v_mfma_f32_32x32x16_bf16 v[32:47], v[76:79], v[124:127], v[32:47]
    buffer_load_dwordx4 v[104:107], v2, s[12:15], s34 offen offset:2048 sc1
    buffer_load_dwordx4 v[108:111], v2, s[12:15], s34 offen offset:3072 sc1
    s_add_u32 s34, s34, 4096
    s_waitcnt vmcnt(12)
    s_barrier
    ds_read_b64_tr_b16 v[48:49], v4 offset:49152
    ds_read_b64_tr_b16 v[50:51], v4 offset:49664
    ds_read_b64_tr_b16 v[52:53], v4 offset:49408
    ds_read_b64_tr_b16 v[54:55], v4 offset:49920
    ds_read_b64_tr_b16 v[56:57], v4 offset:51200
    ds_read_b64_tr_b16 v[58:59], v4 offset:51712
    ds_read_b64_tr_b16 v[60:61], v4 offset:51456
    ds_read_b64_tr_b16 v[62:63], v4 offset:51968
    ds_read_b64_tr_b16 v[64:65], v4 offset:53248
    ds_read_b64_tr_b16 v[66:67], v4 offset:53760
    ds_read_b64_tr_b16 v[68:69], v4 offset:53504
    ds_read_b64_tr_b16 v[70:71], v4 offset:54016
    ds_read_b64_tr_b16 v[72:73], v4 offset:55296
    ds_read_b64_tr_b16 v[74:75], v4 offset:55808
    ds_read_b64_tr_b16 v[76:77], v4 offset:55552
    ds_read_b64_tr_b16 v[78:79], v4 offset:56064
    s_waitcnt lgkmcnt(12)
    v_mfma_f32_32x32x16_bf16 v[16:31], v[48:51], v[128:131], v[16:31]
    v_mfma_f32_32x32x16_bf16 v[32:47], v[52:55], v[128:131], v[32:47]
    s_add_u32 s37, s33, 16384
    s_add_u32 m0, s39, 32768
    s_nop 0
    buffer_load_dwordx4 v3, s[8:11], s33 offen lds
    s_waitcnt lgkmcnt(8)
    v_mfma_f32_32x32x16_bf16 v[16:31], v[56:59], v[132:135], v[16:31]
    v_mfma_f32_32x32x16_bf16 v[32:47], v[60:63], v[132:135], v[32:47]
    s_add_u32 m0, s39, 33792
    s_nop 0
    buffer_load_dwordx4 v3, s[8:11], s37 offen lds
    s_add_u32 s33, s33, 131072
    s_waitcnt lgkmcnt(4)
    v_mfma_f32_32x32x16_bf16 v[16:31], v[64:67], v[136:139], v[16:31]
    v_mfma_f32_32x32x16_bf16 v[32:47], v[68:71], v[136:139], v[32:47]
    buffer_load_dwordx4 v[112:115], v2, s[12:15], s34 offen offset:0 sc1
    buffer_load_dwordx4 v[116:119], v2, s[12:15], s34 offen offset:1024 sc1
    s_waitcnt lgkmcnt(0)
    v_mfma_f32_32x32x16_bf16 v[16:31], v[72:75], v[140:143], v[16:31]
    v_mfma_f32_32x32x16_bf16 v[32:47], v[76:79], v[140:143], v[32:47]
    buffer_load_dwordx4 v[120:123], v2, s[12:15], s34 offen offset:2048 sc1
    buffer_load_dwordx4 v[124:127], v2, s[12:15], s34 offen offset:3072 sc1
    s_add_u32 s34, s34, 4096
    s_waitcnt vmcnt(12)
    s_barrier
    ds_read_b64_tr_b16 v[48:49], v4 offset:0
    ds_read_b64_tr_b16 v[50:51], v4 offset:512
    ds_read_b64_tr_b16 v[52:53], v4 offset:256
    ds_read_b64_tr_b16 v[54:55], v4 offset:768
    ds_read_b64_tr_b16 v[56:57], v4 offset:2048
    ds_read_b64_tr_b16 v[58:59], v4 offset:2560
    ds_read_b64_tr_b16 v[60:61], v4 offset:2304
    ds_read_b64_tr_b16 v[62:63], v4 offset:2816
    ds_read_b64_tr_b16 v[64:65], v4 offset:4096
    ds_read_b64_tr_b16 v[66:67], v4 offset:4608
    ds_read_b64_tr_b16 v[68:69], v4 offset:4352
    ds_read_b64_tr_b16 v[70:71], v4 offset:4864
    ds_read_b64_tr_b16 v[72:73], v4 offset:6144
    ds_read_b64_tr_b16 v[74:75], v4 offset:6656
    ds_read_b64_tr_b16 v[76:77], v4 offset:6400
    ds_read_b64_tr_b16 v[78:79], v4 offset:6912
    s_waitcnt lgkmcnt(12)
    v_mfma_f32_32x32x16_bf16 v[16:31], v[48:51], v[80:83], v[16:31]
    v_mfma_f32_32x32x16_bf16 v[32:47], v[52:55], v[80:83], v[32:47]
    s_add_u32 s37, s33, 16384
    s_add_u32 m0, s39, 49152
    s_nop 0
    buffer_load_dwordx4 v3, s[8:11], s33 offen lds
    v_mov_b32 v172, 128
    buffer_load_dword v172, v172, s[4:7], 0 offen sc1
    v_mov_b32 v173, 32
    buffer_load_dword v173, v173, s[4:7], 0 offen sc1
    s_waitcnt lgkmcnt(8)
    v_mfma_f32_32x32x16_bf16 v[16:31], v[56:59], v[84:87], v[16:31]
    v_mfma_f32_32x32x16_bf16 v[32:47], v[60:63], v[84:87], v[32:47]
    s_add_u32 m0, s39, 50176
    s_nop 0
    buffer_load_dwordx4 v3, s[8:11], s37 offen lds
    s_add_u32 s33, s33, 131072
    s_waitcnt lgkmcnt(4)
    v_mfma_f32_32x32x16_bf16 v[16:31], v[64:67], v[88:91], v[16:31]
    v_mfma_f32_32x32x16_bf16 v[32:47], v[68:71], v[88:91], v[32:47]
    buffer_load_dwordx4 v[128:131], v2, s[12:15], s34 offen offset:0 sc1
    buffer_load_dwordx4 v[132:135], v2, s[12:15], s34 offen offset:1024 sc1
    s_waitcnt lgkmcnt(0)
    v_mfma_f32_32x32x16_bf16 v[16:31], v[72:75], v[92:95], v[16:31]
    v_mfma_f32_32x32x16_bf16 v[32:47], v[76:79], v[92:95], v[32:47]
    buffer_load_dwordx4 v[136:139], v2, s[12:15], s34 offen offset:2048 sc1
    buffer_load_dwordx4 v[140:143], v2, s[12:15], s34 offen offset:3072 sc1
    s_add_u32 s34, s34, 4096
    s_waitcnt vmcnt(14)
    s_barrier
    ds_read_b64_tr_b16 v[48:49], v4 offset:16384
    ds_read_b64_tr_b16 v[50:51], v4 offset:16896
    ds_read_b64_tr_b16 v[52:53], v4 offset:16640
    ds_read_b64_tr_b16 v[54:55], v4 offset:17152
    ds_read_b64_tr_b16 v[56:57], v4 offset:18432
    ds_read_b64_tr_b16 v[58:59], v4 offset:18944
    ds_read_b64_tr_b16 v[60:61], v4 offset:18688
    ds_read_b64_tr_b16 v[62:63], v4 offset:19200
    ds_read_b64_tr_b16 v[64:65], v4 offset:20480
    ds_read_b64_tr_b16 v[66:67], v4 offset:20992
    ds_read_b64_tr_b16 v[68:69], v4 offset:20736
    ds_read_b64_tr_b16 v[70:71], v4 offset:21248
    ds_read_b64_tr_b16 v[72:73], v4 offset:22528
    ds_read_b64_tr_b16 v[74:75], v4 offset:23040
    ds_read_b64_tr_b16 v[76:77], v4 offset:22784
    ds_read_b64_tr_b16 v[78:79], v4 offset:23296
    s_waitcnt lgkmcnt(12)
    v_mfma_f32_32x32x16_bf16 v[16:31], v[48:51], v[96:99], v[16:31]
    v_mfma_f32_32x32x16_bf16 v[32:47], v[52:55], v[96:99], v[32:47]
    s_waitcnt lgkmcnt(8)
    v_mfma_f32_32x32x16_bf16 v[16:31], v[56:59], v[100:103], v[16:31]
    v_mfma_f32_32x32x16_bf16 v[32:47], v[60:63], v[100:103], v[32:47]
    s_waitcnt lgkmcnt(4)
    v_mfma_f32_32x32x16_bf16 v[16:31], v[64:67], v[104:107], v[16:31]
    v_mfma_f32_32x32x16_bf16 v[32:47], v[68:71], v[104:107], v[32:47]
    s_waitcnt lgkmcnt(0)
    v_mfma_f32_32x32x16_bf16 v[16:31], v[72:75], v[108:111], v[16:31]
    v_mfma_f32_32x32x16_bf16 v[32:47], v[76:79], v[108:111], v[32:47]
    s_waitcnt vmcnt(5)
    s_mov_b32 s57, 0
CCK11:
    s_mov_b32 s58, 1
    v_readfirstlane_b32 s59, v172
    s_nop 3
    s_cmp_ge_u32 s59, 128
    s_cselect_b32 s58, s58, 0
    v_readfirstlane_b32 s59, v173
    s_nop 3
    s_cmp_ge_u32 s59, 128
    s_cselect_b32 s58, s58, 0
    s_cmp_eq_u32 s58, 1
    s_cbranch_scc1 CCD11
    s_add_u32 s57, s57, 1
    s_cmp_gt_u32 s57, 400000
    s_cbranch_scc1 CCD11
    s_sleep 2
    v_mov_b32 v172, 128
    buffer_load_dword v172, v172, s[4:7], 0 offen sc1
    v_mov_b32 v173, 32
    buffer_load_dword v173, v173, s[4:7], 0 offen sc1
    s_waitcnt vmcnt(0)
    s_branch CCK11
CCD11:
    s_barrier
    ds_read_b64_tr_b16 v[48:49], v4 offset:32768
    ds_read_b64_tr_b16 v[50:51], v4 offset:33280
    ds_read_b64_tr_b16 v[52:53], v4 offset:33024
    ds_read_b64_tr_b16 v[54:55], v4 offset:33536
    ds_read_b64_tr_b16 v[56:57], v4 offset:34816
    ds_read_b64_tr_b16 v[58:59], v4 offset:35328
    ds_read_b64_tr_b16 v[60:61], v4 offset:35072
    ds_read_b64_tr_b16 v[62:63], v4 offset:35584
    ds_read_b64_tr_b16 v[64:65], v4 offset:36864
    ds_read_b64_tr_b16 v[66:67], v4 offset:37376
    ds_read_b64_tr_b16 v[68:69], v4 offset:37120
    ds_read_b64_tr_b16 v[70:71], v4 offset:37632
    ds_read_b64_tr_b16 v[72:73], v4 offset:38912
    ds_read_b64_tr_b16 v[74:75], v4 offset:39424
    ds_read_b64_tr_b16 v[76:77], v4 offset:39168
    ds_read_b64_tr_b16 v[78:79], v4 offset:39680
    s_waitcnt lgkmcnt(12)
    v_mfma_f32_32x32x16_bf16 v[16:31], v[48:51], v[112:115], v[16:31]
    v_mfma_f32_32x32x16_bf16 v[32:47], v[52:55], v[112:115], v[32:47]
    s_add_u32 m0, s42, 65536
    s_add_u32 s36, s42, 0
    buffer_load_dwordx4 v2, s[16:19], s36 offen offset:0 sc1 lds
    buffer_load_dwordx4 v2, s[16:19], s36 offen offset:1024 sc1 lds
    buffer_load_dwordx4 v2, s[16:19], s36 offen offset:2048 sc1 lds
    buffer_load_dwordx4 v2, s[16:19], s36 offen offset:3072 sc1 lds
    s_add_u32 m0, s42, 98304
    s_add_u32 s36, s42, 32768
    buffer_load_dwordx4 v2, s[16:19], s36 offen offset:0 sc1 lds
    buffer_load_dwordx4 v2, s[16:19], s36 offen offset:1024 sc1 lds
    buffer_load_dwordx4 v2, s[16:19], s36 offen offset:2048 sc1 lds
    buffer_load_dwordx4 v2, s[16:19], s36 offen offset:3072 sc1 lds
    s_waitcnt lgkmcnt(8)
    v_mfma_f32_32x32x16_bf16 v[16:31], v[56:59], v[116:119], v[16:31]
    v_mfma_f32_32x32x16_bf16 v[32:47], v[60:63], v[116:119], v[32:47]
    s_waitcnt lgkmcnt(4)
    v_mfma_f32_32x32x16_bf16 v[16:31], v[64:67], v[120:123], v[16:31]
    v_mfma_f32_32x32x16_bf16 v[32:47], v[68:71], v[120:123], v[32:47]
    s_waitcnt lgkmcnt(0)
    v_mfma_f32_32x32x16_bf16 v[16:31], v[72:75], v[124:127], v[16:31]
    v_mfma_f32_32x32x16_bf16 v[32:47], v[76:79], v[124:127], v[32:47]
    s_waitcnt vmcnt(8)
    s_barrier
    ds_read_b64_tr_b16 v[48:49], v4 offset:49152
    ds_read_b64_tr_b16 v[50:51], v4 offset:49664
    ds_read_b64_tr_b16 v[52:53], v4 offset:49408
    ds_read_b64_tr_b16 v[54:55], v4 offset:49920
    ds_read_b64_tr_b16 v[56:57], v4 offset:51200
    ds_read_b64_tr_b16 v[58:59], v4 offset:51712
    ds_read_b64_tr_b16 v[60:61], v4 offset:51456
    ds_read_b64_tr_b16 v[62:63], v4 offset:51968
    ds_read_b64_tr_b16 v[64:65], v4 offset:53248
    ds_read_b64_tr_b16 v[66:67], v4 offset:53760
    ds_read_b64_tr_b16 v[68:69], v4 offset:53504
    ds_read_b64_tr_b16 v[70:71], v4 offset:54016
    ds_read_b64_tr_b16 v[72:73], v4 offset:55296
    ds_read_b64_tr_b16 v[74:75], v4 offset:55808
    ds_read_b64_tr_b16 v[76:77], v4 offset:55552
    ds_read_b64_tr_b16 v[78:79], v4 offset:56064
    s_waitcnt lgkmcnt(12)
    v_mfma_f32_32x32x16_bf16 v[16:31], v[48:51], v[128:131], v[16:31]
    v_mfma_f32_32x32x16_bf16 v[32:47], v[52:55], v[128:131], v[32:47]
    s_waitcnt lgkmcnt(8)
    v_mfma_f32_32x32x16_bf16 v[16:31], v[56:59], v[132:135], v[16:31]
    v_mfma_f32_32x32x16_bf16 v[32:47], v[60:63], v[132:135], v[32:47]
    s_waitcnt lgkmcnt(4)
    v_mfma_f32_32x32x16_bf16 v[16:31], v[64:67], v[136:139], v[16:31]
    v_mfma_f32_32x32x16_bf16 v[32:47], v[68:71], v[136:139], v[32:47]
    s_waitcnt lgkmcnt(0)
    v_mfma_f32_32x32x16_bf16 v[16:31], v[72:75], v[140:143], v[16:31]
    v_mfma_f32_32x32x16_bf16 v[32:47], v[76:79], v[140:143], v[32:47]
    s_waitcnt vmcnt(0)
    s_barrier
    s_nop 15
    s_lshl_b32 s36, s31, 13
    s_add_u32 s36, s36, 0
    v_add_u32 v5, s36, v2
    s_cmp_eq_u32 s32, 0
    s_cbranch_scc0 P2G_X1
    ds_write_b128 v5, v[32:35] offset:4096
    ds_write_b128 v5, v[36:39] offset:5120
    ds_write_b128 v5, v[40:43] offset:6144
    ds_write_b128 v5, v[44:47] offset:7168
    s_branch P2G_X2
P2G_X1:
    ds_write_b128 v5, v[16:19] offset:0
    ds_write_b128 v5, v[20:23] offset:1024
    ds_write_b128 v5, v[24:27] offset:2048
    ds_write_b128 v5, v[28:31] offset:3072
    s_nop 1
    v_mov_b32 v16, v32
    v_mov_b32 v17, v33
    v_mov_b32 v18, v34
    v_mov_b32 v19, v35
    v_mov_b32 v20, v36
    v_mov_b32 v21, v37
    v_mov_b32 v22, v38
    v_mov_b32 v23, v39
    v_mov_b32 v24, v40
    v_mov_b32 v25, v41
    v_mov_b32 v26, v42
    v_mov_b32 v27, v43
    v_mov_b32 v28, v44
    v_mov_b32 v29, v45
    v_mov_b32 v30, v46
    v_mov_b32 v31, v47
P2G_X2:
    s_waitcnt lgkmcnt(0)
    s_barrier
    s_lshl_b32 s36, s32, 12
    v_add_u32 v5, s36, v5
    ds_read_b128 v[32:35], v5 offset:0
    ds_read_b128 v[36:39], v5 offset:1024
    ds_read_b128 v[40:43], v5 offset:2048
    ds_read_b128 v[44:47], v5 offset:3072
    s_waitcnt lgkmcnt(0)
    v_add_f32 v16, v16, v32
    v_add_f32 v17, v17, v33
    v_add_f32 v18, v18, v34
    v_add_f32 v19, v19, v35
    v_add_f32 v20, v20, v36
    v_add_f32 v21, v21, v37
    v_add_f32 v22, v22, v38
    v_add_f32 v23, v23, v39
    v_add_f32 v24, v24, v40
    v_add_f32 v25, v25, v41
    v_add_f32 v26, v26, v42
    v_add_f32 v27, v27, v43
    v_add_f32 v28, v28, v44
    v_add_f32 v29, v29, v45
    v_add_f32 v30, v30, v46
    v_add_f32 v31, v31, v47
    v_mul_f32 v16, 0x3e8293ee, v16
    v_mul_f32 v17, 0x3e8293ee, v17
    v_mul_f32 v18, 0x3e8293ee, v18
    v_mul_f32 v19, 0x3e8293ee, v19
    v_mul_f32 v20, 0x3e8293ee, v20
    v_mul_f32 v21, 0x3e8293ee, v21
    v_mul_f32 v22, 0x3e8293ee, v22
    v_mul_f32 v23, 0x3e8293ee, v23
    v_mul_f32 v24, 0x3e8293ee, v24
    v_mul_f32 v25, 0x3e8293ee, v25
    v_mul_f32 v26, 0x3e8293ee, v26
    v_mul_f32 v27, 0x3e8293ee, v27
    v_mul_f32 v28, 0x3e8293ee, v28
    v_mul_f32 v29, 0x3e8293ee, v29
    v_mul_f32 v30, 0x3e8293ee, v30
    v_mul_f32 v31, 0x3e8293ee, v31
    v_cvt_pk_bf16_f32 v48, v16, v17
    v_cvt_pk_bf16_f32 v49, v18, v19
    v_cvt_pk_bf16_f32 v50, v20, v21
    v_cvt_pk_bf16_f32 v51, v22, v23
    v_cvt_pk_bf16_f32 v52, v24, v25
    v_cvt_pk_bf16_f32 v53, v26, v27
    v_cvt_pk_bf16_f32 v54, v28, v29
    v_cvt_pk_bf16_f32 v55, v30, v31
    v_add_u32 v5, 65536, v2
    ds_read_b128 v[136:139], v5
    ds_read_b128 v[140:143], v5 offset:1024
    v_and_b32 v5, 3, v1
    v_bfe_u32 v6, v1, 2, 1
    v_bfe_u32 v7, v1, 4, 1
    v_xor_b32 v6, v6, v7
    v_or_b32 v5, v5, v6
    v_cmp_eq_u32 vcc, 0, v5
    v_mov_b32 v6, 0x3f803f80
    v_mov_b32 v5, 0
    s_mov_b32 s44, 0
    s_nop 0
    v_cndmask_b32 v132, v5, v6, vcc
    s_waitcnt lgkmcnt(0)
    v_mfma_f32_32x32x16_bf16 v[72:87], v[136:139], v[48:51], 0
    v_mfma_f32_32x32x16_bf16 v[72:87], v[140:143], v[52:55], v[72:87]
    v_mov_b32 v133, v132
    v_mov_b32 v134, v132
    v_mov_b32 v135, v132
    s_nop 12
    v_max3_f32 v7, v72, v73, v74
    v_max3_f32 v7, v7, v75, v76
    v_max3_f32 v7, v7, v77, v78
    v_max3_f32 v7, v7, v79, v80
    v_max3_f32 v7, v7, v81, v82
    v_max3_f32 v7, v7, v83, v84
    v_max3_f32 v7, v7, v85, v86
    v_max_f32 v7, v7, v87
K2_SETC:
    v_mov_b32 v8, v7
    v_add_u32 v5, 65536, v2
    v_add_u32 v6, 98304, v2
    v_permlane32_swap_b32 v7, v8
    ds_read_b128 v[136:139], v5
    ds_read_b128 v[140:143], v5 offset:1024
    ds_read_b128 v[144:147], v5 offset:4096
    ds_read_b128 v[148:151], v5 offset:5120
    ds_read_b128 v[152:155], v5 offset:2048
    ds_read_b128 v[156:159], v5 offset:3072
    v_max_f32 v7, v7, v8
    v_sub_f32 v7, 0, v7
    v_mov_b32 v56, v7
    v_mov_b32 v57, v7
    v_mov_b32 v58, v7
    v_mov_b32 v59, v7
    v_mov_b32 v60, v7
    v_mov_b32 v61, v7
    v_mov_b32 v62, v7
    v_mov_b32 v63, v7
    v_mov_b32 v64, v7
    v_mov_b32 v65, v7
    v_mov_b32 v66, v7
    v_mov_b32 v67, v7
    v_mov_b32 v68, v7
    v_mov_b32 v69, v7
    v_mov_b32 v70, v7
    v_mov_b32 v71, v7
    v_mov_b32 v112, 0
    v_mov_b32 v113, 0
    v_mov_b32 v114, 0
    v_mov_b32 v115, 0
    v_mov_b32 v116, 0
    v_mov_b32 v117, 0
    v_mov_b32 v118, 0
    v_mov_b32 v119, 0
    v_mov_b32 v120, 0
    v_mov_b32 v121, 0
    v_mov_b32 v122, 0
    v_mov_b32 v123, 0
    v_mov_b32 v124, 0
    v_mov_b32 v125, 0
    v_mov_b32 v126, 0
    v_mov_b32 v127, 0
    v_mov_b32 v128, 0
    v_mov_b32 v129, 0
    v_mov_b32 v130, 0
    v_mov_b32 v131, 0
    v_mov_b32 v108, 0
    v_mov_b32 v164, 0
    v_mov_b32 v109, 0
    v_mov_b32 v165, 0
    v_mov_b32 v110, 0
    v_mov_b32 v166, 0
    v_mov_b32 v111, 0
    v_mov_b32 v167, 0
    s_waitcnt lgkmcnt(0)
    v_mfma_f32_32x32x16_bf16 v[72:87], v[136:139], v[48:51], v[56:71]
    v_mfma_f32_32x32x16_bf16 v[72:87], v[140:143], v[52:55], v[72:87]
    s_mov_b32 s45, 0
    s_add_u32 s46, s42, 65536
    s_mov_b32 s47, 0
    s_mov_b32 s56, 65536
    s_mov_b32 s57, 98304
    s_nop 5
K2_LOOP:
    s_cmp_lt_u32 s45, 3
    s_cbranch_scc1 K2_W1
    s_waitcnt vmcnt(0)
K2_W1:
    s_waitcnt vmcnt(1)
    s_barrier
    s_add_u32 m0, s47, s42
    s_waitcnt lgkmcnt(0)
    v_mfma_f32_32x32x16_bf16 v[88:103], v[144:147], v[48:51], v[56:71]
    v_exp_f32 v72, v72
    v_exp_f32 v73, v73
    v_exp_f32 v74, v74
    v_mfma_f32_32x32x16_bf16 v[112:127], v[164:167], v[108:111], v[112:127]
    v_exp_f32 v75, v75
    v_exp_f32 v76, v76
    v_exp_f32 v77, v77
    v_mfma_f32_16x16x32_bf16 v[128:131], v[132:135], v[108:111], v[128:131]
    ds_read_b128 v[136:139], v5 offset:8192
    ds_read_b128 v[140:143], v5 offset:9216
    v_exp_f32 v78, v78
    v_exp_f32 v79, v79
    v_cvt_pk_bf16_f32 v104, v72, v73
    v_cvt_pk_bf16_f32 v105, v74, v75
    v_mfma_f32_32x32x16_bf16 v[88:103], v[148:151], v[52:55], v[88:103]
    ds_read_b128 v[160:163], v5 offset:6144
    ds_read_b128 v[164:167], v5 offset:7168
    v_cvt_pk_bf16_f32 v106, v76, v77
    v_cvt_pk_bf16_f32 v107, v78, v79
    v_exp_f32 v80, v80
    v_exp_f32 v81, v81
    v_mfma_f32_32x32x16_bf16 v[112:127], v[152:155], v[104:107], v[112:127]
    s_cmp_lt_u32 s45, 6
    s_cbranch_scc0 K2_ND0
    buffer_load_dwordx4 v2, s[16:19], s46 offen offset:0 sc1 lds
K2_ND0:
    v_exp_f32 v82, v82
    v_exp_f32 v83, v83
    v_exp_f32 v84, v84
    v_mfma_f32_16x16x32_bf16 v[128:131], v[132:135], v[104:107], v[128:131]
    v_exp_f32 v85, v85
    v_exp_f32 v86, v86
    v_exp_f32 v87, v87
    v_cvt_pk_bf16_f32 v108, v80, v81
    v_cvt_pk_bf16_f32 v109, v82, v83
    v_cvt_pk_bf16_f32 v110, v84, v85
    v_cvt_pk_bf16_f32 v111, v86, v87
    s_waitcnt lgkmcnt(0)
    v_mfma_f32_32x32x16_bf16 v[72:87], v[136:139], v[48:51], v[56:71]
    v_exp_f32 v88, v88
    v_exp_f32 v89, v89
    v_exp_f32 v90, v90
    v_mfma_f32_32x32x16_bf16 v[112:127], v[156:159], v[108:111], v[112:127]
    v_exp_f32 v91, v91
    v_exp_f32 v92, v92
    v_exp_f32 v93, v93
    v_mfma_f32_16x16x32_bf16 v[128:131], v[132:135], v[108:111], v[128:131]
    ds_read_b128 v[144:147], v5 offset:12288
    ds_read_b128 v[148:151], v5 offset:13312
    v_exp_f32 v94, v94
    v_exp_f32 v95, v95
    v_cvt_pk_bf16_f32 v104, v88, v89
    v_cvt_pk_bf16_f32 v105, v90, v91
    v_mfma_f32_32x32x16_bf16 v[72:87], v[140:143], v[52:55], v[72:87]
    ds_read_b128 v[152:155], v5 offset:10240
    ds_read_b128 v[156:159], v5 offset:11264
    v_cvt_pk_bf16_f32 v106, v92, v93
    v_cvt_pk_bf16_f32 v107, v94, v95
    v_exp_f32 v96, v96
    v_exp_f32 v97, v97
    v_mfma_f32_32x32x16_bf16 v[112:127], v[160:163], v[104:107], v[112:127]
    s_cmp_lt_u32 s45, 6
    s_cbranch_scc0 K2_ND1
    buffer_load_dwordx4 v2, s[16:19], s46 offen offset:1024 sc1 lds
K2_ND1:
    v_exp_f32 v98, v98
    v_exp_f32 v99, v99
    v_exp_f32 v100, v100
    v_mfma_f32_16x16x32_bf16 v[128:131], v[132:135], v[104:107], v[128:131]
    v_exp_f32 v101, v101
    v_exp_f32 v102, v102
    v_exp_f32 v103, v103
    v_cvt_pk_bf16_f32 v108, v96, v97
    v_cvt_pk_bf16_f32 v109, v98, v99
    v_cvt_pk_bf16_f32 v110, v100, v101
    v_cvt_pk_bf16_f32 v111, v102, v103
    s_waitcnt lgkmcnt(0)
    v_mfma_f32_32x32x16_bf16 v[88:103], v[144:147], v[48:51], v[56:71]
    v_exp_f32 v72, v72
    v_exp_f32 v73, v73
    v_exp_f32 v74, v74
    v_mfma_f32_32x32x16_bf16 v[112:127], v[164:167], v[108:111], v[112:127]
    v_exp_f32 v75, v75
    v_exp_f32 v76, v76
    v_exp_f32 v77, v77
    v_mfma_f32_16x16x32_bf16 v[128:131], v[132:135], v[108:111], v[128:131]
    ds_read_b128 v[136:139], v5 offset:16384
    ds_read_b128 v[140:143], v5 offset:17408
    v_exp_f32 v78, v78
    v_exp_f32 v79, v79
    v_cvt_pk_bf16_f32 v104, v72, v73
    v_cvt_pk_bf16_f32 v105, v74, v75
    v_mfma_f32_32x32x16_bf16 v[88:103], v[148:151], v[52:55], v[88:103]
    ds_read_b128 v[160:163], v5 offset:14336
    ds_read_b128 v[164:167], v5 offset:15360
    v_cvt_pk_bf16_f32 v106, v76, v77
    v_cvt_pk_bf16_f32 v107, v78, v79
    v_exp_f32 v80, v80
    v_exp_f32 v81, v81
    v_mfma_f32_32x32x16_bf16 v[112:127], v[152:155], v[104:107], v[112:127]
    s_cmp_lt_u32 s45, 6
    s_cbranch_scc0 K2_ND2
    buffer_load_dwordx4 v2, s[16:19], s46 offen offset:2048 sc1 lds
K2_ND2:
    v_exp_f32 v82, v82
    v_exp_f32 v83, v83
    v_exp_f32 v84, v84
    v_mfma_f32_16x16x32_bf16 v[128:131], v[132:135], v[104:107], v[128:131]
    v_exp_f32 v85, v85
    v_exp_f32 v86, v86
    v_exp_f32 v87, v87
    v_cvt_pk_bf16_f32 v108, v80, v81
    v_cvt_pk_bf16_f32 v109, v82, v83
    v_cvt_pk_bf16_f32 v110, v84, v85
    v_cvt_pk_bf16_f32 v111, v86, v87
    s_waitcnt lgkmcnt(0)
    v_mfma_f32_32x32x16_bf16 v[72:87], v[136:139], v[48:51], v[56:71]
    v_exp_f32 v88, v88
    v_exp_f32 v89, v89
    v_exp_f32 v90, v90
    v_mfma_f32_32x32x16_bf16 v[112:127], v[156:159], v[108:111], v[112:127]
    v_exp_f32 v91, v91
    v_exp_f32 v92, v92
    v_exp_f32 v93, v93
    v_mfma_f32_16x16x32_bf16 v[128:131], v[132:135], v[108:111], v[128:131]
    ds_read_b128 v[144:147], v5 offset:20480
    ds_read_b128 v[148:151], v5 offset:21504
    v_exp_f32 v94, v94
    v_exp_f32 v95, v95
    v_cvt_pk_bf16_f32 v104, v88, v89
    v_cvt_pk_bf16_f32 v105, v90, v91
    v_mfma_f32_32x32x16_bf16 v[72:87], v[140:143], v[52:55], v[72:87]
    ds_read_b128 v[152:155], v5 offset:18432
    ds_read_b128 v[156:159], v5 offset:19456
    v_cvt_pk_bf16_f32 v106, v92, v93
    v_cvt_pk_bf16_f32 v107, v94, v95
    v_exp_f32 v96, v96
    v_exp_f32 v97, v97
    v_mfma_f32_32x32x16_bf16 v[112:127], v[160:163], v[104:107], v[112:127]
    s_cmp_lt_u32 s45, 6
    s_cbranch_scc0 K2_ND3
    buffer_load_dwordx4 v2, s[16:19], s46 offen offset:3072 sc1 lds
K2_ND3:
    v_exp_f32 v98, v98
    v_exp_f32 v99, v99
    v_exp_f32 v100, v100
    v_mfma_f32_16x16x32_bf16 v[128:131], v[132:135], v[104:107], v[128:131]
    v_exp_f32 v101, v101
    v_exp_f32 v102, v102
    v_exp_f32 v103, v103
    v_cvt_pk_bf16_f32 v108, v96, v97
    v_cvt_pk_bf16_f32 v109, v98, v99
    v_cvt_pk_bf16_f32 v110, v100, v101
    v_cvt_pk_bf16_f32 v111, v102, v103
    s_waitcnt lgkmcnt(0)
    v_mfma_f32_32x32x16_bf16 v[88:103], v[144:147], v[48:51], v[56:71]
    v_exp_f32 v72, v72
    v_exp_f32 v73, v73
    v_exp_f32 v74, v74
    v_mfma_f32_32x32x16_bf16 v[112:127], v[164:167], v[108:111], v[112:127]
    v_exp_f32 v75, v75
    v_exp_f32 v76, v76
    v_exp_f32 v77, v77
    v_mfma_f32_16x16x32_bf16 v[128:131], v[132:135], v[108:111], v[128:131]
    ds_read_b128 v[136:139], v5 offset:24576
    ds_read_b128 v[140:143], v5 offset:25600
    v_exp_f32 v78, v78
    v_exp_f32 v79, v79
    v_cvt_pk_bf16_f32 v104, v72, v73
    v_cvt_pk_bf16_f32 v105, v74, v75
    v_mfma_f32_32x32x16_bf16 v[88:103], v[148:151], v[52:55], v[88:103]
    ds_read_b128 v[160:163], v5 offset:22528
    ds_read_b128 v[164:167], v5 offset:23552
    v_cvt_pk_bf16_f32 v106, v76, v77
    v_cvt_pk_bf16_f32 v107, v78, v79
    v_exp_f32 v80, v80
    v_exp_f32 v81, v81
    v_mfma_f32_32x32x16_bf16 v[112:127], v[152:155], v[104:107], v[112:127]
    v_exp_f32 v82, v82
    v_exp_f32 v83, v83
    v_exp_f32 v84, v84
    v_mfma_f32_16x16x32_bf16 v[128:131], v[132:135], v[104:107], v[128:131]
    v_exp_f32 v85, v85
    v_exp_f32 v86, v86
    v_exp_f32 v87, v87
    v_cvt_pk_bf16_f32 v108, v80, v81
    v_cvt_pk_bf16_f32 v109, v82, v83
    v_cvt_pk_bf16_f32 v110, v84, v85
    v_cvt_pk_bf16_f32 v111, v86, v87
    s_waitcnt lgkmcnt(0)
    v_mfma_f32_32x32x16_bf16 v[72:87], v[136:139], v[48:51], v[56:71]
    v_exp_f32 v88, v88
    v_exp_f32 v89, v89
    v_exp_f32 v90, v90
    v_mfma_f32_32x32x16_bf16 v[112:127], v[156:159], v[108:111], v[112:127]
    v_exp_f32 v91, v91
    v_exp_f32 v92, v92
    v_exp_f32 v93, v93
    v_mfma_f32_16x16x32_bf16 v[128:131], v[132:135], v[108:111], v[128:131]
    ds_read_b128 v[144:147], v5 offset:28672
    ds_read_b128 v[148:151], v5 offset:29696
    v_exp_f32 v94, v94
    v_exp_f32 v95, v95
    v_cvt_pk_bf16_f32 v104, v88, v89
    v_cvt_pk_bf16_f32 v105, v90, v91
    v_mfma_f32_32x32x16_bf16 v[72:87], v[140:143], v[52:55], v[72:87]
    ds_read_b128 v[152:155], v5 offset:26624
    ds_read_b128 v[156:159], v5 offset:27648
    v_cvt_pk_bf16_f32 v106, v92, v93
    v_cvt_pk_bf16_f32 v107, v94, v95
    v_exp_f32 v96, v96
    v_exp_f32 v97, v97
    v_mfma_f32_32x32x16_bf16 v[112:127], v[160:163], v[104:107], v[112:127]
    s_cmp_eq_u32 s45, 0
    s_cbranch_scc0 K2_PFA
    global_load_dword v170, v168, s[60:61]
K2_PFA:
    s_cmp_eq_u32 s45, 1
    s_cbranch_scc0 K2_PFB
    global_load_dword v170, v169, s[62:63]
K2_PFB:
    v_exp_f32 v98, v98
    v_exp_f32 v99, v99
    v_exp_f32 v100, v100
    v_mfma_f32_16x16x32_bf16 v[128:131], v[132:135], v[104:107], v[128:131]
    v_exp_f32 v101, v101
    v_exp_f32 v102, v102
    v_exp_f32 v103, v103
    v_cvt_pk_bf16_f32 v108, v96, v97
    v_cvt_pk_bf16_f32 v109, v98, v99
    v_cvt_pk_bf16_f32 v110, v100, v101
    v_cvt_pk_bf16_f32 v111, v102, v103
    s_waitcnt lgkmcnt(0)
    v_mfma_f32_32x32x16_bf16 v[88:103], v[144:147], v[48:51], v[56:71]
    v_exp_f32 v72, v72
    v_exp_f32 v73, v73
    v_exp_f32 v74, v74
    v_mfma_f32_32x32x16_bf16 v[112:127], v[164:167], v[108:111], v[112:127]
    v_exp_f32 v75, v75
    v_exp_f32 v76, v76
    v_exp_f32 v77, v77
    v_mfma_f32_16x16x32_bf16 v[128:131], v[132:135], v[108:111], v[128:131]
    ds_read_b128 v[136:139], v6 offset:0
    ds_read_b128 v[140:143], v6 offset:1024
    v_exp_f32 v78, v78
    v_exp_f32 v79, v79
    v_cvt_pk_bf16_f32 v104, v72, v73
    v_cvt_pk_bf16_f32 v105, v74, v75
    v_mfma_f32_32x32x16_bf16 v[88:103], v[148:151], v[52:55], v[88:103]
    ds_read_b128 v[160:163], v5 offset:30720
    ds_read_b128 v[164:167], v5 offset:31744
    v_cvt_pk_bf16_f32 v106, v76, v77
    v_cvt_pk_bf16_f32 v107, v78, v79
    v_exp_f32 v80, v80
    v_exp_f32 v81, v81
    v_mfma_f32_32x32x16_bf16 v[112:127], v[152:155], v[104:107], v[112:127]
    v_exp_f32 v82, v82
    v_exp_f32 v83, v83
    v_exp_f32 v84, v84
    v_mfma_f32_16x16x32_bf16 v[128:131], v[132:135], v[104:107], v[128:131]
    v_exp_f32 v85, v85
    v_exp_f32 v86, v86
    v_exp_f32 v87, v87
    v_cvt_pk_bf16_f32 v108, v80, v81
    v_cvt_pk_bf16_f32 v109, v82, v83
    v_cvt_pk_bf16_f32 v110, v84, v85
    v_cvt_pk_bf16_f32 v111, v86, v87
    s_waitcnt lgkmcnt(0)
    v_mfma_f32_32x32x16_bf16 v[72:87], v[136:139], v[48:51], v[56:71]
    v_exp_f32 v88, v88
    v_exp_f32 v89, v89
    v_exp_f32 v90, v90
    v_mfma_f32_32x32x16_bf16 v[112:127], v[156:159], v[108:111], v[112:127]
    v_exp_f32 v91, v91
    v_exp_f32 v92, v92
    v_exp_f32 v93, v93
    v_mfma_f32_16x16x32_bf16 v[128:131], v[132:135], v[108:111], v[128:131]
    ds_read_b128 v[144:147], v6 offset:4096
    ds_read_b128 v[148:151], v6 offset:5120
    v_exp_f32 v94, v94
    v_exp_f32 v95, v95
    v_cvt_pk_bf16_f32 v104, v88, v89
    v_cvt_pk_bf16_f32 v105, v90, v91
    v_mfma_f32_32x32x16_bf16 v[72:87], v[140:143], v[52:55], v[72:87]
    ds_read_b128 v[152:155], v6 offset:2048
    ds_read_b128 v[156:159], v6 offset:3072
    v_cvt_pk_bf16_f32 v106, v92, v93
    v_cvt_pk_bf16_f32 v107, v94, v95
    v_exp_f32 v96, v96
    v_exp_f32 v97, v97
    v_mfma_f32_32x32x16_bf16 v[112:127], v[160:163], v[104:107], v[112:127]
    v_exp_f32 v98, v98
    v_exp_f32 v99, v99
    v_exp_f32 v100, v100
    v_mfma_f32_16x16x32_bf16 v[128:131], v[132:135], v[104:107], v[128:131]
    v_exp_f32 v101, v101
    v_exp_f32 v102, v102
    v_exp_f32 v103, v103
    v_cvt_pk_bf16_f32 v108, v96, v97
    v_cvt_pk_bf16_f32 v109, v98, v99
    v_cvt_pk_bf16_f32 v110, v100, v101
    v_cvt_pk_bf16_f32 v111, v102, v103
    v_mov_b32 v5, v6
    v_add_u32 v6, s47, v2
    s_mov_b32 s36, s56
    s_mov_b32 s56, s57
    s_mov_b32 s57, s47
    s_mov_b32 s47, s36
    s_add_u32 s46, s46, 32768
    s_add_u32 s45, s45, 1
    s_cmp_lt_u32 s45, 8
    s_cbranch_scc1 K2_LOOP
    v_mfma_f32_32x32x16_bf16 v[112:127], v[164:167], v[108:111], v[112:127]
    v_mfma_f32_16x16x32_bf16 v[128:131], v[132:135], v[108:111], v[128:131]
    s_waitcnt vmcnt(0) lgkmcnt(0)
    s_nop 15
    v_mov_b32 v7, 0x71800000
    v_cmp_nlt_f32 vcc, v128, v7
    s_mov_b64 s[48:49], vcc
    v_mov_b32 v7, 0x207
    v_cmp_class_f32 vcc, v112, v7
    s_or_b64 s[48:49], s[48:49], vcc
    v_cmp_class_f32 vcc, v113, v7
    s_or_b64 s[48:49], s[48:49], vcc
    v_cmp_class_f32 vcc, v114, v7
    s_or_b64 s[48:49], s[48:49], vcc
    v_cmp_class_f32 vcc, v115, v7
    s_or_b64 s[48:49], s[48:49], vcc
    v_cmp_class_f32 vcc, v116, v7
    s_or_b64 s[48:49], s[48:49], vcc
    v_cmp_class_f32 vcc, v117, v7
    s_or_b64 s[48:49], s[48:49], vcc
    v_cmp_class_f32 vcc, v118, v7
    s_or_b64 s[48:49], s[48:49], vcc
    v_cmp_class_f32 vcc, v119, v7
    s_or_b64 s[48:49], s[48:49], vcc
    v_cmp_class_f32 vcc, v120, v7
    s_or_b64 s[48:49], s[48:49], vcc
    v_cmp_class_f32 vcc, v121, v7
    s_or_b64 s[48:49], s[48:49], vcc
    v_cmp_class_f32 vcc, v122, v7
    s_or_b64 s[48:49], s[48:49], vcc
    v_cmp_class_f32 vcc, v123, v7
    s_or_b64 s[48:49], s[48:49], vcc
    v_cmp_class_f32 vcc, v124, v7
    s_or_b64 s[48:49], s[48:49], vcc
    v_cmp_class_f32 vcc, v125, v7
    s_or_b64 s[48:49], s[48:49], vcc
    v_cmp_class_f32 vcc, v126, v7
    s_or_b64 s[48:49], s[48:49], vcc
    v_cmp_class_f32 vcc, v127, v7
    s_or_b64 s[48:49], s[48:49], vcc
    v_rcp_f32 v7, v128
    s_cmp_eq_u64 s[48:49], 0
    s_cbranch_scc1 K2_NOFLAG
    v_mov_b32 v9, 131072
    v_mov_b32 v8, 1
    ds_write_b32 v9, v8
K2_NOFLAG:
    v_mul_f32 v112, v112, v7
    v_mul_f32 v113, v113, v7
    v_mul_f32 v114, v114, v7
    v_mul_f32 v115, v115, v7
    v_mul_f32 v116, v116, v7
    v_mul_f32 v117, v117, v7
    v_mul_f32 v118, v118, v7
    v_mul_f32 v119, v119, v7
    v_mul_f32 v120, v120, v7
    v_mul_f32 v121, v121, v7
    v_mul_f32 v122, v122, v7
    v_mul_f32 v123, v123, v7
    v_mul_f32 v124, v124, v7
    v_mul_f32 v125, v125, v7
    v_mul_f32 v126, v126, v7
    v_mul_f32 v127, v127, v7
    v_cvt_pk_bf16_f32 v104, v112, v113
    v_cvt_pk_bf16_f32 v105, v114, v115
    v_cvt_pk_bf16_f32 v106, v116, v117
    v_cvt_pk_bf16_f32 v107, v118, v119
    v_cvt_pk_bf16_f32 v108, v120, v121
    v_cvt_pk_bf16_f32 v109, v122, v123
    v_cvt_pk_bf16_f32 v110, v124, v125
    v_cvt_pk_bf16_f32 v111, v126, v127
    s_lshl_b32 s36, s28, 2
    s_add_u32 s36, s36, s31
    s_lshl_b32 s36, s36, 6
    s_lshl_b32 s37, s29, 2
    s_add_u32 s36, s36, s37
    s_lshl_b32 s37, s32, 1
    s_add_u32 s36, s36, s37
    s_lshl_b32 s36, s36, 10
    buffer_store_dwordx4 v[104:107], v2, s[24:27], s36 offen sc1
    buffer_store_dwordx4 v[108:111], v2, s[24:27], s36 offen offset:1024 sc1
    s_mov_b32 s48, s76
    s_mov_b32 s49, s77
    s_mov_b32 s50, 0x700000
    s_mov_b32 s51, 0x00020000
    s_mov_b32 s52, s20
    s_mov_b32 s53, s21
    s_mov_b32 s54, 0x18000
    s_mov_b32 s55, 0x00020000
    s_lshr_b32 s58, s2, 1
    s_and_b32 s59, s2, 1
    s_lshl_b32 s36, s59, 9
    s_lshl_b32 s37, s30, 6
    s_add_u32 s36, s36, s37
    s_mul_i32 s37, s36, 7168
    s_lshl_b32 s38, s58, 6
    s_add_u32 s37, s37, s38
    s_cmp_lt_u32 s2, 224
    s_cselect_b32 s37, s37, 0x7f000000
    v_lshrrev_b32 v8, 2, v1
    v_mul_u32_u24 v8, 7168, v8
    v_and_b32 v9, 3, v1
    v_lshl_add_u32 v8, v9, 4, v8
    s_lshl_b32 s38, s30, 12
    s_add_u32 s38, s38, 65536
    s_add_u32 m0, s38, 0
    s_nop 0
    buffer_load_dwordx4 v8, s[48:51], s37 offen lds
    s_add_u32 s37, s37, 114688
    s_add_u32 m0, s38, 1024
    s_nop 0
    buffer_load_dwordx4 v8, s[48:51], s37 offen lds
    s_add_u32 s37, s37, 114688
    s_add_u32 m0, s38, 2048
    s_nop 0
    buffer_load_dwordx4 v8, s[48:51], s37 offen lds
    s_add_u32 s37, s37, 114688
    s_add_u32 m0, s38, 3072
    s_nop 0
    buffer_load_dwordx4 v8, s[48:51], s37 offen lds
    s_add_u32 s37, s37, 114688
    v_and_b32 v9, 15, v1
    v_lshlrev_b32 v9, 4, v9
    v_bfe_u32 v10, v1, 4, 1
    v_lshl_add_u32 v9, v10, 12, v9
    s_lshl_b32 s36, s36, 2
    s_add_u32 s36, s36, 8192
    s_add_u32 s37, s36, 0
    buffer_load_dwordx4 v[176:179], v9, s[52:55], s37 offen sc1
    s_add_u32 s37, s36, 16384
    buffer_load_dwordx4 v[180:183], v9, s[52:55], s37 offen sc1
    s_add_u32 s37, s36, 32768
    buffer_load_dwordx4 v[184:187], v9, s[52:55], s37 offen sc1
    s_add_u32 s37, s36, 49152
    buffer_load_dwordx4 v[188:191], v9, s[52:55], s37 offen sc1
    s_mov_b32 s8, s72
    s_mov_b32 s9, s73
    s_mov_b32 s10, 0x200000
    s_mov_b32 s11, 0x00020000
    s_add_u32 s12, s20, 0x500000
    s_addc_u32 s13, s21, 0
    s_mov_b32 s14, 0x400000
    s_mov_b32 s15, 0x00020000
    v_lshrrev_b32 v5, 5, v1
    v_bfe_u32 v6, v1, 2, 2
    v_lshl_add_u32 v5, v5, 2, v6
    v_mul_u32_u24 v3, 2048, v5
    v_bfe_u32 v5, v1, 4, 1
    v_lshl_add_u32 v3, v5, 6, v3
    v_and_b32 v7, 3, v1
    v_lshl_add_u32 v3, v7, 4, v3
    v_lshlrev_b32 v4, 6, v6
    v_lshl_add_u32 v4, v5, 5, v4
    v_lshl_add_u32 v4, v7, 3, v4
    v_lshrrev_b32 v5, 5, v1
    v_lshl_add_u32 v4, v5, 9, v4
    s_lshl_b32 s36, s32, 13
    v_add_u32 v4, s36, v4
    s_mul_i32 s33, s32, 512
    s_lshl_b32 s36, s31, 4
    s_add_u32 s33, s33, s36
    s_mul_i32 s33, s33, 2048
    s_lshl_b32 s36, s29, 7
    s_add_u32 s33, s33, s36
    s_lshl_b32 s34, s28, 2
    s_add_u32 s34, s34, s31
    s_mul_i32 s34, s34, 64
    s_mul_i32 s36, s32, 32
    s_add_u32 s34, s34, s36
    s_lshl_b32 s34, s34, 10
    s_lshl_b32 s39, s32, 13
    s_lshl_b32 s36, s31, 11
    s_add_u32 s39, s39, s36
    s_add_u32 s37, s33, 16384
    s_add_u32 m0, s39, 0
    s_nop 0
    buffer_load_dwordx4 v3, s[8:11], s33 offen lds
    s_add_u32 m0, s39, 1024
    s_nop 0
    buffer_load_dwordx4 v3, s[8:11], s37 offen lds
    s_add_u32 s33, s33, 131072
    s_add_u32 s37, s33, 16384
    s_add_u32 m0, s39, 16384
    s_nop 0
    buffer_load_dwordx4 v3, s[8:11], s33 offen lds
    s_add_u32 m0, s39, 17408
    s_nop 0
    buffer_load_dwordx4 v3, s[8:11], s37 offen lds
    s_add_u32 s33, s33, 131072
    s_add_u32 s37, s33, 16384
    s_add_u32 m0, s39, 32768
    s_nop 0
    buffer_load_dwordx4 v3, s[8:11], s33 offen lds
    s_add_u32 m0, s39, 33792
    s_nop 0
    buffer_load_dwordx4 v3, s[8:11], s37 offen lds
    s_add_u32 s33, s33, 131072
    s_waitcnt vmcnt(14) lgkmcnt(0)
    s_barrier
    s_cmp_lg_u32 s44, 0
    s_cbranch_scc1 K2_FINISH
    v_mov_b32 v9, 131072
    ds_read_b32 v8, v9
    s_waitcnt lgkmcnt(0)
    v_readfirstlane_b32 s36, v8
    s_nop 3
    s_cmp_eq_u32 s36, 0
    s_cbranch_scc1 K2_FINISH
    s_waitcnt vmcnt(0)
    s_mov_b32 s44, 1
    s_lshl_b32 s42, s30, 12
    v_mov_b32 v7, 0xff800000
    s_mov_b32 s45, 0
    v_add_u32 v5, 65536, v2
K2_MAXL:
    s_barrier
    s_lshl_b32 s36, s45, 15
    s_add_u32 s36, s36, s42
    s_add_u32 m0, s42, 65536
    s_nop 0
    buffer_load_dwordx4 v2, s[16:19], s36 offen offset:0 sc1 lds
    buffer_load_dwordx4 v2, s[16:19], s36 offen offset:1024 sc1 lds
    buffer_load_dwordx4 v2, s[16:19], s36 offen offset:2048 sc1 lds
    buffer_load_dwordx4 v2, s[16:19], s36 offen offset:3072 sc1 lds
    s_waitcnt vmcnt(0)
    s_barrier
    ds_read_b128 v[136:139], v5 offset:0
    ds_read_b128 v[140:143], v5 offset:1024
    s_waitcnt lgkmcnt(0)
    v_mfma_f32_32x32x16_bf16 v[72:87], v[136:139], v[48:51], 0
    v_mfma_f32_32x32x16_bf16 v[72:87], v[140:143], v[52:55], v[72:87]
    s_nop 15
    v_max3_f32 v7, v7, v72, v73
    v_max3_f32 v7, v7, v74, v75
    v_max3_f32 v7, v7, v76, v77
    v_max3_f32 v7, v7, v78, v79
    v_max3_f32 v7, v7, v80, v81
    v_max3_f32 v7, v7, v82, v83
    v_max3_f32 v7, v7, v84, v85
    v_max3_f32 v7, v7, v86, v87
    ds_read_b128 v[136:139], v5 offset:4096
    ds_read_b128 v[140:143], v5 offset:5120
    s_waitcnt lgkmcnt(0)
    v_mfma_f32_32x32x16_bf16 v[72:87], v[136:139], v[48:51], 0
    v_mfma_f32_32x32x16_bf16 v[72:87], v[140:143], v[52:55], v[72:87]
    s_nop 15
    v_max3_f32 v7, v7, v72, v73
    v_max3_f32 v7, v7, v74, v75
    v_max3_f32 v7, v7, v76, v77
    v_max3_f32 v7, v7, v78, v79
    v_max3_f32 v7, v7, v80, v81
    v_max3_f32 v7, v7, v82, v83
    v_max3_f32 v7, v7, v84, v85
    v_max3_f32 v7, v7, v86, v87
    ds_read_b128 v[136:139], v5 offset:8192
    ds_read_b128 v[140:143], v5 offset:9216
    s_waitcnt lgkmcnt(0)
    v_mfma_f32_32x32x16_bf16 v[72:87], v[136:139], v[48:51], 0
    v_mfma_f32_32x32x16_bf16 v[72:87], v[140:143], v[52:55], v[72:87]
    s_nop 15
    v_max3_f32 v7, v7, v72, v73
    v_max3_f32 v7, v7, v74, v75
    v_max3_f32 v7, v7, v76, v77
    v_max3_f32 v7, v7, v78, v79
    v_max3_f32 v7, v7, v80, v81
    v_max3_f32 v7, v7, v82, v83
    v_max3_f32 v7, v7, v84, v85
    v_max3_f32 v7, v7, v86, v87
    ds_read_b128 v[136:139], v5 offset:12288
    ds_read_b128 v[140:143], v5 offset:13312
    s_waitcnt lgkmcnt(0)
    v_mfma_f32_32x32x16_bf16 v[72:87], v[136:139], v[48:51], 0
    v_mfma_f32_32x32x16_bf16 v[72:87], v[140:143], v[52:55], v[72:87]
    s_nop 15
    v_max3_f32 v7, v7, v72, v73
    v_max3_f32 v7, v7, v74, v75
    v_max3_f32 v7, v7, v76, v77
    v_max3_f32 v7, v7, v78, v79
    v_max3_f32 v7, v7, v80, v81
    v_max3_f32 v7, v7, v82, v83
    v_max3_f32 v7, v7, v84, v85
    v_max3_f32 v7, v7, v86, v87
    ds_read_b128 v[136:139], v5 offset:16384
    ds_read_b128 v[140:143], v5 offset:17408
    s_waitcnt lgkmcnt(0)
    v_mfma_f32_32x32x16_bf16 v[72:87], v[136:139], v[48:51], 0
    v_mfma_f32_32x32x16_bf16 v[72:87], v[140:143], v[52:55], v[72:87]
    s_nop 15
    v_max3_f32 v7, v7, v72, v73
    v_max3_f32 v7, v7, v74, v75
    v_max3_f32 v7, v7, v76, v77
    v_max3_f32 v7, v7, v78, v79
    v_max3_f32 v7, v7, v80, v81
    v_max3_f32 v7, v7, v82, v83
    v_max3_f32 v7, v7, v84, v85
    v_max3_f32 v7, v7, v86, v87
    ds_read_b128 v[136:139], v5 offset:20480
    ds_read_b128 v[140:143], v5 offset:21504
    s_waitcnt lgkmcnt(0)
    v_mfma_f32_32x32x16_bf16 v[72:87], v[136:139], v[48:51], 0
    v_mfma_f32_32x32x16_bf16 v[72:87], v[140:143], v[52:55], v[72:87]
    s_nop 15
    v_max3_f32 v7, v7, v72, v73
    v_max3_f32 v7, v7, v74, v75
    v_max3_f32 v7, v7, v76, v77
    v_max3_f32 v7, v7, v78, v79
    v_max3_f32 v7, v7, v80, v81
    v_max3_f32 v7, v7, v82, v83
    v_max3_f32 v7, v7, v84, v85
    v_max3_f32 v7, v7, v86, v87
    ds_read_b128 v[136:139], v5 offset:24576
    ds_read_b128 v[140:143], v5 offset:25600
    s_waitcnt lgkmcnt(0)
    v_mfma_f32_32x32x16_bf16 v[72:87], v[136:139], v[48:51], 0
    v_mfma_f32_32x32x16_bf16 v[72:87], v[140:143], v[52:55], v[72:87]
    s_nop 15
    v_max3_f32 v7, v7, v72, v73
    v_max3_f32 v7, v7, v74, v75
    v_max3_f32 v7, v7, v76, v77
    v_max3_f32 v7, v7, v78, v79
    v_max3_f32 v7, v7, v80, v81
    v_max3_f32 v7, v7, v82, v83
    v_max3_f32 v7, v7, v84, v85
    v_max3_f32 v7, v7, v86, v87
    ds_read_b128 v[136:139], v5 offset:28672
    ds_read_b128 v[140:143], v5 offset:29696
    s_waitcnt lgkmcnt(0)
    v_mfma_f32_32x32x16_bf16 v[72:87], v[136:139], v[48:51], 0
    v_mfma_f32_32x32x16_bf16 v[72:87], v[140:143], v[52:55], v[72:87]
    s_nop 15
    v_max3_f32 v7, v7, v72, v73
    v_max3_f32 v7, v7, v74, v75
    v_max3_f32 v7, v7, v76, v77
    v_max3_f32 v7, v7, v78, v79
    v_max3_f32 v7, v7, v80, v81
    v_max3_f32 v7, v7, v82, v83
    v_max3_f32 v7, v7, v84, v85
    v_max3_f32 v7, v7, v86, v87
    s_add_u32 s45, s45, 1
    s_cmp_lt_u32 s45, 8
    s_cbranch_scc1 K2_MAXL
    s_barrier
    s_add_u32 m0, s42, 65536
    s_add_u32 s36, s42, 0
    buffer_load_dwordx4 v2, s[16:19], s36 offen offset:0 sc1 lds
    buffer_load_dwordx4 v2, s[16:19], s36 offen offset:1024 sc1 lds
    buffer_load_dwordx4 v2, s[16:19], s36 offen offset:2048 sc1 lds
    buffer_load_dwordx4 v2, s[16:19], s36 offen offset:3072 sc1 lds
    s_add_u32 m0, s42, 98304
    s_add_u32 s36, s42, 32768
    buffer_load_dwordx4 v2, s[16:19], s36 offen offset:0 sc1 lds
    buffer_load_dwordx4 v2, s[16:19], s36 offen offset:1024 sc1 lds
    buffer_load_dwordx4 v2, s[16:19], s36 offen offset:2048 sc1 lds
    buffer_load_dwordx4 v2, s[16:19], s36 offen offset:3072 sc1 lds
    s_waitcnt vmcnt(0)
    s_barrier
    s_branch K2_SETC
K2_FINISH:
    s_lshl_b32 s56, s28, 4
    s_add_u32 s56, s56, s29
    s_cmp_eq_u32 s30, 0
    s_cbranch_scc0 SIG12
    s_lshl_b32 s36, s56, 7
    s_add_u32 s36, s36, 73728
    v_mov_b32 v250, s100
    v_mov_b32 v251, 0
    v_cmp_eq_u32 vcc, 0, v1
    s_and_saveexec_b64 s[54:55], vcc
    buffer_store_dword v250, v251, s[96:99], s36 offen sc1
    s_mov_b64 exec, s[54:55]
SIG12:
    s_cmp_eq_u32 s30, 7
    s_cbranch_scc0 P3W13
    s_mov_b32 s4, s94
    s_mov_b32 s5, s95
    s_mov_b32 s6, 256
    s_mov_b32 s7, 0x00020000
    v_mov_b32 v249, 160
    buffer_load_dword v249, v249, s[4:7], 0 offen sc1
    s_lshl_b32 s56, s28, 11
    s_add_u32 s56, s56, 73728
    s_mov_b32 s57, 0
POLL14:
    v_min_u32 v248, 15, v1
    v_lshlrev_b32 v248, 7, v248
    buffer_load_dword v248, v248, s[96:99], s56 offen sc1
    s_waitcnt vmcnt(0)
    s_mov_b64 s[58:59], -1
    v_cmp_eq_u32 vcc, s100, v248
    s_and_b64 s[58:59], s[58:59], vcc
    s_cmp_eq_u64 s[58:59], -1
    s_cbranch_scc1 POLLD14
    s_add_u32 s57, s57, 1
    s_cmp_gt_u32 s57, 400000
    s_cbranch_scc1 POLLD14
    s_sleep 1
    s_branch POLL14
POLLD14:
    s_mov_b32 s57, 0
CCK15:
    s_mov_b32 s58, 1
    v_readfirstlane_b32 s59, v249
    s_nop 3
    s_cmp_ge_u32 s59, 128
    s_cselect_b32 s58, s58, 0
    s_cmp_eq_u32 s58, 1
    s_cbranch_scc1 CCD15
    s_add_u32 s57, s57, 1
    s_cmp_gt_u32 s57, 400000
    s_cbranch_scc1 CCD15
    s_sleep 2
    v_mov_b32 v249, 160
    buffer_load_dword v249, v249, s[4:7], 0 offen sc1
    s_waitcnt vmcnt(0)
    s_branch CCK15
CCD15:
P3W13:
    s_mov_b32 s16, s64
    s_mov_b32 s17, s65
    s_mov_b32 s18, 0x400000
    s_mov_b32 s19, 0x00020000
    s_mov_b32 s44, s20
    s_mov_b32 s45, s21
    s_mov_b32 s46, 0x18000
    s_mov_b32 s47, 0x00020000
    s_add_u32 s48, s20, 0xd00000
    s_addc_u32 s49, s21, 0
    s_mov_b32 s50, 0x400000
    s_mov_b32 s51, 0x00020000
    s_add_u32 s24, s20, 0x2300000
    s_addc_u32 s25, s21, 0
    s_mov_b32 s26, 0x10000
    s_mov_b32 s27, 0x00020000
    s_barrier
    buffer_load_dwordx4 v[80:83], v2, s[12:15], s34 offen offset:0 sc1
    buffer_load_dwordx4 v[84:87], v2, s[12:15], s34 offen offset:1024 sc1
    buffer_load_dwordx4 v[88:91], v2, s[12:15], s34 offen offset:2048 sc1
    buffer_load_dwordx4 v[92:95], v2, s[12:15], s34 offen offset:3072 sc1
    s_add_u32 s34, s34, 4096
    buffer_load_dwordx4 v[96:99], v2, s[12:15], s34 offen offset:0 sc1
    buffer_load_dwordx4 v[100:103], v2, s[12:15], s34 offen offset:1024 sc1
    buffer_load_dwordx4 v[104:107], v2, s[12:15], s34 offen offset:2048 sc1
    buffer_load_dwordx4 v[108:111], v2, s[12:15], s34 offen offset:3072 sc1
    s_add_u32 s34, s34, 4096
    buffer_load_dwordx4 v[112:115], v2, s[12:15], s34 offen offset:0 sc1
    buffer_load_dwordx4 v[116:119], v2, s[12:15], s34 offen offset:1024 sc1
    buffer_load_dwordx4 v[120:123], v2, s[12:15], s34 offen offset:2048 sc1
    buffer_load_dwordx4 v[124:127], v2, s[12:15], s34 offen offset:3072 sc1
    s_add_u32 s34, s34, 4096
    v_mov_b32 v16, 0
    v_mov_b32 v17, 0
    v_mov_b32 v18, 0
    v_mov_b32 v19, 0
    v_mov_b32 v20, 0
    v_mov_b32 v21, 0
    v_mov_b32 v22, 0
    v_mov_b32 v23, 0
    v_mov_b32 v24, 0
    v_mov_b32 v25, 0
    v_mov_b32 v26, 0
    v_mov_b32 v27, 0
    v_mov_b32 v28, 0
    v_mov_b32 v29, 0
    v_mov_b32 v30, 0
    v_mov_b32 v31, 0
    v_mov_b32 v32, 0
    v_mov_b32 v33, 0
    v_mov_b32 v34, 0
    v_mov_b32 v35, 0
    v_mov_b32 v36, 0
    v_mov_b32 v37, 0
    v_mov_b32 v38, 0
    v_mov_b32 v39, 0
    v_mov_b32 v40, 0
    v_mov_b32 v41, 0
    v_mov_b32 v42, 0
    v_mov_b32 v43, 0
    v_mov_b32 v44, 0
    v_mov_b32 v45, 0
    v_mov_b32 v46, 0
    v_mov_b32 v47, 0
    s_waitcnt vmcnt(12)
    s_add_u32 s40, s20, 0x28000
    s_addc_u32 s41, s21, 0
    s_mov_b32 s42, 0x15080
    s_mov_b32 s43, 0x00020000
    s_lshr_b32 s60, s2, 1
    s_and_b32 s61, s2, 1
    v_add_f32 v176, v176, v180
    v_add_f32 v177, v177, v181
    v_add_f32 v178, v178, v182
    v_add_f32 v179, v179, v183
    v_add_f32 v184, v184, v188
    v_add_f32 v185, v185, v189
    v_add_f32 v186, v186, v190
    v_add_f32 v187, v187, v191
    v_add_f32 v176, v176, v184
    v_add_f32 v177, v177, v185
    v_add_f32 v178, v178, v186
    v_add_f32 v179, v179, v187
    v_cvt_pk_bf16_f32 v180, v176, v177
    v_lshlrev_b32 v176, 16, v180
    v_and_b32 v177, 0xffff0000, v180
    v_cvt_pk_bf16_f32 v180, v178, v179
    v_lshlrev_b32 v178, 16, v180
    v_and_b32 v179, 0xffff0000, v180
    v_bfe_u32 v10, v1, 4, 1
    v_cvt_f32_u32 v180, v10
    v_add_f32 v176, v180, v176
    v_add_f32 v177, v180, v177
    v_add_f32 v178, v180, v178
    v_add_f32 v179, v180, v179
    v_cvt_pk_bf16_f32 v176, v176, v177
    v_cvt_pk_bf16_f32 v177, v178, v179
    v_xor_b32 v10, 1, v10
    v_lshlrev_b32 v10, 7, v10
    v_and_b32 v9, 15, v1
    v_lshl_add_u32 v10, v9, 3, v10
    s_lshl_b32 s36, s30, 8
    s_add_u32 s36, s36, 98304
    v_add_u32 v10, s36, v10
    ds_write_b64 v10, v[176:177]
    v_and_b32 v9, 31, v1
    v_lshrrev_b32 v11, 5, v1
    v_min_u32 v10, 1, v9
    v_lshlrev_b32 v10, 7, v10
    v_lshl_add_u32 v10, v11, 4, v10
    v_add_u32 v10, s36, v10
    v_bfe_u32 v8, v1, 2, 2
    v_lshlrev_b32 v8, 6, v8
    v_bfe_u32 v12, v1, 4, 1
    v_lshl_add_u32 v8, v12, 5, v8
    v_and_b32 v12, 3, v1
    v_lshl_add_u32 v8, v12, 3, v8
    v_lshl_add_u32 v8, v11, 9, v8
    s_lshl_b32 s37, s30, 12
    s_add_u32 s37, s37, 65536
    v_add_u32 v8, s37, v8
    v_cmp_eq_u32 vcc, 2, v9
    v_cmp_lt_u32 s[62:63], v9, 2
    v_mov_b32 v12, 0x3f803f80
    v_mov_b32 v13, 0
    s_waitcnt lgkmcnt(0)
    ds_read_b128 v[176:179], v10 offset:0
    ds_read_b128 v[180:183], v10 offset:32
    ds_read_b128 v[184:187], v10 offset:64
    ds_read_b128 v[188:191], v10 offset:96
    ds_read_b64_tr_b16 v[192:193], v8 offset:0
    ds_read_b64_tr_b16 v[194:195], v8 offset:256
    ds_read_b64_tr_b16 v[196:197], v8 offset:1024
    ds_read_b64_tr_b16 v[198:199], v8 offset:1280
    ds_read_b64_tr_b16 v[200:201], v8 offset:2048
    ds_read_b64_tr_b16 v[202:203], v8 offset:2304
    ds_read_b64_tr_b16 v[204:205], v8 offset:3072
    ds_read_b64_tr_b16 v[206:207], v8 offset:3328
    v_cndmask_b32 v12, v13, v12, vcc
    s_waitcnt lgkmcnt(0)
    v_cndmask_b32 v176, v12, v176, s[62:63]
    v_cndmask_b32 v177, v12, v177, s[62:63]
    v_cndmask_b32 v178, v12, v178, s[62:63]
    v_cndmask_b32 v179, v12, v179, s[62:63]
    v_cndmask_b32 v180, v12, v180, s[62:63]
    v_cndmask_b32 v181, v12, v181, s[62:63]
    v_cndmask_b32 v182, v12, v182, s[62:63]
    v_cndmask_b32 v183, v12, v183, s[62:63]
    v_cndmask_b32 v184, v12, v184, s[62:63]
    v_cndmask_b32 v185, v12, v185, s[62:63]
    v_cndmask_b32 v186, v12, v186, s[62:63]
    v_cndmask_b32 v187, v12, v187, s[62:63]
    v_cndmask_b32 v188, v12, v188, s[62:63]
    v_cndmask_b32 v189, v12, v189, s[62:63]
    v_cndmask_b32 v190, v12, v190, s[62:63]
    v_cndmask_b32 v191, v12, v191, s[62:63]
    s_nop 1
    v_mfma_f32_32x32x16_bf16 v[208:223], v[192:195], v[176:179], 0
    v_mfma_f32_32x32x16_bf16 v[224:239], v[176:179], v[176:179], 0
    v_mfma_f32_32x32x16_bf16 v[208:223], v[196:199], v[180:183], v[208:223]
    v_mfma_f32_32x32x16_bf16 v[224:239], v[180:183], v[180:183], v[224:239]
    v_mfma_f32_32x32x16_bf16 v[208:223], v[200:203], v[184:187], v[208:223]
    v_mfma_f32_32x32x16_bf16 v[224:239], v[184:187], v[184:187], v[224:239]
    v_mfma_f32_32x32x16_bf16 v[208:223], v[204:207], v[188:191], v[208:223]
    v_mfma_f32_32x32x16_bf16 v[224:239], v[188:191], v[188:191], v[224:239]
    s_nop 15
    v_cmp_gt_u32 vcc, 4, v9
    s_and_saveexec_b64 s[54:55], vcc
    v_lshlrev_b32 v10, 7, v9
    v_lshl_add_u32 v10, v11, 4, v10
    s_lshl_b32 s36, s30, 9
    s_add_u32 s36, s36, 102400
    v_add_u32 v10, s36, v10
    ds_write_b128 v10, v[208:211] offset:0
    ds_write_b128 v10, v[212:215] offset:32
    ds_write_b128 v10, v[216:219] offset:64
    ds_write_b128 v10, v[220:223] offset:96
    v_lshlrev_b32 v10, 4, v9
    s_lshl_b32 s36, s30, 6
    s_add_u32 s36, s36, 106496
    v_add_u32 v10, s36, v10
    v_cmp_eq_u32 vcc, 0, v11
    s_and_b64 exec, exec, vcc
    ds_write_b128 v10, v[224:227]
    s_mov_b64 exec, s[54:55]
    s_waitcnt lgkmcnt(0)
    s_barrier
    s_cmp_eq_u32 s30, 1
    s_cbranch_scc0 UV_NG
    s_cmp_eq_u32 s60, 0
    s_cbranch_scc0 UV_END
    v_lshlrev_b32 v10, 2, v1
    v_add_u32 v8, 106496, v10
    ds_read_b32 v176, v8 offset:0
    ds_read_b32 v177, v8 offset:64
    ds_read_b32 v178, v8 offset:128
    ds_read_b32 v179, v8 offset:192
    ds_read_b32 v180, v8 offset:256
    ds_read_b32 v181, v8 offset:320
    ds_read_b32 v182, v8 offset:384
    ds_read_b32 v183, v8 offset:448
    s_waitcnt lgkmcnt(0)
    v_add_f32 v176, v176, v180
    v_add_f32 v177, v177, v181
    v_add_f32 v178, v178, v182
    v_add_f32 v179, v179, v183
    v_add_f32 v176, v176, v178
    v_add_f32 v177, v177, v179
    v_add_f32 v176, v176, v177
    s_lshl_b32 s36, s61, 6
    s_add_u32 s36, s36, 86016
    v_cmp_gt_u32 vcc, 16, v1
    s_and_saveexec_b64 s[54:55], vcc
    buffer_store_dword v176, v10, s[40:43], s36 offen sc1
    s_mov_b64 exec, s[54:55]
    s_branch UV_END
UV_NG:
    s_cmp_lt_u32 s30, 4
    s_cbranch_scc0 UV_END
    s_cmp_lt_u32 s2, 224
    s_cbranch_scc0 UV_END
    s_cmp_eq_u32 s30, 0
    s_cselect_b32 s37, 0, s30
    s_sub_u32 s38, s37, 1
    s_cselect_b32 s37, 0, s38
    v_and_b32 v9, 31, v1
    v_lshlrev_b32 v10, 2, v9
    s_lshl_b32 s36, s37, 7
    s_add_u32 s36, s36, 102400
    v_add_u32 v8, s36, v10
    ds_read_b32 v176, v8 offset:0
    ds_read_b32 v177, v8 offset:512
    ds_read_b32 v178, v8 offset:1024
    ds_read_b32 v179, v8 offset:1536
    ds_read_b32 v180, v8 offset:2048
    ds_read_b32 v181, v8 offset:2560
    ds_read_b32 v182, v8 offset:3072
    ds_read_b32 v183, v8 offset:3584
    s_waitcnt lgkmcnt(0)
    v_add_f32 v176, v176, v180
    v_add_f32 v177, v177, v181
    v_add_f32 v178, v178, v182
    v_add_f32 v179, v179, v183
    v_add_f32 v176, v176, v178
    v_add_f32 v177, v177, v179
    v_add_f32 v176, v176, v177
    s_mul_i32 s36, s61, 43008
    s_mul_i32 s38, s37, 14336
    s_add_u32 s36, s36, s38
    s_lshl_b32 s38, s60, 7
    s_add_u32 s36, s36, s38
    v_cmp_gt_u32 vcc, 32, v1
    s_and_saveexec_b64 s[54:55], vcc
    buffer_store_dword v176, v10, s[40:43], s36 offen sc1
    s_mov_b64 exec, s[54:55]
UV_END:
    s_waitcnt vmcnt(8)
    s_barrier
    ds_read_b64_tr_b16 v[48:49], v4 offset:0
    ds_read_b64_tr_b16 v[50:51], v4 offset:1024
    ds_read_b64_tr_b16 v[52:53], v4 offset:256
    ds_read_b64_tr_b16 v[54:55], v4 offset:1280
    ds_read_b64_tr_b16 v[56:57], v4 offset:2048
    ds_read_b64_tr_b16 v[58:59], v4 offset:3072
    ds_read_b64_tr_b16 v[60:61], v4 offset:2304
    ds_read_b64_tr_b16 v[62:63], v4 offset:3328
    ds_read_b64_tr_b16 v[64:65], v4 offset:4096
    ds_read_b64_tr_b16 v[66:67], v4 offset:5120
    ds_read_b64_tr_b16 v[68:69], v4 offset:4352
    ds_read_b64_tr_b16 v[70:71], v4 offset:5376
    ds_read_b64_tr_b16 v[72:73], v4 offset:6144
    ds_read_b64_tr_b16 v[74:75], v4 offset:7168
    ds_read_b64_tr_b16 v[76:77], v4 offset:6400
    ds_read_b64_tr_b16 v[78:79], v4 offset:7424
    s_waitcnt lgkmcnt(12)
    v_mfma_f32_32x32x16_bf16 v[16:31], v[48:51], v[80:83], v[16:31]
    v_mfma_f32_32x32x16_bf16 v[32:47], v[52:55], v[80:83], v[32:47]
    s_add_u32 s37, s33, 16384
    s_add_u32 m0, s39, 49152
    s_nop 0
    buffer_load_dwordx4 v3, s[8:11], s33 offen lds
    s_waitcnt lgkmcnt(8)
    v_mfma_f32_32x32x16_bf16 v[16:31], v[56:59], v[84:87], v[16:31]
    v_mfma_f32_32x32x16_bf16 v[32:47], v[60:63], v[84:87], v[32:47]
    s_add_u32 m0, s39, 50176
    s_nop 0
    buffer_load_dwordx4 v3, s[8:11], s37 offen lds
    s_add_u32 s33, s33, 131072
    s_waitcnt lgkmcnt(4)
    v_mfma_f32_32x32x16_bf16 v[16:31], v[64:67], v[88:91], v[16:31]
    v_mfma_f32_32x32x16_bf16 v[32:47], v[68:71], v[88:91], v[32:47]
    buffer_load_dwordx4 v[128:131], v2, s[12:15], s34 offen offset:0 sc1
    buffer_load_dwordx4 v[132:135], v2, s[12:15], s34 offen offset:1024 sc1
    s_waitcnt lgkmcnt(0)
    v_mfma_f32_32x32x16_bf16 v[16:31], v[72:75], v[92:95], v[16:31]
    v_mfma_f32_32x32x16_bf16 v[32:47], v[76:79], v[92:95], v[32:47]
    buffer_load_dwordx4 v[136:139], v2, s[12:15], s34 offen offset:2048 sc1
    buffer_load_dwordx4 v[140:143], v2, s[12:15], s34 offen offset:3072 sc1
    s_add_u32 s34, s34, 4096
    s_waitcnt vmcnt(10)
    s_barrier
    ds_read_b64_tr_b16 v[48:49], v4 offset:16384
    ds_read_b64_tr_b16 v[50:51], v4 offset:17408
    ds_read_b64_tr_b16 v[52:53], v4 offset:16640
    ds_read_b64_tr_b16 v[54:55], v4 offset:17664
    ds_read_b64_tr_b16 v[56:57], v4 offset:18432
    ds_read_b64_tr_b16 v[58:59], v4 offset:19456
    ds_read_b64_tr_b16 v[60:61], v4 offset:18688
    ds_read_b64_tr_b16 v[62:63], v4 offset:19712
    ds_read_b64_tr_b16 v[64:65], v4 offset:20480
    ds_read_b64_tr_b16 v[66:67], v4 offset:21504
    ds_read_b64_tr_b16 v[68:69], v4 offset:20736
    ds_read_b64_tr_b16 v[70:71], v4 offset:21760
    ds_read_b64_tr_b16 v[72:73], v4 offset:22528
    ds_read_b64_tr_b16 v[74:75], v4 offset:23552
    ds_read_b64_tr_b16 v[76:77], v4 offset:22784
    ds_read_b64_tr_b16 v[78:79], v4 offset:23808
    s_waitcnt lgkmcnt(12)
    v_mfma_f32_32x32x16_bf16 v[16:31], v[48:51], v[96:99], v[16:31]
    v_mfma_f32_32x32x16_bf16 v[32:47], v[52:55], v[96:99], v[32:47]
    s_add_u32 s37, s33, 16384
    s_add_u32 m0, s39, 0
    s_nop 0
    buffer_load_dwordx4 v3, s[8:11], s33 offen lds
    s_waitcnt lgkmcnt(8)
    v_mfma_f32_32x32x16_bf16 v[16:31], v[56:59], v[100:103], v[16:31]
    v_mfma_f32_32x32x16_bf16 v[32:47], v[60:63], v[100:103], v[32:47]
    s_add_u32 m0, s39, 1024
    s_nop 0
    buffer_load_dwordx4 v3, s[8:11], s37 offen lds
    s_add_u32 s33, s33, 131072
    s_waitcnt lgkmcnt(4)
    v_mfma_f32_32x32x16_bf16 v[16:31], v[64:67], v[104:107], v[16:31]
    v_mfma_f32_32x32x16_bf16 v[32:47], v[68:71], v[104:107], v[32:47]
    buffer_load_dwordx4 v[80:83], v2, s[12:15], s34 offen offset:0 sc1
    buffer_load_dwordx4 v[84:87], v2, s[12:15], s34 offen offset:1024 sc1
    s_waitcnt lgkmcnt(0)
    v_mfma_f32_32x32x16_bf16 v[16:31], v[72:75], v[108:111], v[16:31]
    v_mfma_f32_32x32x16_bf16 v[32:47], v[76:79], v[108:111], v[32:47]
    buffer_load_dwordx4 v[88:91], v2, s[12:15], s34 offen offset:2048 sc1
    buffer_load_dwordx4 v[92:95], v2, s[12:15], s34 offen offset:3072 sc1
    s_add_u32 s34, s34, 4096
    s_waitcnt vmcnt(12)
    s_barrier
    ds_read_b64_tr_b16 v[48:49], v4 offset:32768
    ds_read_b64_tr_b16 v[50:51], v4 offset:33792
    ds_read_b64_tr_b16 v[52:53], v4 offset:33024
    ds_read_b64_tr_b16 v[54:55], v4 offset:34048
    ds_read_b64_tr_b16 v[56:57], v4 offset:34816
    ds_read_b64_tr_b16 v[58:59], v4 offset:35840
    ds_read_b64_tr_b16 v[60:61], v4 offset:35072
    ds_read_b64_tr_b16 v[62:63], v4 offset:36096
    ds_read_b64_tr_b16 v[64:65], v4 offset:36864
    ds_read_b64_tr_b16 v[66:67], v4 offset:37888
    ds_read_b64_tr_b16 v[68:69], v4 offset:37120
    ds_read_b64_tr_b16 v[70:71], v4 offset:38144
    ds_read_b64_tr_b16 v[72:73], v4 offset:38912
    ds_read_b64_tr_b16 v[74:75], v4 offset:39936
    ds_read_b64_tr_b16 v[76:77], v4 offset:39168
    ds_read_b64_tr_b16 v[78:79], v4 offset:40192
    s_waitcnt lgkmcnt(12)
    v_mfma_f32_32x32x16_bf16 v[16:31], v[48:51], v[112:115], v[16:31]
    v_mfma_f32_32x32x16_bf16 v[32:47], v[52:55], v[112:115], v[32:47]
    s_add_u32 s37, s33, 16384
    s_add_u32 m0, s39, 16384
    s_nop 0
    buffer_load_dwordx4 v3, s[8:11], s33 offen lds
    s_waitcnt lgkmcnt(8)
    v_mfma_f32_32x32x16_bf16 v[16:31], v[56:59], v[116:119], v[16:31]
    v_mfma_f32_32x32x16_bf16 v[32:47], v[60:63], v[116:119], v[32:47]
    s_add_u32 m0, s39, 17408
    s_nop 0
    buffer_load_dwordx4 v3, s[8:11], s37 offen lds
    s_add_u32 s33, s33, 131072
    s_waitcnt lgkmcnt(4)
    v_mfma_f32_32x32x16_bf16 v[16:31], v[64:67], v[120:123], v[16:31]
    v_mfma_f32_32x32x16_bf16 v[32:47], v[68:71], v[120:123], v[32:47]
    buffer_load_dwordx4 v[96:99], v2, s[12:15], s34 offen offset:0 sc1
    buffer_load_dwordx4 v[100:103], v2, s[12:15], s34 offen offset:1024 sc1
    s_waitcnt lgkmcnt(0)
    v_mfma_f32_32x32x16_bf16 v[16:31], v[72:75], v[124:127], v[16:31]
    v_mfma_f32_32x32x16_bf16 v[32:47], v[76:79], v[124:127], v[32:47]
    buffer_load_dwordx4 v[104:107], v2, s[12:15], s34 offen offset:2048 sc1
    buffer_load_dwordx4 v[108:111], v2, s[12:15], s34 offen offset:3072 sc1
    s_add_u32 s34, s34, 4096
    s_waitcnt vmcnt(12)
    s_barrier
    ds_read_b64_tr_b16 v[48:49], v4 offset:49152
    ds_read_b64_tr_b16 v[50:51], v4 offset:50176
    ds_read_b64_tr_b16 v[52:53], v4 offset:49408
    ds_read_b64_tr_b16 v[54:55], v4 offset:50432
    ds_read_b64_tr_b16 v[56:57], v4 offset:51200
    ds_read_b64_tr_b16 v[58:59], v4 offset:52224
    ds_read_b64_tr_b16 v[60:61], v4 offset:51456
    ds_read_b64_tr_b16 v[62:63], v4 offset:52480
    ds_read_b64_tr_b16 v[64:65], v4 offset:53248
    ds_read_b64_tr_b16 v[66:67], v4 offset:54272
    ds_read_b64_tr_b16 v[68:69], v4 offset:53504
    ds_read_b64_tr_b16 v[70:71], v4 offset:54528
    ds_read_b64_tr_b16 v[72:73], v4 offset:55296
    ds_read_b64_tr_b16 v[74:75], v4 offset:56320
    ds_read_b64_tr_b16 v[76:77], v4 offset:55552
    ds_read_b64_tr_b16 v[78:79], v4 offset:56576
    s_waitcnt lgkmcnt(12)
    v_mfma_f32_32x32x16_bf16 v[16:31], v[48:51], v[128:131], v[16:31]
    v_mfma_f32_32x32x16_bf16 v[32:47], v[52:55], v[128:131], v[32:47]
    s_add_u32 s37, s33, 16384
    s_add_u32 m0, s39, 32768
    s_nop 0
    buffer_load_dwordx4 v3, s[8:11], s33 offen lds
    s_waitcnt lgkmcnt(8)
    v_mfma_f32_32x32x16_bf16 v[16:31], v[56:59], v[132:135], v[16:31]
    v_mfma_f32_32x32x16_bf16 v[32:47], v[60:63], v[132:135], v[32:47]
    s_add_u32 m0, s39, 33792
    s_nop 0
    buffer_load_dwordx4 v3, s[8:11], s37 offen lds
    s_add_u32 s33, s33, 131072
    s_waitcnt lgkmcnt(4)
    v_mfma_f32_32x32x16_bf16 v[16:31], v[64:67], v[136:139], v[16:31]
    v_mfma_f32_32x32x16_bf16 v[32:47], v[68:71], v[136:139], v[32:47]
    buffer_load_dwordx4 v[112:115], v2, s[12:15], s34 offen offset:0 sc1
    buffer_load_dwordx4 v[116:119], v2, s[12:15], s34 offen offset:1024 sc1
    s_waitcnt lgkmcnt(0)
    v_mfma_f32_32x32x16_bf16 v[16:31], v[72:75], v[140:143], v[16:31]
    v_mfma_f32_32x32x16_bf16 v[32:47], v[76:79], v[140:143], v[32:47]
    buffer_load_dwordx4 v[120:123], v2, s[12:15], s34 offen offset:2048 sc1
    buffer_load_dwordx4 v[124:127], v2, s[12:15], s34 offen offset:3072 sc1
    s_add_u32 s34, s34, 4096
    s_waitcnt vmcnt(12)
    s_barrier
    ds_read_b64_tr_b16 v[48:49], v4 offset:0
    ds_read_b64_tr_b16 v[50:51], v4 offset:1024
    ds_read_b64_tr_b16 v[52:53], v4 offset:256
    ds_read_b64_tr_b16 v[54:55], v4 offset:1280
    ds_read_b64_tr_b16 v[56:57], v4 offset:2048
    ds_read_b64_tr_b16 v[58:59], v4 offset:3072
    ds_read_b64_tr_b16 v[60:61], v4 offset:2304
    ds_read_b64_tr_b16 v[62:63], v4 offset:3328
    ds_read_b64_tr_b16 v[64:65], v4 offset:4096
    ds_read_b64_tr_b16 v[66:67], v4 offset:5120
    ds_read_b64_tr_b16 v[68:69], v4 offset:4352
    ds_read_b64_tr_b16 v[70:71], v4 offset:5376
    ds_read_b64_tr_b16 v[72:73], v4 offset:6144
    ds_read_b64_tr_b16 v[74:75], v4 offset:7168
    ds_read_b64_tr_b16 v[76:77], v4 offset:6400
    ds_read_b64_tr_b16 v[78:79], v4 offset:7424
    s_waitcnt lgkmcnt(12)
    v_mfma_f32_32x32x16_bf16 v[16:31], v[48:51], v[80:83], v[16:31]
    v_mfma_f32_32x32x16_bf16 v[32:47], v[52:55], v[80:83], v[32:47]
    s_add_u32 s37, s33, 16384
    s_add_u32 m0, s39, 49152
    s_nop 0
    buffer_load_dwordx4 v3, s[8:11], s33 offen lds
    s_waitcnt lgkmcnt(8)
    v_mfma_f32_32x32x16_bf16 v[16:31], v[56:59], v[84:87], v[16:31]
    v_mfma_f32_32x32x16_bf16 v[32:47], v[60:63], v[84:87], v[32:47]
    s_add_u32 m0, s39, 50176
    s_nop 0
    buffer_load_dwordx4 v3, s[8:11], s37 offen lds
    s_add_u32 s33, s33, 131072
    s_waitcnt lgkmcnt(4)
    v_mfma_f32_32x32x16_bf16 v[16:31], v[64:67], v[88:91], v[16:31]
    v_mfma_f32_32x32x16_bf16 v[32:47], v[68:71], v[88:91], v[32:47]
    buffer_load_dwordx4 v[128:131], v2, s[12:15], s34 offen offset:0 sc1
    buffer_load_dwordx4 v[132:135], v2, s[12:15], s34 offen offset:1024 sc1
    s_waitcnt lgkmcnt(0)
    v_mfma_f32_32x32x16_bf16 v[16:31], v[72:75], v[92:95], v[16:31]
    v_mfma_f32_32x32x16_bf16 v[32:47], v[76:79], v[92:95], v[32:47]
    buffer_load_dwordx4 v[136:139], v2, s[12:15], s34 offen offset:2048 sc1
    buffer_load_dwordx4 v[140:143], v2, s[12:15], s34 offen offset:3072 sc1
    s_add_u32 s34, s34, 4096
    s_waitcnt vmcnt(12)
    s_barrier
    ds_read_b64_tr_b16 v[48:49], v4 offset:16384
    ds_read_b64_tr_b16 v[50:51], v4 offset:17408
    ds_read_b64_tr_b16 v[52:53], v4 offset:16640
    ds_read_b64_tr_b16 v[54:55], v4 offset:17664
    ds_read_b64_tr_b16 v[56:57], v4 offset:18432
    ds_read_b64_tr_b16 v[58:59], v4 offset:19456
    ds_read_b64_tr_b16 v[60:61], v4 offset:18688
    ds_read_b64_tr_b16 v[62:63], v4 offset:19712
    ds_read_b64_tr_b16 v[64:65], v4 offset:20480
    ds_read_b64_tr_b16 v[66:67], v4 offset:21504
    ds_read_b64_tr_b16 v[68:69], v4 offset:20736
    ds_read_b64_tr_b16 v[70:71], v4 offset:21760
    ds_read_b64_tr_b16 v[72:73], v4 offset:22528
    ds_read_b64_tr_b16 v[74:75], v4 offset:23552
    ds_read_b64_tr_b16 v[76:77], v4 offset:22784
    ds_read_b64_tr_b16 v[78:79], v4 offset:23808
    s_waitcnt lgkmcnt(12)
    v_mfma_f32_32x32x16_bf16 v[16:31], v[48:51], v[96:99], v[16:31]
    v_mfma_f32_32x32x16_bf16 v[32:47], v[52:55], v[96:99], v[32:47]
    v_and_b32 v8, 31, v1
    v_lshrrev_b32 v9, 5, v1
    v_lshlrev_b32 v10, 11, v8
    v_lshl_add_u32 v10, v9, 4, v10
    s_lshl_b32 s36, s28, 2
    s_add_u32 s36, s36, s31
    s_lshl_b32 s36, s36, 16
    s_lshl_b32 s37, s29, 7
    s_add_u32 s36, s36, s37
    s_lshl_b32 s37, s32, 6
    s_add_u32 s36, s36, s37
    buffer_load_dwordx4 v[144:147], v10, s[16:19], s36 offen
    buffer_load_dwordx4 v[148:151], v10, s[16:19], s36 offen offset:32
    v_lshlrev_b32 v11, 2, v1
    s_lshl_b32 s36, s29, 8
    s_add_u32 s37, s36, 65536
    buffer_load_dword v152, v11, s[44:47], s37 offen sc1
    s_add_u32 s37, s36, 73728
    buffer_load_dword v153, v11, s[44:47], s37 offen sc1
    s_add_u32 s37, s36, 81920
    buffer_load_dword v162, v11, s[44:47], s37 offen sc1
    s_add_u32 s37, s36, 90112
    buffer_load_dword v163, v11, s[44:47], s37 offen sc1
    s_add_u32 s37, s36, 8192
    buffer_load_dword v154, v11, s[44:47], s37 offen sc1
    s_add_u32 s37, s36, 24576
    buffer_load_dword v155, v11, s[44:47], s37 offen sc1
    s_add_u32 s37, s36, 40960
    buffer_load_dword v156, v11, s[44:47], s37 offen sc1
    s_add_u32 s37, s36, 57344
    buffer_load_dword v157, v11, s[44:47], s37 offen sc1
    s_add_u32 s37, s36, 12288
    buffer_load_dword v158, v11, s[44:47], s37 offen sc1
    s_add_u32 s37, s36, 28672
    buffer_load_dword v159, v11, s[44:47], s37 offen sc1
    s_add_u32 s37, s36, 45056
    buffer_load_dword v160, v11, s[44:47], s37 offen sc1
    s_add_u32 s37, s36, 61440
    buffer_load_dword v161, v11, s[44:47], s37 offen sc1
    s_waitcnt lgkmcnt(8)
    v_mfma_f32_32x32x16_bf16 v[16:31], v[56:59], v[100:103], v[16:31]
    v_mfma_f32_32x32x16_bf16 v[32:47], v[60:63], v[100:103], v[32:47]
    s_waitcnt lgkmcnt(4)
    v_mfma_f32_32x32x16_bf16 v[16:31], v[64:67], v[104:107], v[16:31]
    v_mfma_f32_32x32x16_bf16 v[32:47], v[68:71], v[104:107], v[32:47]
    s_waitcnt lgkmcnt(0)
    v_mfma_f32_32x32x16_bf16 v[16:31], v[72:75], v[108:111], v[16:31]
    v_mfma_f32_32x32x16_bf16 v[32:47], v[76:79], v[108:111], v[32:47]
    s_waitcnt vmcnt(20)
    s_barrier
    ds_read_b64_tr_b16 v[48:49], v4 offset:32768
    ds_read_b64_tr_b16 v[50:51], v4 offset:33792
    ds_read_b64_tr_b16 v[52:53], v4 offset:33024
    ds_read_b64_tr_b16 v[54:55], v4 offset:34048
    ds_read_b64_tr_b16 v[56:57], v4 offset:34816
    ds_read_b64_tr_b16 v[58:59], v4 offset:35840
    ds_read_b64_tr_b16 v[60:61], v4 offset:35072
    ds_read_b64_tr_b16 v[62:63], v4 offset:36096
    ds_read_b64_tr_b16 v[64:65], v4 offset:36864
    ds_read_b64_tr_b16 v[66:67], v4 offset:37888
    ds_read_b64_tr_b16 v[68:69], v4 offset:37120
    ds_read_b64_tr_b16 v[70:71], v4 offset:38144
    ds_read_b64_tr_b16 v[72:73], v4 offset:38912
    ds_read_b64_tr_b16 v[74:75], v4 offset:39936
    ds_read_b64_tr_b16 v[76:77], v4 offset:39168
    ds_read_b64_tr_b16 v[78:79], v4 offset:40192
    s_waitcnt lgkmcnt(12)
    v_mfma_f32_32x32x16_bf16 v[16:31], v[48:51], v[112:115], v[16:31]
    v_mfma_f32_32x32x16_bf16 v[32:47], v[52:55], v[112:115], v[32:47]
    s_waitcnt lgkmcnt(8)
    v_mfma_f32_32x32x16_bf16 v[16:31], v[56:59], v[116:119], v[16:31]
    v_mfma_f32_32x32x16_bf16 v[32:47], v[60:63], v[116:119], v[32:47]
    s_waitcnt lgkmcnt(4)
    v_mfma_f32_32x32x16_bf16 v[16:31], v[64:67], v[120:123], v[16:31]
    v_mfma_f32_32x32x16_bf16 v[32:47], v[68:71], v[120:123], v[32:47]
    s_waitcnt lgkmcnt(0)
    v_mfma_f32_32x32x16_bf16 v[16:31], v[72:75], v[124:127], v[16:31]
    v_mfma_f32_32x32x16_bf16 v[32:47], v[76:79], v[124:127], v[32:47]
    s_waitcnt vmcnt(14)
    s_barrier
    ds_read_b64_tr_b16 v[48:49], v4 offset:49152
    ds_read_b64_tr_b16 v[50:51], v4 offset:50176
    ds_read_b64_tr_b16 v[52:53], v4 offset:49408
    ds_read_b64_tr_b16 v[54:55], v4 offset:50432
    ds_read_b64_tr_b16 v[56:57], v4 offset:51200
    ds_read_b64_tr_b16 v[58:59], v4 offset:52224
    ds_read_b64_tr_b16 v[60:61], v4 offset:51456
    ds_read_b64_tr_b16 v[62:63], v4 offset:52480
    ds_read_b64_tr_b16 v[64:65], v4 offset:53248
    ds_read_b64_tr_b16 v[66:67], v4 offset:54272
    ds_read_b64_tr_b16 v[68:69], v4 offset:53504
    ds_read_b64_tr_b16 v[70:71], v4 offset:54528
    ds_read_b64_tr_b16 v[72:73], v4 offset:55296
    ds_read_b64_tr_b16 v[74:75], v4 offset:56320
    ds_read_b64_tr_b16 v[76:77], v4 offset:55552
    ds_read_b64_tr_b16 v[78:79], v4 offset:56576
    s_waitcnt lgkmcnt(12)
    v_mfma_f32_32x32x16_bf16 v[16:31], v[48:51], v[128:131], v[16:31]
    v_mfma_f32_32x32x16_bf16 v[32:47], v[52:55], v[128:131], v[32:47]
    s_waitcnt lgkmcnt(8)
    v_mfma_f32_32x32x16_bf16 v[16:31], v[56:59], v[132:135], v[16:31]
    v_mfma_f32_32x32x16_bf16 v[32:47], v[60:63], v[132:135], v[32:47]
    s_waitcnt lgkmcnt(4)
    v_mfma_f32_32x32x16_bf16 v[16:31], v[64:67], v[136:139], v[16:31]
    v_mfma_f32_32x32x16_bf16 v[32:47], v[68:71], v[136:139], v[32:47]
    s_waitcnt lgkmcnt(0)
    v_mfma_f32_32x32x16_bf16 v[16:31], v[72:75], v[140:143], v[16:31]
    v_mfma_f32_32x32x16_bf16 v[32:47], v[76:79], v[140:143], v[32:47]
    s_waitcnt vmcnt(0)
    s_barrier
    s_nop 15
    s_cmp_lt_u32 s2, 224
    s_cbranch_scc0 UV_NOSIG
    s_cmp_eq_u32 s30, 0
    s_cbranch_scc0 CSIG16
    s_mov_b32 s4, s94
    s_mov_b32 s5, s95
    s_mov_b32 s6, 256
    s_mov_b32 s7, 0x00020000
    v_mov_b32 v250, 1
    v_mov_b32 v251, 64
    v_cmp_eq_u32 vcc, 0, v1
    s_and_saveexec_b64 s[54:55], vcc
    buffer_atomic_add v250, v251, s[4:7], 0 offen sc1
    s_mov_b64 exec, s[54:55]
CSIG16:
UV_NOSIG:
    v_add_f32 v152, v152, v153
    v_add_f32 v162, v162, v163
    v_add_f32 v152, v152, v162
    v_add_f32 v154, v154, v155
    v_add_f32 v156, v156, v157
    v_add_f32 v158, v158, v159
    v_add_f32 v160, v160, v161
    v_add_f32 v154, v154, v156
    v_add_f32 v158, v158, v160
    v_cvt_pk_bf16_f32 v152, v152, v154
    v_cvt_pk_bf16_f32 v158, v158, v158
    v_and_b32 v154, 0xffff0000, v152
    v_lshlrev_b32 v152, 16, v152
    v_lshlrev_b32 v158, 16, v158
    v_add_f32 v158, 1.0, v158
    v_cvt_pk_bf16_f32 v158, v158, v158
    v_lshlrev_b32 v158, 16, v158
    v_lshlrev_b32 v8, 2, v1
    v_add_u32 v8, 159232, v8
    ds_write_b32 v8, v152
    ds_write_b32 v8, v158 offset:256
    v_lshlrev_b32 v8, 1, v1
    v_add_u32 v8, 159232, v8
    ds_write_b16_d16_hi v8, v154 offset:512
    ds_write_b16_d16_hi v8, v158 offset:640
    s_lshl_b32 s36, s31, 13
    s_add_u32 s36, s36, 126464
    v_add_u32 v5, s36, v2
    s_cmp_eq_u32 s32, 0
    s_cbranch_scc0 P3G_X1
    ds_write_b128 v5, v[32:35] offset:4096
    ds_write_b128 v5, v[36:39] offset:5120
    ds_write_b128 v5, v[40:43] offset:6144
    ds_write_b128 v5, v[44:47] offset:7168
    s_branch P3G_X2
P3G_X1:
    ds_write_b128 v5, v[16:19] offset:0
    ds_write_b128 v5, v[20:23] offset:1024
    ds_write_b128 v5, v[24:27] offset:2048
    ds_write_b128 v5, v[28:31] offset:3072
    s_nop 1
    v_mov_b32 v16, v32
    v_mov_b32 v17, v33
    v_mov_b32 v18, v34
    v_mov_b32 v19, v35
    v_mov_b32 v20, v36
    v_mov_b32 v21, v37
    v_mov_b32 v22, v38
    v_mov_b32 v23, v39
    v_mov_b32 v24, v40
    v_mov_b32 v25, v41
    v_mov_b32 v26, v42
    v_mov_b32 v27, v43
    v_mov_b32 v28, v44
    v_mov_b32 v29, v45
    v_mov_b32 v30, v46
    v_mov_b32 v31, v47
P3G_X2:
    s_waitcnt lgkmcnt(0)
    s_barrier
    s_lshl_b32 s36, s32, 12
    v_add_u32 v5, s36, v5
    ds_read_b128 v[32:35], v5 offset:0
    ds_read_b128 v[36:39], v5 offset:1024
    ds_read_b128 v[40:43], v5 offset:2048
    ds_read_b128 v[44:47], v5 offset:3072
    s_waitcnt lgkmcnt(0)
    v_add_f32 v16, v16, v32
    v_add_f32 v17, v17, v33
    v_add_f32 v18, v18, v34
    v_add_f32 v19, v19, v35
    v_add_f32 v20, v20, v36
    v_add_f32 v21, v21, v37
    v_add_f32 v22, v22, v38
    v_add_f32 v23, v23, v39
    v_add_f32 v24, v24, v40
    v_add_f32 v25, v25, v41
    v_add_f32 v26, v26, v42
    v_add_f32 v27, v27, v43
    v_add_f32 v28, v28, v44
    v_add_f32 v29, v29, v45
    v_add_f32 v30, v30, v46
    v_add_f32 v31, v31, v47
    v_lshrrev_b32 v9, 5, v1
    v_lshlrev_b32 v10, 4, v9
    s_lshl_b32 s36, s32, 7
    s_add_u32 s36, s36, 159232
    v_add_u32 v10, s36, v10
    v_lshlrev_b32 v11, 3, v9
    s_lshl_b32 s36, s32, 6
    s_add_u32 s36, s36, 159232
    v_add_u32 v11, s36, v11
    ds_read_b128 v[152:155], v10 offset:0
    ds_read_b128 v[156:159], v10 offset:32
    ds_read_b128 v[160:163], v10 offset:64
    ds_read_b128 v[164:167], v10 offset:96
    ds_read_b128 v[168:171], v10 offset:256
    ds_read_b128 v[172:175], v10 offset:288
    ds_read_b128 v[176:179], v10 offset:320
    ds_read_b128 v[180:183], v10 offset:352
    ds_read_b64 v[184:185], v11 offset:512
    ds_read_b64 v[192:193], v11 offset:640
    ds_read_b64 v[186:187], v11 offset:528
    ds_read_b64 v[194:195], v11 offset:656
    ds_read_b64 v[188:189], v11 offset:544
    ds_read_b64 v[196:197], v11 offset:672
    ds_read_b64 v[190:191], v11 offset:560
    ds_read_b64 v[198:199], v11 offset:688
    v_permlane32_swap_b32 v144, v146
    v_permlane32_swap_b32 v145, v147
    v_permlane32_swap_b32 v148, v150
    v_permlane32_swap_b32 v149, v151
    s_lshl_b32 s36, s28, 2
    s_add_u32 s36, s36, s31
    s_lshl_b32 s36, s36, 6
    s_lshl_b32 s37, s29, 2
    s_add_u32 s36, s36, s37
    s_lshl_b32 s37, s32, 1
    s_add_u32 s36, s36, s37
    s_lshl_b32 s36, s36, 10
    v_mov_b32 v70, 0x3f803f80
    s_waitcnt lgkmcnt(8)
    v_lshlrev_b32 v72, 16, v144
    v_and_b32 v73, 0xffff0000, v144
    v_fma_f32 v16, v16, v152, v72
    v_fma_f32 v17, v17, v153, v73
    v_lshlrev_b32 v74, 16, v145
    v_and_b32 v75, 0xffff0000, v145
    v_fma_f32 v18, v18, v154, v74
    v_fma_f32 v19, v19, v155, v75
    v_lshlrev_b32 v76, 16, v146
    v_and_b32 v77, 0xffff0000, v146
    v_fma_f32 v20, v20, v156, v76
    v_fma_f32 v21, v21, v157, v77
    v_lshlrev_b32 v78, 16, v147
    v_and_b32 v79, 0xffff0000, v147
    v_fma_f32 v22, v22, v158, v78
    v_fma_f32 v23, v23, v159, v79
    v_lshlrev_b32 v72, 16, v148
    v_and_b32 v73, 0xffff0000, v148
    v_fma_f32 v24, v24, v160, v72
    v_fma_f32 v25, v25, v161, v73
    v_lshlrev_b32 v74, 16, v149
    v_and_b32 v75, 0xffff0000, v149
    v_fma_f32 v26, v26, v162, v74
    v_fma_f32 v27, v27, v163, v75
    v_lshlrev_b32 v76, 16, v150
    v_and_b32 v77, 0xffff0000, v150
    v_fma_f32 v28, v28, v164, v76
    v_fma_f32 v29, v29, v165, v77
    v_lshlrev_b32 v78, 16, v151
    v_and_b32 v79, 0xffff0000, v151
    v_fma_f32 v30, v30, v166, v78
    v_fma_f32 v31, v31, v167, v79
    s_waitcnt lgkmcnt(0)
    v_mul_f32 v48, v16, v168
    v_mul_f32 v49, v17, v169
    v_cvt_pk_bf16_f32 v240, v16, v17
    v_mul_f32 v50, v18, v170
    v_mul_f32 v51, v19, v171
    v_cvt_pk_bf16_f32 v241, v18, v19
    v_mul_f32 v52, v20, v172
    v_mul_f32 v53, v21, v173
    v_cvt_pk_bf16_f32 v242, v20, v21
    v_mul_f32 v54, v22, v174
    v_mul_f32 v55, v23, v175
    v_cvt_pk_bf16_f32 v243, v22, v23
    v_mul_f32 v56, v24, v176
    v_mul_f32 v57, v25, v177
    v_cvt_pk_bf16_f32 v244, v24, v25
    v_mul_f32 v58, v26, v178
    v_mul_f32 v59, v27, v179
    v_cvt_pk_bf16_f32 v245, v26, v27
    v_mul_f32 v60, v28, v180
    v_mul_f32 v61, v29, v181
    v_cvt_pk_bf16_f32 v246, v28, v29
    v_mul_f32 v62, v30, v182
    v_mul_f32 v63, v31, v183
    v_cvt_pk_bf16_f32 v247, v30, v31
    v_cvt_pk_bf16_f32 v40, v48, v49
    v_cvt_pk_bf16_f32 v41, v50, v51
    v_cvt_pk_bf16_f32 v42, v52, v53
    v_cvt_pk_bf16_f32 v43, v54, v55
    v_cvt_pk_bf16_f32 v44, v56, v57
    v_cvt_pk_bf16_f32 v45, v58, v59
    v_cvt_pk_bf16_f32 v46, v60, v61
    v_cvt_pk_bf16_f32 v47, v62, v63
    buffer_store_dwordx4 v[40:43], v2, s[48:51], s36 offen sc1
    buffer_store_dwordx4 v[44:47], v2, s[48:51], s36 offen offset:1024 sc1
    v_dot2_f32_bf16 v64, v240, v70, 0
    v_dot2_f32_bf16 v65, v240, v240, 0
    v_dot2_f32_bf16 v66, v40, v70, 0
    v_dot2_f32_bf16 v67, v40, v192, 0
    v_dot2_f32_bf16 v68, v40, v40, 0
    v_dot2_f32_bf16 v69, v40, v184, 0
    v_dot2_f32_bf16 v64, v241, v70, v64
    v_dot2_f32_bf16 v65, v241, v241, v65
    v_dot2_f32_bf16 v66, v41, v70, v66
    v_dot2_f32_bf16 v67, v41, v193, v67
    v_dot2_f32_bf16 v68, v41, v41, v68
    v_dot2_f32_bf16 v69, v41, v185, v69
    v_dot2_f32_bf16 v64, v242, v70, v64
    v_dot2_f32_bf16 v65, v242, v242, v65
    v_dot2_f32_bf16 v66, v42, v70, v66
    v_dot2_f32_bf16 v67, v42, v194, v67
    v_dot2_f32_bf16 v68, v42, v42, v68
    v_dot2_f32_bf16 v69, v42, v186, v69
    v_dot2_f32_bf16 v64, v243, v70, v64
    v_dot2_f32_bf16 v65, v243, v243, v65
    v_dot2_f32_bf16 v66, v43, v70, v66
    v_dot2_f32_bf16 v67, v43, v195, v67
    v_dot2_f32_bf16 v68, v43, v43, v68
    v_dot2_f32_bf16 v69, v43, v187, v69
    v_dot2_f32_bf16 v64, v244, v70, v64
    v_dot2_f32_bf16 v65, v244, v244, v65
    v_dot2_f32_bf16 v66, v44, v70, v66
    v_dot2_f32_bf16 v67, v44, v196, v67
    v_dot2_f32_bf16 v68, v44, v44, v68
    v_dot2_f32_bf16 v69, v44, v188, v69
    v_dot2_f32_bf16 v64, v245, v70, v64
    v_dot2_f32_bf16 v65, v245, v245, v65
    v_dot2_f32_bf16 v66, v45, v70, v66
    v_dot2_f32_bf16 v67, v45, v197, v67
    v_dot2_f32_bf16 v68, v45, v45, v68
    v_dot2_f32_bf16 v69, v45, v189, v69
    v_dot2_f32_bf16 v64, v246, v70, v64
    v_dot2_f32_bf16 v65, v246, v246, v65
    v_dot2_f32_bf16 v66, v46, v70, v66
    v_dot2_f32_bf16 v67, v46, v198, v67
    v_dot2_f32_bf16 v68, v46, v46, v68
    v_dot2_f32_bf16 v69, v46, v190, v69
    v_dot2_f32_bf16 v64, v247, v70, v64
    v_dot2_f32_bf16 v65, v247, v247, v65
    v_dot2_f32_bf16 v66, v47, v70, v66
    v_dot2_f32_bf16 v67, v47, v199, v67
    v_dot2_f32_bf16 v68, v47, v47, v68
    v_dot2_f32_bf16 v69, v47, v191, v69
    s_nop 2
    v_mov_b32 v72, v64
    v_mov_b32 v73, v65
    v_mov_b32 v74, v66
    v_mov_b32 v75, v67
    v_mov_b32 v76, v68
    v_mov_b32 v77, v69
    s_nop 1
    v_permlane32_swap_b32 v64, v72
    v_permlane32_swap_b32 v65, v73
    v_permlane32_swap_b32 v66, v74
    v_permlane32_swap_b32 v67, v75
    v_permlane32_swap_b32 v68, v76
    v_permlane32_swap_b32 v69, v77
    s_nop 1
    v_add_f32 v64, v64, v72
    v_add_f32 v65, v65, v73
    v_add_f32 v66, v66, v74
    v_add_f32 v67, v67, v75
    v_add_f32 v68, v68, v76
    v_add_f32 v69, v69, v77
    v_and_b32 v8, 31, v1
    v_lshlrev_b32 v8, 5, v8
    s_lshl_b32 s37, s31, 13
    s_add_u32 s37, s37, 130560
    v_add_u32 v8, s37, v8
    v_mov_b32 v70, 0
    v_mov_b32 v71, 0
    s_lshl_b32 s101, s28, 4
    s_add_u32 s101, s101, s29
    s_cmp_eq_u32 s32, 1
    s_cbranch_scc0 P3_ST0
    ds_write_b128 v8, v[64:67]
    ds_write_b128 v8, v[68:71] offset:16
    s_waitcnt vmcnt(0) lgkmcnt(0)
    s_barrier
    s_branch P3_STE
P3_ST0:
    s_waitcnt vmcnt(0)
    s_barrier
    s_cmp_eq_u32 s30, 0
    s_cbranch_scc0 SIG17
    s_lshl_b32 s36, s101, 7
    s_add_u32 s36, s36, 106496
    v_mov_b32 v250, s100
    v_mov_b32 v251, 0
    v_cmp_eq_u32 vcc, 0, v1
    s_and_saveexec_b64 s[54:55], vcc
    buffer_store_dword v250, v251, s[96:99], s36 offen sc1
    s_mov_b64 exec, s[54:55]
SIG17:
    ds_read_b128 v[72:75], v8
    ds_read_b128 v[76:79], v8 offset:16
    s_waitcnt lgkmcnt(0)
    v_add_f32 v64, v64, v72
    v_add_f32 v65, v65, v73
    v_add_f32 v66, v66, v74
    v_add_f32 v67, v67, v75
    v_add_f32 v68, v68, v76
    v_add_f32 v69, v69, v77
    v_cmp_lt_u32 vcc, 31, v1
    v_and_b32 v8, 31, v1
    v_lshlrev_b32 v8, 5, v8
    v_lshrrev_b32 v9, 5, v1
    v_lshl_add_u32 v8, v9, 2, v8
    v_cndmask_b32 v64, v64, v65, vcc
    v_cndmask_b32 v66, v66, v67, vcc
    v_cndmask_b32 v68, v68, v69, vcc
    s_lshl_b32 s36, s28, 2
    s_add_u32 s36, s36, s31
    s_lshl_b32 s36, s36, 10
    buffer_atomic_add_f32 v64, v8, s[24:27], s36 offen sc1
    buffer_atomic_add_f32 v66, v8, s[24:27], s36 offen offset:8 sc1
    buffer_atomic_add_f32 v68, v8, s[24:27], s36 offen offset:16 sc1
P3_STE:
    s_and_b32 s26, s2, 7
    s_lshr_b32 s27, s2, 3
    s_and_b32 s28, s26, 1
    s_lshl_b32 s28, s28, 3
    s_and_b32 s29, s27, 7
    s_add_u32 s28, s28, s29
    s_lshr_b32 s29, s26, 1
    s_lshl_b32 s29, s29, 2
    s_lshr_b32 s27, s27, 3
    s_add_u32 s29, s29, s27
    s_mov_b32 s8, s76
    s_mov_b32 s9, s77
    s_mov_b32 s10, 0x700000
    s_mov_b32 s11, 0x00020000
    s_add_u32 s12, s20, 0xd00000
    s_addc_u32 s13, s21, 0
    s_mov_b32 s14, 0x400000
    s_mov_b32 s15, 0x00020000
    s_mov_b32 s16, s78
    s_mov_b32 s17, s79
    s_mov_b32 s18, 0x1c00
    s_mov_b32 s19, 0x00020000
    s_add_u32 s24, s20, 0x1100000
    s_addc_u32 s25, s21, 0
    s_mov_b32 s26, 0xe00000
    s_mov_b32 s27, 0x00020000
    s_cmp_ge_u32 s30, 4
    s_cbranch_scc1 P4_LOADER
    s_waitcnt vmcnt(0)
    s_barrier
    s_cmp_eq_u32 s30, 0
    s_cbranch_scc0 SIG18
    s_lshl_b32 s36, s101, 7
    s_add_u32 s36, s36, 172032
    v_mov_b32 v250, s100
    v_mov_b32 v251, 0
    v_cmp_eq_u32 vcc, 0, v1
    s_and_saveexec_b64 s[54:55], vcc
    buffer_store_dword v250, v251, s[96:99], s36 offen sc1
    s_mov_b64 exec, s[54:55]
SIG18:
    v_lshrrev_b32 v9, 5, v1
    s_lshl_b32 s34, s28, 2
    s_add_u32 s34, s34, s30
    s_lshl_b32 s34, s34, 16
    v_bfe_u32 v6, v1, 2, 2
    v_lshlrev_b32 v4, 6, v6
    v_bfe_u32 v5, v1, 4, 1
    v_lshl_add_u32 v4, v5, 5, v4
    v_and_b32 v7, 3, v1
    v_lshl_add_u32 v4, v7, 3, v4
    v_mul_u32_u24 v5, 1792, v9
    v_add_u32 v4, v4, v5
    v_add_u32 v3, 57344, v4
    v_mov_b32 v16, 0
    v_mov_b32 v17, 0
    v_mov_b32 v18, 0
    v_mov_b32 v19, 0
    v_mov_b32 v20, 0
    v_mov_b32 v21, 0
    v_mov_b32 v22, 0
    v_mov_b32 v23, 0
    v_mov_b32 v24, 0
    v_mov_b32 v25, 0
    v_mov_b32 v26, 0
    v_mov_b32 v27, 0
    v_mov_b32 v28, 0
    v_mov_b32 v29, 0
    v_mov_b32 v30, 0
    v_mov_b32 v31, 0
    v_mov_b32 v32, 0
    v_mov_b32 v33, 0
    v_mov_b32 v34, 0
    v_mov_b32 v35, 0
    v_mov_b32 v36, 0
    v_mov_b32 v37, 0
    v_mov_b32 v38, 0
    v_mov_b32 v39, 0
    v_mov_b32 v40, 0
    v_mov_b32 v41, 0
    v_mov_b32 v42, 0
    v_mov_b32 v43, 0
    v_mov_b32 v44, 0
    v_mov_b32 v45, 0
    v_mov_b32 v46, 0
    v_mov_b32 v47, 0
    v_mov_b32 v48, 0
    v_mov_b32 v49, 0
    v_mov_b32 v50, 0
    v_mov_b32 v51, 0
    v_mov_b32 v52, 0
    v_mov_b32 v53, 0
    v_mov_b32 v54, 0
    v_mov_b32 v55, 0
    v_mov_b32 v56, 0
    v_mov_b32 v57, 0
    v_mov_b32 v58, 0
    v_mov_b32 v59, 0
    v_mov_b32 v60, 0
    v_mov_b32 v61, 0
    v_mov_b32 v62, 0
    v_mov_b32 v63, 0
    v_mov_b32 v64, 0
    v_mov_b32 v65, 0
    v_mov_b32 v66, 0
    v_mov_b32 v67, 0
    v_mov_b32 v68, 0
    v_mov_b32 v69, 0
    v_mov_b32 v70, 0
    v_mov_b32 v71, 0
    v_mov_b32 v72, 0
    v_mov_b32 v73, 0
    v_mov_b32 v74, 0
    v_mov_b32 v75, 0
    v_mov_b32 v76, 0
    v_mov_b32 v77, 0
    v_mov_b32 v78, 0
    v_mov_b32 v79, 0
    v_mov_b32 v80, 0
    v_mov_b32 v81, 0
    v_mov_b32 v82, 0
    v_mov_b32 v83, 0
    v_mov_b32 v84, 0
    v_mov_b32 v85, 0
    v_mov_b32 v86, 0
    v_mov_b32 v87, 0
    v_mov_b32 v88, 0
    v_mov_b32 v89, 0
    v_mov_b32 v90, 0
    v_mov_b32 v91, 0
    v_mov_b32 v92, 0
    v_mov_b32 v93, 0
    v_mov_b32 v94, 0
    v_mov_b32 v95, 0
    v_mov_b32 v96, 0
    v_mov_b32 v97, 0
    v_mov_b32 v98, 0
    v_mov_b32 v99, 0
    v_mov_b32 v100, 0
    v_mov_b32 v101, 0
    v_mov_b32 v102, 0
    v_mov_b32 v103, 0
    v_mov_b32 v104, 0
    v_mov_b32 v105, 0
    v_mov_b32 v106, 0
    v_mov_b32 v107, 0
    v_mov_b32 v108, 0
    v_mov_b32 v109, 0
    v_mov_b32 v110, 0
    v_mov_b32 v111, 0
    v_mov_b32 v112, 0
    v_mov_b32 v113, 0
    v_mov_b32 v114, 0
    v_mov_b32 v115, 0
    v_mov_b32 v116, 0
    v_mov_b32 v117, 0
    v_mov_b32 v118, 0
    v_mov_b32 v119, 0
    v_mov_b32 v120, 0
    v_mov_b32 v121, 0
    v_mov_b32 v122, 0
    v_mov_b32 v123, 0
    v_mov_b32 v124, 0
    v_mov_b32 v125, 0
    v_mov_b32 v126, 0
    v_mov_b32 v127, 0
    s_barrier
    buffer_load_dwordx4 v[184:187], v2, s[12:15], s34 offen offset:0 sc1
    buffer_load_dwordx4 v[188:191], v2, s[12:15], s34 offen offset:1024 sc1
    buffer_load_dwordx4 v[192:195], v2, s[12:15], s34 offen offset:2048 sc1
    buffer_load_dwordx4 v[196:199], v2, s[12:15], s34 offen offset:3072 sc1
    s_add_u32 s34, s34, 4096
    buffer_load_dwordx4 v[200:203], v2, s[12:15], s34 offen offset:0 sc1
    buffer_load_dwordx4 v[204:207], v2, s[12:15], s34 offen offset:1024 sc1
    buffer_load_dwordx4 v[208:211], v2, s[12:15], s34 offen offset:2048 sc1
    buffer_load_dwordx4 v[212:215], v2, s[12:15], s34 offen offset:3072 sc1
    s_add_u32 s34, s34, 4096
    ds_read_b64_tr_b16 v[128:129], v4 offset:0
    ds_read_b64_tr_b16 v[130:131], v4 offset:3584
    ds_read_b64_tr_b16 v[132:133], v4 offset:256
    ds_read_b64_tr_b16 v[134:135], v4 offset:3840
    ds_read_b64_tr_b16 v[136:137], v4 offset:512
    ds_read_b64_tr_b16 v[138:139], v4 offset:4096
    ds_read_b64_tr_b16 v[140:141], v4 offset:768
    ds_read_b64_tr_b16 v[142:143], v4 offset:4352
    ds_read_b64_tr_b16 v[144:145], v4 offset:1024
    ds_read_b64_tr_b16 v[146:147], v4 offset:4608
    ds_read_b64_tr_b16 v[148:149], v4 offset:1280
    ds_read_b64_tr_b16 v[150:151], v4 offset:4864
    ds_read_b64_tr_b16 v[152:153], v4 offset:1536
    ds_read_b64_tr_b16 v[154:155], v4 offset:5120
    s_mov_b32 s41, 4
P4_LOOP:
    s_barrier
    s_waitcnt vmcnt(7) lgkmcnt(0)
    v_mfma_f32_32x32x16_bf16 v[16:31], v[128:131], v[184:187], v[16:31]
    ds_read_b64_tr_b16 v[156:157], v4 offset:7168
    ds_read_b64_tr_b16 v[158:159], v4 offset:10752
    ds_read_b64_tr_b16 v[160:161], v4 offset:7424
    v_mfma_f32_32x32x16_bf16 v[32:47], v[132:135], v[184:187], v[32:47]
    ds_read_b64_tr_b16 v[162:163], v4 offset:11008
    ds_read_b64_tr_b16 v[164:165], v4 offset:7680
    ds_read_b64_tr_b16 v[166:167], v4 offset:11264
    v_mfma_f32_32x32x16_bf16 v[48:63], v[136:139], v[184:187], v[48:63]
    ds_read_b64_tr_b16 v[168:169], v4 offset:7936
    ds_read_b64_tr_b16 v[170:171], v4 offset:11520
    ds_read_b64_tr_b16 v[172:173], v4 offset:8192
    v_mfma_f32_32x32x16_bf16 v[64:79], v[140:143], v[184:187], v[64:79]
    ds_read_b64_tr_b16 v[174:175], v4 offset:11776
    ds_read_b64_tr_b16 v[176:177], v4 offset:8448
    ds_read_b64_tr_b16 v[178:179], v4 offset:12032
    v_mfma_f32_32x32x16_bf16 v[80:95], v[144:147], v[184:187], v[80:95]
    ds_read_b64_tr_b16 v[180:181], v4 offset:8704
    ds_read_b64_tr_b16 v[182:183], v4 offset:12288
    v_mfma_f32_32x32x16_bf16 v[96:111], v[148:151], v[184:187], v[96:111]
    v_mfma_f32_32x32x16_bf16 v[112:127], v[152:155], v[184:187], v[112:127]
    buffer_load_dwordx4 v[184:187], v2, s[12:15], s34 offen offset:0 sc1
    s_waitcnt vmcnt(7) lgkmcnt(0)
    v_mfma_f32_32x32x16_bf16 v[16:31], v[156:159], v[188:191], v[16:31]
    ds_read_b64_tr_b16 v[128:129], v4 offset:14336
    ds_read_b64_tr_b16 v[130:131], v4 offset:17920
    ds_read_b64_tr_b16 v[132:133], v4 offset:14592
    v_mfma_f32_32x32x16_bf16 v[32:47], v[160:163], v[188:191], v[32:47]
    ds_read_b64_tr_b16 v[134:135], v4 offset:18176
    ds_read_b64_tr_b16 v[136:137], v4 offset:14848
    ds_read_b64_tr_b16 v[138:139], v4 offset:18432
    v_mfma_f32_32x32x16_bf16 v[48:63], v[164:167], v[188:191], v[48:63]
    ds_read_b64_tr_b16 v[140:141], v4 offset:15104
    ds_read_b64_tr_b16 v[142:143], v4 offset:18688
    ds_read_b64_tr_b16 v[144:145], v4 offset:15360
    v_mfma_f32_32x32x16_bf16 v[64:79], v[168:171], v[188:191], v[64:79]
    ds_read_b64_tr_b16 v[146:147], v4 offset:18944
    ds_read_b64_tr_b16 v[148:149], v4 offset:15616
    ds_read_b64_tr_b16 v[150:151], v4 offset:19200
    v_mfma_f32_32x32x16_bf16 v[80:95], v[172:175], v[188:191], v[80:95]
    ds_read_b64_tr_b16 v[152:153], v4 offset:15872
    ds_read_b64_tr_b16 v[154:155], v4 offset:19456
    v_mfma_f32_32x32x16_bf16 v[96:111], v[176:179], v[188:191], v[96:111]
    v_mfma_f32_32x32x16_bf16 v[112:127], v[180:183], v[188:191], v[112:127]
    buffer_load_dwordx4 v[188:191], v2, s[12:15], s34 offen offset:1024 sc1
    s_waitcnt vmcnt(7) lgkmcnt(0)
    v_mfma_f32_32x32x16_bf16 v[16:31], v[128:131], v[192:195], v[16:31]
    ds_read_b64_tr_b16 v[156:157], v4 offset:21504
    ds_read_b64_tr_b16 v[158:159], v4 offset:25088
    ds_read_b64_tr_b16 v[160:161], v4 offset:21760
    v_mfma_f32_32x32x16_bf16 v[32:47], v[132:135], v[192:195], v[32:47]
    ds_read_b64_tr_b16 v[162:163], v4 offset:25344
    ds_read_b64_tr_b16 v[164:165], v4 offset:22016
    ds_read_b64_tr_b16 v[166:167], v4 offset:25600
    v_mfma_f32_32x32x16_bf16 v[48:63], v[136:139], v[192:195], v[48:63]
    ds_read_b64_tr_b16 v[168:169], v4 offset:22272
    ds_read_b64_tr_b16 v[170:171], v4 offset:25856
    ds_read_b64_tr_b16 v[172:173], v4 offset:22528
    v_mfma_f32_32x32x16_bf16 v[64:79], v[140:143], v[192:195], v[64:79]
    ds_read_b64_tr_b16 v[174:175], v4 offset:26112
    ds_read_b64_tr_b16 v[176:177], v4 offset:22784
    ds_read_b64_tr_b16 v[178:179], v4 offset:26368
    v_mfma_f32_32x32x16_bf16 v[80:95], v[144:147], v[192:195], v[80:95]
    ds_read_b64_tr_b16 v[180:181], v4 offset:23040
    ds_read_b64_tr_b16 v[182:183], v4 offset:26624
    v_mfma_f32_32x32x16_bf16 v[96:111], v[148:151], v[192:195], v[96:111]
    v_mfma_f32_32x32x16_bf16 v[112:127], v[152:155], v[192:195], v[112:127]
    buffer_load_dwordx4 v[192:195], v2, s[12:15], s34 offen offset:2048 sc1
    s_waitcnt vmcnt(7) lgkmcnt(0)
    v_mfma_f32_32x32x16_bf16 v[16:31], v[156:159], v[196:199], v[16:31]
    ds_read_b64_tr_b16 v[128:129], v4 offset:28672
    ds_read_b64_tr_b16 v[130:131], v4 offset:32256
    ds_read_b64_tr_b16 v[132:133], v4 offset:28928
    v_mfma_f32_32x32x16_bf16 v[32:47], v[160:163], v[196:199], v[32:47]
    ds_read_b64_tr_b16 v[134:135], v4 offset:32512
    ds_read_b64_tr_b16 v[136:137], v4 offset:29184
    ds_read_b64_tr_b16 v[138:139], v4 offset:32768
    v_mfma_f32_32x32x16_bf16 v[48:63], v[164:167], v[196:199], v[48:63]
    ds_read_b64_tr_b16 v[140:141], v4 offset:29440
    ds_read_b64_tr_b16 v[142:143], v4 offset:33024
    ds_read_b64_tr_b16 v[144:145], v4 offset:29696
    v_mfma_f32_32x32x16_bf16 v[64:79], v[168:171], v[196:199], v[64:79]
    ds_read_b64_tr_b16 v[146:147], v4 offset:33280
    ds_read_b64_tr_b16 v[148:149], v4 offset:29952
    ds_read_b64_tr_b16 v[150:151], v4 offset:33536
    v_mfma_f32_32x32x16_bf16 v[80:95], v[172:175], v[196:199], v[80:95]
    ds_read_b64_tr_b16 v[152:153], v4 offset:30208
    ds_read_b64_tr_b16 v[154:155], v4 offset:33792
    v_mfma_f32_32x32x16_bf16 v[96:111], v[176:179], v[196:199], v[96:111]
    v_mfma_f32_32x32x16_bf16 v[112:127], v[180:183], v[196:199], v[112:127]
    buffer_load_dwordx4 v[196:199], v2, s[12:15], s34 offen offset:3072 sc1
    s_add_u32 s34, s34, 4096
    s_barrier
    s_waitcnt vmcnt(7) lgkmcnt(0)
    v_mfma_f32_32x32x16_bf16 v[16:31], v[128:131], v[200:203], v[16:31]
    ds_read_b64_tr_b16 v[156:157], v4 offset:35840
    ds_read_b64_tr_b16 v[158:159], v4 offset:39424
    ds_read_b64_tr_b16 v[160:161], v4 offset:36096
    v_mfma_f32_32x32x16_bf16 v[32:47], v[132:135], v[200:203], v[32:47]
    ds_read_b64_tr_b16 v[162:163], v4 offset:39680
    ds_read_b64_tr_b16 v[164:165], v4 offset:36352
    ds_read_b64_tr_b16 v[166:167], v4 offset:39936
    v_mfma_f32_32x32x16_bf16 v[48:63], v[136:139], v[200:203], v[48:63]
    ds_read_b64_tr_b16 v[168:169], v4 offset:36608
    ds_read_b64_tr_b16 v[170:171], v4 offset:40192
    ds_read_b64_tr_b16 v[172:173], v4 offset:36864
    v_mfma_f32_32x32x16_bf16 v[64:79], v[140:143], v[200:203], v[64:79]
    ds_read_b64_tr_b16 v[174:175], v4 offset:40448
    ds_read_b64_tr_b16 v[176:177], v4 offset:37120
    ds_read_b64_tr_b16 v[178:179], v4 offset:40704
    v_mfma_f32_32x32x16_bf16 v[80:95], v[144:147], v[200:203], v[80:95]
    ds_read_b64_tr_b16 v[180:181], v4 offset:37376
    ds_read_b64_tr_b16 v[182:183], v4 offset:40960
    v_mfma_f32_32x32x16_bf16 v[96:111], v[148:151], v[200:203], v[96:111]
    v_mfma_f32_32x32x16_bf16 v[112:127], v[152:155], v[200:203], v[112:127]
    buffer_load_dwordx4 v[200:203], v2, s[12:15], s34 offen offset:0 sc1
    s_waitcnt vmcnt(7) lgkmcnt(0)
    v_mfma_f32_32x32x16_bf16 v[16:31], v[156:159], v[204:207], v[16:31]
    ds_read_b64_tr_b16 v[128:129], v4 offset:43008
    ds_read_b64_tr_b16 v[130:131], v4 offset:46592
    ds_read_b64_tr_b16 v[132:133], v4 offset:43264
    v_mfma_f32_32x32x16_bf16 v[32:47], v[160:163], v[204:207], v[32:47]
    ds_read_b64_tr_b16 v[134:135], v4 offset:46848
    ds_read_b64_tr_b16 v[136:137], v4 offset:43520
    ds_read_b64_tr_b16 v[138:139], v4 offset:47104
    v_mfma_f32_32x32x16_bf16 v[48:63], v[164:167], v[204:207], v[48:63]
    ds_read_b64_tr_b16 v[140:141], v4 offset:43776
    ds_read_b64_tr_b16 v[142:143], v4 offset:47360
    ds_read_b64_tr_b16 v[144:145], v4 offset:44032
    v_mfma_f32_32x32x16_bf16 v[64:79], v[168:171], v[204:207], v[64:79]
    ds_read_b64_tr_b16 v[146:147], v4 offset:47616
    ds_read_b64_tr_b16 v[148:149], v4 offset:44288
    ds_read_b64_tr_b16 v[150:151], v4 offset:47872
    v_mfma_f32_32x32x16_bf16 v[80:95], v[172:175], v[204:207], v[80:95]
    ds_read_b64_tr_b16 v[152:153], v4 offset:44544
    ds_read_b64_tr_b16 v[154:155], v4 offset:48128
    v_mfma_f32_32x32x16_bf16 v[96:111], v[176:179], v[204:207], v[96:111]
    v_mfma_f32_32x32x16_bf16 v[112:127], v[180:183], v[204:207], v[112:127]
    buffer_load_dwordx4 v[204:207], v2, s[12:15], s34 offen offset:1024 sc1
    s_waitcnt vmcnt(7) lgkmcnt(0)
    v_mfma_f32_32x32x16_bf16 v[16:31], v[128:131], v[208:211], v[16:31]
    ds_read_b64_tr_b16 v[156:157], v4 offset:50176
    ds_read_b64_tr_b16 v[158:159], v4 offset:53760
    ds_read_b64_tr_b16 v[160:161], v4 offset:50432
    v_mfma_f32_32x32x16_bf16 v[32:47], v[132:135], v[208:211], v[32:47]
    ds_read_b64_tr_b16 v[162:163], v4 offset:54016
    ds_read_b64_tr_b16 v[164:165], v4 offset:50688
    ds_read_b64_tr_b16 v[166:167], v4 offset:54272
    v_mfma_f32_32x32x16_bf16 v[48:63], v[136:139], v[208:211], v[48:63]
    ds_read_b64_tr_b16 v[168:169], v4 offset:50944
    ds_read_b64_tr_b16 v[170:171], v4 offset:54528
    ds_read_b64_tr_b16 v[172:173], v4 offset:51200
    v_mfma_f32_32x32x16_bf16 v[64:79], v[140:143], v[208:211], v[64:79]
    ds_read_b64_tr_b16 v[174:175], v4 offset:54784
    ds_read_b64_tr_b16 v[176:177], v4 offset:51456
    ds_read_b64_tr_b16 v[178:179], v4 offset:55040
    v_mfma_f32_32x32x16_bf16 v[80:95], v[144:147], v[208:211], v[80:95]
    ds_read_b64_tr_b16 v[180:181], v4 offset:51712
    ds_read_b64_tr_b16 v[182:183], v4 offset:55296
    v_mfma_f32_32x32x16_bf16 v[96:111], v[148:151], v[208:211], v[96:111]
    v_mfma_f32_32x32x16_bf16 v[112:127], v[152:155], v[208:211], v[112:127]
    buffer_load_dwordx4 v[208:211], v2, s[12:15], s34 offen offset:2048 sc1
    s_waitcnt vmcnt(7) lgkmcnt(0)
    v_mfma_f32_32x32x16_bf16 v[16:31], v[156:159], v[212:215], v[16:31]
    ds_read_b64_tr_b16 v[128:129], v3 offset:0
    ds_read_b64_tr_b16 v[130:131], v3 offset:3584
    ds_read_b64_tr_b16 v[132:133], v3 offset:256
    v_mfma_f32_32x32x16_bf16 v[32:47], v[160:163], v[212:215], v[32:47]
    ds_read_b64_tr_b16 v[134:135], v3 offset:3840
    ds_read_b64_tr_b16 v[136:137], v3 offset:512
    ds_read_b64_tr_b16 v[138:139], v3 offset:4096
    v_mfma_f32_32x32x16_bf16 v[48:63], v[164:167], v[212:215], v[48:63]
    ds_read_b64_tr_b16 v[140:141], v3 offset:768
    ds_read_b64_tr_b16 v[142:143], v3 offset:4352
    ds_read_b64_tr_b16 v[144:145], v3 offset:1024
    v_mfma_f32_32x32x16_bf16 v[64:79], v[168:171], v[212:215], v[64:79]
    ds_read_b64_tr_b16 v[146:147], v3 offset:4608
    ds_read_b64_tr_b16 v[148:149], v3 offset:1280
    ds_read_b64_tr_b16 v[150:151], v3 offset:4864
    v_mfma_f32_32x32x16_bf16 v[80:95], v[172:175], v[212:215], v[80:95]
    ds_read_b64_tr_b16 v[152:153], v3 offset:1536
    ds_read_b64_tr_b16 v[154:155], v3 offset:5120
    v_mfma_f32_32x32x16_bf16 v[96:111], v[176:179], v[212:215], v[96:111]
    v_mfma_f32_32x32x16_bf16 v[112:127], v[180:183], v[212:215], v[112:127]
    buffer_load_dwordx4 v[212:215], v2, s[12:15], s34 offen offset:3072 sc1
    s_add_u32 s34, s34, 4096
    s_barrier
    s_waitcnt vmcnt(7) lgkmcnt(0)
    v_mfma_f32_32x32x16_bf16 v[16:31], v[128:131], v[184:187], v[16:31]
    ds_read_b64_tr_b16 v[156:157], v3 offset:7168
    ds_read_b64_tr_b16 v[158:159], v3 offset:10752
    ds_read_b64_tr_b16 v[160:161], v3 offset:7424
    v_mfma_f32_32x32x16_bf16 v[32:47], v[132:135], v[184:187], v[32:47]
    ds_read_b64_tr_b16 v[162:163], v3 offset:11008
    ds_read_b64_tr_b16 v[164:165], v3 offset:7680
    ds_read_b64_tr_b16 v[166:167], v3 offset:11264
    v_mfma_f32_32x32x16_bf16 v[48:63], v[136:139], v[184:187], v[48:63]
    ds_read_b64_tr_b16 v[168:169], v3 offset:7936
    ds_read_b64_tr_b16 v[170:171], v3 offset:11520
    ds_read_b64_tr_b16 v[172:173], v3 offset:8192
    v_mfma_f32_32x32x16_bf16 v[64:79], v[140:143], v[184:187], v[64:79]
    ds_read_b64_tr_b16 v[174:175], v3 offset:11776
    ds_read_b64_tr_b16 v[176:177], v3 offset:8448
    ds_read_b64_tr_b16 v[178:179], v3 offset:12032
    v_mfma_f32_32x32x16_bf16 v[80:95], v[144:147], v[184:187], v[80:95]
    ds_read_b64_tr_b16 v[180:181], v3 offset:8704
    ds_read_b64_tr_b16 v[182:183], v3 offset:12288
    v_mfma_f32_32x32x16_bf16 v[96:111], v[148:151], v[184:187], v[96:111]
    v_mfma_f32_32x32x16_bf16 v[112:127], v[152:155], v[184:187], v[112:127]
    buffer_load_dwordx4 v[184:187], v2, s[12:15], s34 offen offset:0 sc1
    s_waitcnt vmcnt(7) lgkmcnt(0)
    v_mfma_f32_32x32x16_bf16 v[16:31], v[156:159], v[188:191], v[16:31]
    ds_read_b64_tr_b16 v[128:129], v3 offset:14336
    ds_read_b64_tr_b16 v[130:131], v3 offset:17920
    ds_read_b64_tr_b16 v[132:133], v3 offset:14592
    v_mfma_f32_32x32x16_bf16 v[32:47], v[160:163], v[188:191], v[32:47]
    ds_read_b64_tr_b16 v[134:135], v3 offset:18176
    ds_read_b64_tr_b16 v[136:137], v3 offset:14848
    ds_read_b64_tr_b16 v[138:139], v3 offset:18432
    v_mfma_f32_32x32x16_bf16 v[48:63], v[164:167], v[188:191], v[48:63]
    ds_read_b64_tr_b16 v[140:141], v3 offset:15104
    ds_read_b64_tr_b16 v[142:143], v3 offset:18688
    ds_read_b64_tr_b16 v[144:145], v3 offset:15360
    v_mfma_f32_32x32x16_bf16 v[64:79], v[168:171], v[188:191], v[64:79]
    ds_read_b64_tr_b16 v[146:147], v3 offset:18944
    ds_read_b64_tr_b16 v[148:149], v3 offset:15616
    ds_read_b64_tr_b16 v[150:151], v3 offset:19200
    v_mfma_f32_32x32x16_bf16 v[80:95], v[172:175], v[188:191], v[80:95]
    ds_read_b64_tr_b16 v[152:153], v3 offset:15872
    ds_read_b64_tr_b16 v[154:155], v3 offset:19456
    v_mfma_f32_32x32x16_bf16 v[96:111], v[176:179], v[188:191], v[96:111]
    v_mfma_f32_32x32x16_bf16 v[112:127], v[180:183], v[188:191], v[112:127]
    buffer_load_dwordx4 v[188:191], v2, s[12:15], s34 offen offset:1024 sc1
    s_waitcnt vmcnt(7) lgkmcnt(0)
    v_mfma_f32_32x32x16_bf16 v[16:31], v[128:131], v[192:195], v[16:31]
    ds_read_b64_tr_b16 v[156:157], v3 offset:21504
    ds_read_b64_tr_b16 v[158:159], v3 offset:25088
    ds_read_b64_tr_b16 v[160:161], v3 offset:21760
    v_mfma_f32_32x32x16_bf16 v[32:47], v[132:135], v[192:195], v[32:47]
    ds_read_b64_tr_b16 v[162:163], v3 offset:25344
    ds_read_b64_tr_b16 v[164:165], v3 offset:22016
    ds_read_b64_tr_b16 v[166:167], v3 offset:25600
    v_mfma_f32_32x32x16_bf16 v[48:63], v[136:139], v[192:195], v[48:63]
    ds_read_b64_tr_b16 v[168:169], v3 offset:22272
    ds_read_b64_tr_b16 v[170:171], v3 offset:25856
    ds_read_b64_tr_b16 v[172:173], v3 offset:22528
    v_mfma_f32_32x32x16_bf16 v[64:79], v[140:143], v[192:195], v[64:79]
    ds_read_b64_tr_b16 v[174:175], v3 offset:26112
    ds_read_b64_tr_b16 v[176:177], v3 offset:22784
    ds_read_b64_tr_b16 v[178:179], v3 offset:26368
    v_mfma_f32_32x32x16_bf16 v[80:95], v[144:147], v[192:195], v[80:95]
    ds_read_b64_tr_b16 v[180:181], v3 offset:23040
    ds_read_b64_tr_b16 v[182:183], v3 offset:26624
    v_mfma_f32_32x32x16_bf16 v[96:111], v[148:151], v[192:195], v[96:111]
    v_mfma_f32_32x32x16_bf16 v[112:127], v[152:155], v[192:195], v[112:127]
    buffer_load_dwordx4 v[192:195], v2, s[12:15], s34 offen offset:2048 sc1
    s_waitcnt vmcnt(7) lgkmcnt(0)
    v_mfma_f32_32x32x16_bf16 v[16:31], v[156:159], v[196:199], v[16:31]
    ds_read_b64_tr_b16 v[128:129], v3 offset:28672
    ds_read_b64_tr_b16 v[130:131], v3 offset:32256
    ds_read_b64_tr_b16 v[132:133], v3 offset:28928
    v_mfma_f32_32x32x16_bf16 v[32:47], v[160:163], v[196:199], v[32:47]
    ds_read_b64_tr_b16 v[134:135], v3 offset:32512
    ds_read_b64_tr_b16 v[136:137], v3 offset:29184
    ds_read_b64_tr_b16 v[138:139], v3 offset:32768
    v_mfma_f32_32x32x16_bf16 v[48:63], v[164:167], v[196:199], v[48:63]
    ds_read_b64_tr_b16 v[140:141], v3 offset:29440
    ds_read_b64_tr_b16 v[142:143], v3 offset:33024
    ds_read_b64_tr_b16 v[144:145], v3 offset:29696
    v_mfma_f32_32x32x16_bf16 v[64:79], v[168:171], v[196:199], v[64:79]
    ds_read_b64_tr_b16 v[146:147], v3 offset:33280
    ds_read_b64_tr_b16 v[148:149], v3 offset:29952
    ds_read_b64_tr_b16 v[150:151], v3 offset:33536
    v_mfma_f32_32x32x16_bf16 v[80:95], v[172:175], v[196:199], v[80:95]
    ds_read_b64_tr_b16 v[152:153], v3 offset:30208
    ds_read_b64_tr_b16 v[154:155], v3 offset:33792
    v_mfma_f32_32x32x16_bf16 v[96:111], v[176:179], v[196:199], v[96:111]
    v_mfma_f32_32x32x16_bf16 v[112:127], v[180:183], v[196:199], v[112:127]
    buffer_load_dwordx4 v[196:199], v2, s[12:15], s34 offen offset:3072 sc1
    s_add_u32 s34, s34, 4096
    s_barrier
    s_waitcnt vmcnt(7) lgkmcnt(0)
    v_mfma_f32_32x32x16_bf16 v[16:31], v[128:131], v[200:203], v[16:31]
    ds_read_b64_tr_b16 v[156:157], v3 offset:35840
    ds_read_b64_tr_b16 v[158:159], v3 offset:39424
    ds_read_b64_tr_b16 v[160:161], v3 offset:36096
    v_mfma_f32_32x32x16_bf16 v[32:47], v[132:135], v[200:203], v[32:47]
    ds_read_b64_tr_b16 v[162:163], v3 offset:39680
    ds_read_b64_tr_b16 v[164:165], v3 offset:36352
    ds_read_b64_tr_b16 v[166:167], v3 offset:39936
    v_mfma_f32_32x32x16_bf16 v[48:63], v[136:139], v[200:203], v[48:63]
    ds_read_b64_tr_b16 v[168:169], v3 offset:36608
    ds_read_b64_tr_b16 v[170:171], v3 offset:40192
    ds_read_b64_tr_b16 v[172:173], v3 offset:36864
    v_mfma_f32_32x32x16_bf16 v[64:79], v[140:143], v[200:203], v[64:79]
    ds_read_b64_tr_b16 v[174:175], v3 offset:40448
    ds_read_b64_tr_b16 v[176:177], v3 offset:37120
    ds_read_b64_tr_b16 v[178:179], v3 offset:40704
    v_mfma_f32_32x32x16_bf16 v[80:95], v[144:147], v[200:203], v[80:95]
    ds_read_b64_tr_b16 v[180:181], v3 offset:37376
    ds_read_b64_tr_b16 v[182:183], v3 offset:40960
    v_mfma_f32_32x32x16_bf16 v[96:111], v[148:151], v[200:203], v[96:111]
    v_mfma_f32_32x32x16_bf16 v[112:127], v[152:155], v[200:203], v[112:127]
    buffer_load_dwordx4 v[200:203], v2, s[12:15], s34 offen offset:0 sc1
    s_waitcnt vmcnt(7) lgkmcnt(0)
    v_mfma_f32_32x32x16_bf16 v[16:31], v[156:159], v[204:207], v[16:31]
    ds_read_b64_tr_b16 v[128:129], v3 offset:43008
    ds_read_b64_tr_b16 v[130:131], v3 offset:46592
    ds_read_b64_tr_b16 v[132:133], v3 offset:43264
    v_mfma_f32_32x32x16_bf16 v[32:47], v[160:163], v[204:207], v[32:47]
    ds_read_b64_tr_b16 v[134:135], v3 offset:46848
    ds_read_b64_tr_b16 v[136:137], v3 offset:43520
    ds_read_b64_tr_b16 v[138:139], v3 offset:47104
    v_mfma_f32_32x32x16_bf16 v[48:63], v[164:167], v[204:207], v[48:63]
    ds_read_b64_tr_b16 v[140:141], v3 offset:43776
    ds_read_b64_tr_b16 v[142:143], v3 offset:47360
    ds_read_b64_tr_b16 v[144:145], v3 offset:44032
    v_mfma_f32_32x32x16_bf16 v[64:79], v[168:171], v[204:207], v[64:79]
    ds_read_b64_tr_b16 v[146:147], v3 offset:47616
    ds_read_b64_tr_b16 v[148:149], v3 offset:44288
    ds_read_b64_tr_b16 v[150:151], v3 offset:47872
    v_mfma_f32_32x32x16_bf16 v[80:95], v[172:175], v[204:207], v[80:95]
    ds_read_b64_tr_b16 v[152:153], v3 offset:44544
    ds_read_b64_tr_b16 v[154:155], v3 offset:48128
    v_mfma_f32_32x32x16_bf16 v[96:111], v[176:179], v[204:207], v[96:111]
    v_mfma_f32_32x32x16_bf16 v[112:127], v[180:183], v[204:207], v[112:127]
    buffer_load_dwordx4 v[204:207], v2, s[12:15], s34 offen offset:1024 sc1
    s_waitcnt vmcnt(7) lgkmcnt(0)
    v_mfma_f32_32x32x16_bf16 v[16:31], v[128:131], v[208:211], v[16:31]
    ds_read_b64_tr_b16 v[156:157], v3 offset:50176
    ds_read_b64_tr_b16 v[158:159], v3 offset:53760
    ds_read_b64_tr_b16 v[160:161], v3 offset:50432
    v_mfma_f32_32x32x16_bf16 v[32:47], v[132:135], v[208:211], v[32:47]
    ds_read_b64_tr_b16 v[162:163], v3 offset:54016
    ds_read_b64_tr_b16 v[164:165], v3 offset:50688
    ds_read_b64_tr_b16 v[166:167], v3 offset:54272
    v_mfma_f32_32x32x16_bf16 v[48:63], v[136:139], v[208:211], v[48:63]
    ds_read_b64_tr_b16 v[168:169], v3 offset:50944
    ds_read_b64_tr_b16 v[170:171], v3 offset:54528
    ds_read_b64_tr_b16 v[172:173], v3 offset:51200
    v_mfma_f32_32x32x16_bf16 v[64:79], v[140:143], v[208:211], v[64:79]
    ds_read_b64_tr_b16 v[174:175], v3 offset:54784
    ds_read_b64_tr_b16 v[176:177], v3 offset:51456
    ds_read_b64_tr_b16 v[178:179], v3 offset:55040
    v_mfma_f32_32x32x16_bf16 v[80:95], v[144:147], v[208:211], v[80:95]
    ds_read_b64_tr_b16 v[180:181], v3 offset:51712
    ds_read_b64_tr_b16 v[182:183], v3 offset:55296
    v_mfma_f32_32x32x16_bf16 v[96:111], v[148:151], v[208:211], v[96:111]
    v_mfma_f32_32x32x16_bf16 v[112:127], v[152:155], v[208:211], v[112:127]
    buffer_load_dwordx4 v[208:211], v2, s[12:15], s34 offen offset:2048 sc1
    s_waitcnt vmcnt(7) lgkmcnt(0)
    v_mfma_f32_32x32x16_bf16 v[16:31], v[156:159], v[212:215], v[16:31]
    ds_read_b64_tr_b16 v[128:129], v4 offset:0
    ds_read_b64_tr_b16 v[130:131], v4 offset:3584
    ds_read_b64_tr_b16 v[132:133], v4 offset:256
    v_mfma_f32_32x32x16_bf16 v[32:47], v[160:163], v[212:215], v[32:47]
    ds_read_b64_tr_b16 v[134:135], v4 offset:3840
    ds_read_b64_tr_b16 v[136:137], v4 offset:512
    ds_read_b64_tr_b16 v[138:139], v4 offset:4096
    v_mfma_f32_32x32x16_bf16 v[48:63], v[164:167], v[212:215], v[48:63]
    ds_read_b64_tr_b16 v[140:141], v4 offset:768
    ds_read_b64_tr_b16 v[142:143], v4 offset:4352
    ds_read_b64_tr_b16 v[144:145], v4 offset:1024
    v_mfma_f32_32x32x16_bf16 v[64:79], v[168:171], v[212:215], v[64:79]
    ds_read_b64_tr_b16 v[146:147], v4 offset:4608
    ds_read_b64_tr_b16 v[148:149], v4 offset:1280
    ds_read_b64_tr_b16 v[150:151], v4 offset:4864
    v_mfma_f32_32x32x16_bf16 v[80:95], v[172:175], v[212:215], v[80:95]
    ds_read_b64_tr_b16 v[152:153], v4 offset:1536
    ds_read_b64_tr_b16 v[154:155], v4 offset:5120
    v_mfma_f32_32x32x16_bf16 v[96:111], v[176:179], v[212:215], v[96:111]
    v_mfma_f32_32x32x16_bf16 v[112:127], v[180:183], v[212:215], v[112:127]
    buffer_load_dwordx4 v[212:215], v2, s[12:15], s34 offen offset:3072 sc1
    s_add_u32 s34, s34, 4096
    s_sub_u32 s41, s41, 1
    s_cmp_lg_u32 s41, 0
    s_cbranch_scc1 P4_LOOP
    s_waitcnt lgkmcnt(0)
    v_add_u32 v10, 114688, v2
    ds_read_b128 v[128:131], v10 offset:0
    ds_read_b128 v[132:135], v10 offset:1024
    ds_read_b128 v[136:139], v10 offset:2048
    ds_read_b128 v[140:143], v10 offset:3072
    ds_read_b128 v[144:147], v10 offset:4096
    ds_read_b128 v[148:151], v10 offset:5120
    ds_read_b128 v[152:155], v10 offset:6144
    s_lshl_b32 s36, s30, 10
    v_add_u32 v11, s36, v10
    ds_read_b128 v[156:159], v11 offset:7168
    v_and_b32 v11, 31, v1
    v_lshlrev_b32 v11, 2, v11
    s_lshl_b32 s36, s30, 7
    v_add_u32 v11, s36, v11
    v_add_u32 v11, 125952, v11
    ds_read_b32 v12, v11
    s_waitcnt lgkmcnt(0)
    s_barrier
    v_mfma_f32_32x32x16_bf16 v[16:31], v[128:131], v[156:159], v[16:31]
    v_mfma_f32_32x32x16_bf16 v[32:47], v[132:135], v[156:159], v[32:47]
    v_mfma_f32_32x32x16_bf16 v[48:63], v[136:139], v[156:159], v[48:63]
    v_mfma_f32_32x32x16_bf16 v[64:79], v[140:143], v[156:159], v[64:79]
    v_mfma_f32_32x32x16_bf16 v[80:95], v[144:147], v[156:159], v[80:95]
    v_mfma_f32_32x32x16_bf16 v[96:111], v[148:151], v[156:159], v[96:111]
    v_mfma_f32_32x32x16_bf16 v[112:127], v[152:155], v[156:159], v[112:127]
    s_waitcnt vmcnt(0)
    s_nop 15
    v_mul_f32 v6, 0xc0135761, v12
    v_mul_f32 v8, v12, v12
    v_mul_f32 v8, v8, v12
    v_mul_f32 v8, 0xbdd2d3e8, v8
    v_rcp_f32 v10, v12
    v_mov_b32 v7, v6
    v_mov_b32 v9, v8
    v_mov_b32 v11, v10
    s_lshl_b32 s36, s28, 2
    s_add_u32 s36, s36, s30
    s_mul_i32 s36, s36, 224
    s_mul_i32 s37, s29, 14
    s_add_u32 s36, s36, s37
    s_lshl_b32 s36, s36, 10
    v_pk_mul_f32 v[160:161], v[16:17], v[16:17]
    v_pk_mul_f32 v[162:163], v[18:19], v[18:19]
    v_pk_mul_f32 v[164:165], v[20:21], v[20:21]
    v_pk_mul_f32 v[166:167], v[22:23], v[22:23]
    v_pk_mul_f32 v[168:169], v[24:25], v[24:25]
    v_pk_mul_f32 v[170:171], v[26:27], v[26:27]
    v_pk_mul_f32 v[172:173], v[28:29], v[28:29]
    v_pk_mul_f32 v[174:175], v[30:31], v[30:31]
    v_pk_fma_f32 v[160:161], v[160:161], v[8:9], v[6:7]
    v_pk_fma_f32 v[162:163], v[162:163], v[8:9], v[6:7]
    v_pk_fma_f32 v[164:165], v[164:165], v[8:9], v[6:7]
    v_pk_fma_f32 v[166:167], v[166:167], v[8:9], v[6:7]
    v_pk_fma_f32 v[168:169], v[168:169], v[8:9], v[6:7]
    v_pk_fma_f32 v[170:171], v[170:171], v[8:9], v[6:7]
    v_pk_fma_f32 v[172:173], v[172:173], v[8:9], v[6:7]
    v_pk_fma_f32 v[174:175], v[174:175], v[8:9], v[6:7]
    v_pk_mul_f32 v[160:161], v[160:161], v[16:17]
    v_pk_mul_f32 v[162:163], v[162:163], v[18:19]
    v_pk_mul_f32 v[164:165], v[164:165], v[20:21]
    v_pk_mul_f32 v[166:167], v[166:167], v[22:23]
    v_pk_mul_f32 v[168:169], v[168:169], v[24:25]
    v_pk_mul_f32 v[170:171], v[170:171], v[26:27]
    v_pk_mul_f32 v[172:173], v[172:173], v[28:29]
    v_pk_mul_f32 v[174:175], v[174:175], v[30:31]
    v_exp_f32 v160, v160
    v_exp_f32 v161, v161
    v_exp_f32 v162, v162
    v_exp_f32 v163, v163
    v_exp_f32 v164, v164
    v_exp_f32 v165, v165
    v_exp_f32 v166, v166
    v_exp_f32 v167, v167
    v_exp_f32 v168, v168
    v_exp_f32 v169, v169
    v_exp_f32 v170, v170
    v_exp_f32 v171, v171
    v_exp_f32 v172, v172
    v_exp_f32 v173, v173
    v_exp_f32 v174, v174
    v_exp_f32 v175, v175
    v_pk_fma_f32 v[160:161], v[160:161], v[10:11], v[10:11]
    v_pk_fma_f32 v[162:163], v[162:163], v[10:11], v[10:11]
    v_pk_fma_f32 v[164:165], v[164:165], v[10:11], v[10:11]
    v_pk_fma_f32 v[166:167], v[166:167], v[10:11], v[10:11]
    v_pk_fma_f32 v[168:169], v[168:169], v[10:11], v[10:11]
    v_pk_fma_f32 v[170:171], v[170:171], v[10:11], v[10:11]
    v_pk_fma_f32 v[172:173], v[172:173], v[10:11], v[10:11]
    v_pk_fma_f32 v[174:175], v[174:175], v[10:11], v[10:11]
    v_rcp_f32 v160, v160
    v_rcp_f32 v161, v161
    v_rcp_f32 v162, v162
    v_rcp_f32 v163, v163
    v_rcp_f32 v164, v164
    v_rcp_f32 v165, v165
    v_rcp_f32 v166, v166
    v_rcp_f32 v167, v167
    v_rcp_f32 v168, v168
    v_rcp_f32 v169, v169
    v_rcp_f32 v170, v170
    v_rcp_f32 v171, v171
    v_rcp_f32 v172, v172
    v_rcp_f32 v173, v173
    v_rcp_f32 v174, v174
    v_rcp_f32 v175, v175
    v_pk_mul_f32 v[160:161], v[160:161], v[16:17]
    v_pk_mul_f32 v[162:163], v[162:163], v[18:19]
    v_pk_mul_f32 v[164:165], v[164:165], v[20:21]
    v_pk_mul_f32 v[166:167], v[166:167], v[22:23]
    v_pk_mul_f32 v[168:169], v[168:169], v[24:25]
    v_pk_mul_f32 v[170:171], v[170:171], v[26:27]
    v_pk_mul_f32 v[172:173], v[172:173], v[28:29]
    v_pk_mul_f32 v[174:175], v[174:175], v[30:31]
    v_cvt_pk_bf16_f32 v176, v160, v161
    v_cvt_pk_bf16_f32 v177, v162, v163
    v_cvt_pk_bf16_f32 v178, v164, v165
    v_cvt_pk_bf16_f32 v179, v166, v167
    v_cvt_pk_bf16_f32 v180, v168, v169
    v_cvt_pk_bf16_f32 v181, v170, v171
    v_cvt_pk_bf16_f32 v182, v172, v173
    v_cvt_pk_bf16_f32 v183, v174, v175
    buffer_store_dwordx4 v[176:179], v2, s[24:27], s36 offen offset:0 sc1
    buffer_store_dwordx4 v[180:183], v2, s[24:27], s36 offen offset:1024 sc1
    v_pk_mul_f32 v[160:161], v[32:33], v[32:33]
    v_pk_mul_f32 v[162:163], v[34:35], v[34:35]
    v_pk_mul_f32 v[164:165], v[36:37], v[36:37]
    v_pk_mul_f32 v[166:167], v[38:39], v[38:39]
    v_pk_mul_f32 v[168:169], v[40:41], v[40:41]
    v_pk_mul_f32 v[170:171], v[42:43], v[42:43]
    v_pk_mul_f32 v[172:173], v[44:45], v[44:45]
    v_pk_mul_f32 v[174:175], v[46:47], v[46:47]
    v_pk_fma_f32 v[160:161], v[160:161], v[8:9], v[6:7]
    v_pk_fma_f32 v[162:163], v[162:163], v[8:9], v[6:7]
    v_pk_fma_f32 v[164:165], v[164:165], v[8:9], v[6:7]
    v_pk_fma_f32 v[166:167], v[166:167], v[8:9], v[6:7]
    v_pk_fma_f32 v[168:169], v[168:169], v[8:9], v[6:7]
    v_pk_fma_f32 v[170:171], v[170:171], v[8:9], v[6:7]
    v_pk_fma_f32 v[172:173], v[172:173], v[8:9], v[6:7]
    v_pk_fma_f32 v[174:175], v[174:175], v[8:9], v[6:7]
    v_pk_mul_f32 v[160:161], v[160:161], v[32:33]
    v_pk_mul_f32 v[162:163], v[162:163], v[34:35]
    v_pk_mul_f32 v[164:165], v[164:165], v[36:37]
    v_pk_mul_f32 v[166:167], v[166:167], v[38:39]
    v_pk_mul_f32 v[168:169], v[168:169], v[40:41]
    v_pk_mul_f32 v[170:171], v[170:171], v[42:43]
    v_pk_mul_f32 v[172:173], v[172:173], v[44:45]
    v_pk_mul_f32 v[174:175], v[174:175], v[46:47]
    v_exp_f32 v160, v160
    v_exp_f32 v161, v161
    v_exp_f32 v162, v162
    v_exp_f32 v163, v163
    v_exp_f32 v164, v164
    v_exp_f32 v165, v165
    v_exp_f32 v166, v166
    v_exp_f32 v167, v167
    v_exp_f32 v168, v168
    v_exp_f32 v169, v169
    v_exp_f32 v170, v170
    v_exp_f32 v171, v171
    v_exp_f32 v172, v172
    v_exp_f32 v173, v173
    v_exp_f32 v174, v174
    v_exp_f32 v175, v175
    v_pk_fma_f32 v[160:161], v[160:161], v[10:11], v[10:11]
    v_pk_fma_f32 v[162:163], v[162:163], v[10:11], v[10:11]
    v_pk_fma_f32 v[164:165], v[164:165], v[10:11], v[10:11]
    v_pk_fma_f32 v[166:167], v[166:167], v[10:11], v[10:11]
    v_pk_fma_f32 v[168:169], v[168:169], v[10:11], v[10:11]
    v_pk_fma_f32 v[170:171], v[170:171], v[10:11], v[10:11]
    v_pk_fma_f32 v[172:173], v[172:173], v[10:11], v[10:11]
    v_pk_fma_f32 v[174:175], v[174:175], v[10:11], v[10:11]
    v_rcp_f32 v160, v160
    v_rcp_f32 v161, v161
    v_rcp_f32 v162, v162
    v_rcp_f32 v163, v163
    v_rcp_f32 v164, v164
    v_rcp_f32 v165, v165
    v_rcp_f32 v166, v166
    v_rcp_f32 v167, v167
    v_rcp_f32 v168, v168
    v_rcp_f32 v169, v169
    v_rcp_f32 v170, v170
    v_rcp_f32 v171, v171
    v_rcp_f32 v172, v172
    v_rcp_f32 v173, v173
    v_rcp_f32 v174, v174
    v_rcp_f32 v175, v175
    v_pk_mul_f32 v[160:161], v[160:161], v[32:33]
    v_pk_mul_f32 v[162:163], v[162:163], v[34:35]
    v_pk_mul_f32 v[164:165], v[164:165], v[36:37]
    v_pk_mul_f32 v[166:167], v[166:167], v[38:39]
    v_pk_mul_f32 v[168:169], v[168:169], v[40:41]
    v_pk_mul_f32 v[170:171], v[170:171], v[42:43]
    v_pk_mul_f32 v[172:173], v[172:173], v[44:45]
    v_pk_mul_f32 v[174:175], v[174:175], v[46:47]
    v_cvt_pk_bf16_f32 v184, v160, v161
    v_cvt_pk_bf16_f32 v185, v162, v163
    v_cvt_pk_bf16_f32 v186, v164, v165
    v_cvt_pk_bf16_f32 v187, v166, v167
    v_cvt_pk_bf16_f32 v188, v168, v169
    v_cvt_pk_bf16_f32 v189, v170, v171
    v_cvt_pk_bf16_f32 v190, v172, v173
    v_cvt_pk_bf16_f32 v191, v174, v175
    buffer_store_dwordx4 v[184:187], v2, s[24:27], s36 offen offset:2048 sc1
    buffer_store_dwordx4 v[188:191], v2, s[24:27], s36 offen offset:3072 sc1
    v_pk_mul_f32 v[160:161], v[48:49], v[48:49]
    v_pk_mul_f32 v[162:163], v[50:51], v[50:51]
    v_pk_mul_f32 v[164:165], v[52:53], v[52:53]
    v_pk_mul_f32 v[166:167], v[54:55], v[54:55]
    v_pk_mul_f32 v[168:169], v[56:57], v[56:57]
    v_pk_mul_f32 v[170:171], v[58:59], v[58:59]
    v_pk_mul_f32 v[172:173], v[60:61], v[60:61]
    v_pk_mul_f32 v[174:175], v[62:63], v[62:63]
    v_pk_fma_f32 v[160:161], v[160:161], v[8:9], v[6:7]
    v_pk_fma_f32 v[162:163], v[162:163], v[8:9], v[6:7]
    v_pk_fma_f32 v[164:165], v[164:165], v[8:9], v[6:7]
    v_pk_fma_f32 v[166:167], v[166:167], v[8:9], v[6:7]
    v_pk_fma_f32 v[168:169], v[168:169], v[8:9], v[6:7]
    v_pk_fma_f32 v[170:171], v[170:171], v[8:9], v[6:7]
    v_pk_fma_f32 v[172:173], v[172:173], v[8:9], v[6:7]
    v_pk_fma_f32 v[174:175], v[174:175], v[8:9], v[6:7]
    v_pk_mul_f32 v[160:161], v[160:161], v[48:49]
    v_pk_mul_f32 v[162:163], v[162:163], v[50:51]
    v_pk_mul_f32 v[164:165], v[164:165], v[52:53]
    v_pk_mul_f32 v[166:167], v[166:167], v[54:55]
    v_pk_mul_f32 v[168:169], v[168:169], v[56:57]
    v_pk_mul_f32 v[170:171], v[170:171], v[58:59]
    v_pk_mul_f32 v[172:173], v[172:173], v[60:61]
    v_pk_mul_f32 v[174:175], v[174:175], v[62:63]
    v_exp_f32 v160, v160
    v_exp_f32 v161, v161
    v_exp_f32 v162, v162
    v_exp_f32 v163, v163
    v_exp_f32 v164, v164
    v_exp_f32 v165, v165
    v_exp_f32 v166, v166
    v_exp_f32 v167, v167
    v_exp_f32 v168, v168
    v_exp_f32 v169, v169
    v_exp_f32 v170, v170
    v_exp_f32 v171, v171
    v_exp_f32 v172, v172
    v_exp_f32 v173, v173
    v_exp_f32 v174, v174
    v_exp_f32 v175, v175
    v_pk_fma_f32 v[160:161], v[160:161], v[10:11], v[10:11]
    v_pk_fma_f32 v[162:163], v[162:163], v[10:11], v[10:11]
    v_pk_fma_f32 v[164:165], v[164:165], v[10:11], v[10:11]
    v_pk_fma_f32 v[166:167], v[166:167], v[10:11], v[10:11]
    v_pk_fma_f32 v[168:169], v[168:169], v[10:11], v[10:11]
    v_pk_fma_f32 v[170:171], v[170:171], v[10:11], v[10:11]
    v_pk_fma_f32 v[172:173], v[172:173], v[10:11], v[10:11]
    v_pk_fma_f32 v[174:175], v[174:175], v[10:11], v[10:11]
    v_rcp_f32 v160, v160
    v_rcp_f32 v161, v161
    v_rcp_f32 v162, v162
    v_rcp_f32 v163, v163
    v_rcp_f32 v164, v164
    v_rcp_f32 v165, v165
    v_rcp_f32 v166, v166
    v_rcp_f32 v167, v167
    v_rcp_f32 v168, v168
    v_rcp_f32 v169, v169
    v_rcp_f32 v170, v170
    v_rcp_f32 v171, v171
    v_rcp_f32 v172, v172
    v_rcp_f32 v173, v173
    v_rcp_f32 v174, v174
    v_rcp_f32 v175, v175
    v_pk_mul_f32 v[160:161], v[160:161], v[48:49]
    v_pk_mul_f32 v[162:163], v[162:163], v[50:51]
    v_pk_mul_f32 v[164:165], v[164:165], v[52:53]
    v_pk_mul_f32 v[166:167], v[166:167], v[54:55]
    v_pk_mul_f32 v[168:169], v[168:169], v[56:57]
    v_pk_mul_f32 v[170:171], v[170:171], v[58:59]
    v_pk_mul_f32 v[172:173], v[172:173], v[60:61]
    v_pk_mul_f32 v[174:175], v[174:175], v[62:63]
    v_cvt_pk_bf16_f32 v176, v160, v161
    v_cvt_pk_bf16_f32 v177, v162, v163
    v_cvt_pk_bf16_f32 v178, v164, v165
    v_cvt_pk_bf16_f32 v179, v166, v167
    v_cvt_pk_bf16_f32 v180, v168, v169
    v_cvt_pk_bf16_f32 v181, v170, v171
    v_cvt_pk_bf16_f32 v182, v172, v173
    v_cvt_pk_bf16_f32 v183, v174, v175
    s_add_u32 s36, s36, 4096
    buffer_store_dwordx4 v[176:179], v2, s[24:27], s36 offen offset:0 sc1
    buffer_store_dwordx4 v[180:183], v2, s[24:27], s36 offen offset:1024 sc1
    v_pk_mul_f32 v[160:161], v[64:65], v[64:65]
    v_pk_mul_f32 v[162:163], v[66:67], v[66:67]
    v_pk_mul_f32 v[164:165], v[68:69], v[68:69]
    v_pk_mul_f32 v[166:167], v[70:71], v[70:71]
    v_pk_mul_f32 v[168:169], v[72:73], v[72:73]
    v_pk_mul_f32 v[170:171], v[74:75], v[74:75]
    v_pk_mul_f32 v[172:173], v[76:77], v[76:77]
    v_pk_mul_f32 v[174:175], v[78:79], v[78:79]
    v_pk_fma_f32 v[160:161], v[160:161], v[8:9], v[6:7]
    v_pk_fma_f32 v[162:163], v[162:163], v[8:9], v[6:7]
    v_pk_fma_f32 v[164:165], v[164:165], v[8:9], v[6:7]
    v_pk_fma_f32 v[166:167], v[166:167], v[8:9], v[6:7]
    v_pk_fma_f32 v[168:169], v[168:169], v[8:9], v[6:7]
    v_pk_fma_f32 v[170:171], v[170:171], v[8:9], v[6:7]
    v_pk_fma_f32 v[172:173], v[172:173], v[8:9], v[6:7]
    v_pk_fma_f32 v[174:175], v[174:175], v[8:9], v[6:7]
    v_pk_mul_f32 v[160:161], v[160:161], v[64:65]
    v_pk_mul_f32 v[162:163], v[162:163], v[66:67]
    v_pk_mul_f32 v[164:165], v[164:165], v[68:69]
    v_pk_mul_f32 v[166:167], v[166:167], v[70:71]
    v_pk_mul_f32 v[168:169], v[168:169], v[72:73]
    v_pk_mul_f32 v[170:171], v[170:171], v[74:75]
    v_pk_mul_f32 v[172:173], v[172:173], v[76:77]
    v_pk_mul_f32 v[174:175], v[174:175], v[78:79]
    v_exp_f32 v160, v160
    v_exp_f32 v161, v161
    v_exp_f32 v162, v162
    v_exp_f32 v163, v163
    v_exp_f32 v164, v164
    v_exp_f32 v165, v165
    v_exp_f32 v166, v166
    v_exp_f32 v167, v167
    v_exp_f32 v168, v168
    v_exp_f32 v169, v169
    v_exp_f32 v170, v170
    v_exp_f32 v171, v171
    v_exp_f32 v172, v172
    v_exp_f32 v173, v173
    v_exp_f32 v174, v174
    v_exp_f32 v175, v175
    v_pk_fma_f32 v[160:161], v[160:161], v[10:11], v[10:11]
    v_pk_fma_f32 v[162:163], v[162:163], v[10:11], v[10:11]
    v_pk_fma_f32 v[164:165], v[164:165], v[10:11], v[10:11]
    v_pk_fma_f32 v[166:167], v[166:167], v[10:11], v[10:11]
    v_pk_fma_f32 v[168:169], v[168:169], v[10:11], v[10:11]
    v_pk_fma_f32 v[170:171], v[170:171], v[10:11], v[10:11]
    v_pk_fma_f32 v[172:173], v[172:173], v[10:11], v[10:11]
    v_pk_fma_f32 v[174:175], v[174:175], v[10:11], v[10:11]
    v_rcp_f32 v160, v160
    v_rcp_f32 v161, v161
    v_rcp_f32 v162, v162
    v_rcp_f32 v163, v163
    v_rcp_f32 v164, v164
    v_rcp_f32 v165, v165
    v_rcp_f32 v166, v166
    v_rcp_f32 v167, v167
    v_rcp_f32 v168, v168
    v_rcp_f32 v169, v169
    v_rcp_f32 v170, v170
    v_rcp_f32 v171, v171
    v_rcp_f32 v172, v172
    v_rcp_f32 v173, v173
    v_rcp_f32 v174, v174
    v_rcp_f32 v175, v175
    v_pk_mul_f32 v[160:161], v[160:161], v[64:65]
    v_pk_mul_f32 v[162:163], v[162:163], v[66:67]
    v_pk_mul_f32 v[164:165], v[164:165], v[68:69]
    v_pk_mul_f32 v[166:167], v[166:167], v[70:71]
    v_pk_mul_f32 v[168:169], v[168:169], v[72:73]
    v_pk_mul_f32 v[170:171], v[170:171], v[74:75]
    v_pk_mul_f32 v[172:173], v[172:173], v[76:77]
    v_pk_mul_f32 v[174:175], v[174:175], v[78:79]
    v_cvt_pk_bf16_f32 v184, v160, v161
    v_cvt_pk_bf16_f32 v185, v162, v163
    v_cvt_pk_bf16_f32 v186, v164, v165
    v_cvt_pk_bf16_f32 v187, v166, v167
    v_cvt_pk_bf16_f32 v188, v168, v169
    v_cvt_pk_bf16_f32 v189, v170, v171
    v_cvt_pk_bf16_f32 v190, v172, v173
    v_cvt_pk_bf16_f32 v191, v174, v175
    buffer_store_dwordx4 v[184:187], v2, s[24:27], s36 offen offset:2048 sc1
    buffer_store_dwordx4 v[188:191], v2, s[24:27], s36 offen offset:3072 sc1
    v_pk_mul_f32 v[160:161], v[80:81], v[80:81]
    v_pk_mul_f32 v[162:163], v[82:83], v[82:83]
    v_pk_mul_f32 v[164:165], v[84:85], v[84:85]
    v_pk_mul_f32 v[166:167], v[86:87], v[86:87]
    v_pk_mul_f32 v[168:169], v[88:89], v[88:89]
    v_pk_mul_f32 v[170:171], v[90:91], v[90:91]
    v_pk_mul_f32 v[172:173], v[92:93], v[92:93]
    v_pk_mul_f32 v[174:175], v[94:95], v[94:95]
    v_pk_fma_f32 v[160:161], v[160:161], v[8:9], v[6:7]
    v_pk_fma_f32 v[162:163], v[162:163], v[8:9], v[6:7]
    v_pk_fma_f32 v[164:165], v[164:165], v[8:9], v[6:7]
    v_pk_fma_f32 v[166:167], v[166:167], v[8:9], v[6:7]
    v_pk_fma_f32 v[168:169], v[168:169], v[8:9], v[6:7]
    v_pk_fma_f32 v[170:171], v[170:171], v[8:9], v[6:7]
    v_pk_fma_f32 v[172:173], v[172:173], v[8:9], v[6:7]
    v_pk_fma_f32 v[174:175], v[174:175], v[8:9], v[6:7]
    v_pk_mul_f32 v[160:161], v[160:161], v[80:81]
    v_pk_mul_f32 v[162:163], v[162:163], v[82:83]
    v_pk_mul_f32 v[164:165], v[164:165], v[84:85]
    v_pk_mul_f32 v[166:167], v[166:167], v[86:87]
    v_pk_mul_f32 v[168:169], v[168:169], v[88:89]
    v_pk_mul_f32 v[170:171], v[170:171], v[90:91]
    v_pk_mul_f32 v[172:173], v[172:173], v[92:93]
    v_pk_mul_f32 v[174:175], v[174:175], v[94:95]
    v_exp_f32 v160, v160
    v_exp_f32 v161, v161
    v_exp_f32 v162, v162
    v_exp_f32 v163, v163
    v_exp_f32 v164, v164
    v_exp_f32 v165, v165
    v_exp_f32 v166, v166
    v_exp_f32 v167, v167
    v_exp_f32 v168, v168
    v_exp_f32 v169, v169
    v_exp_f32 v170, v170
    v_exp_f32 v171, v171
    v_exp_f32 v172, v172
    v_exp_f32 v173, v173
    v_exp_f32 v174, v174
    v_exp_f32 v175, v175
    v_pk_fma_f32 v[160:161], v[160:161], v[10:11], v[10:11]
    v_pk_fma_f32 v[162:163], v[162:163], v[10:11], v[10:11]
    v_pk_fma_f32 v[164:165], v[164:165], v[10:11], v[10:11]
    v_pk_fma_f32 v[166:167], v[166:167], v[10:11], v[10:11]
    v_pk_fma_f32 v[168:169], v[168:169], v[10:11], v[10:11]
    v_pk_fma_f32 v[170:171], v[170:171], v[10:11], v[10:11]
    v_pk_fma_f32 v[172:173], v[172:173], v[10:11], v[10:11]
    v_pk_fma_f32 v[174:175], v[174:175], v[10:11], v[10:11]
    v_rcp_f32 v160, v160
    v_rcp_f32 v161, v161
    v_rcp_f32 v162, v162
    v_rcp_f32 v163, v163
    v_rcp_f32 v164, v164
    v_rcp_f32 v165, v165
    v_rcp_f32 v166, v166
    v_rcp_f32 v167, v167
    v_rcp_f32 v168, v168
    v_rcp_f32 v169, v169
    v_rcp_f32 v170, v170
    v_rcp_f32 v171, v171
    v_rcp_f32 v172, v172
    v_rcp_f32 v173, v173
    v_rcp_f32 v174, v174
    v_rcp_f32 v175, v175
    v_pk_mul_f32 v[160:161], v[160:161], v[80:81]
    v_pk_mul_f32 v[162:163], v[162:163], v[82:83]
    v_pk_mul_f32 v[164:165], v[164:165], v[84:85]
    v_pk_mul_f32 v[166:167], v[166:167], v[86:87]
    v_pk_mul_f32 v[168:169], v[168:169], v[88:89]
    v_pk_mul_f32 v[170:171], v[170:171], v[90:91]
    v_pk_mul_f32 v[172:173], v[172:173], v[92:93]
    v_pk_mul_f32 v[174:175], v[174:175], v[94:95]
    v_cvt_pk_bf16_f32 v176, v160, v161
    v_cvt_pk_bf16_f32 v177, v162, v163
    v_cvt_pk_bf16_f32 v178, v164, v165
    v_cvt_pk_bf16_f32 v179, v166, v167
    v_cvt_pk_bf16_f32 v180, v168, v169
    v_cvt_pk_bf16_f32 v181, v170, v171
    v_cvt_pk_bf16_f32 v182, v172, v173
    v_cvt_pk_bf16_f32 v183, v174, v175
    s_add_u32 s36, s36, 4096
    buffer_store_dwordx4 v[176:179], v2, s[24:27], s36 offen offset:0 sc1
    buffer_store_dwordx4 v[180:183], v2, s[24:27], s36 offen offset:1024 sc1
    v_pk_mul_f32 v[160:161], v[96:97], v[96:97]
    v_pk_mul_f32 v[162:163], v[98:99], v[98:99]
    v_pk_mul_f32 v[164:165], v[100:101], v[100:101]
    v_pk_mul_f32 v[166:167], v[102:103], v[102:103]
    v_pk_mul_f32 v[168:169], v[104:105], v[104:105]
    v_pk_mul_f32 v[170:171], v[106:107], v[106:107]
    v_pk_mul_f32 v[172:173], v[108:109], v[108:109]
    v_pk_mul_f32 v[174:175], v[110:111], v[110:111]
    v_pk_fma_f32 v[160:161], v[160:161], v[8:9], v[6:7]
    v_pk_fma_f32 v[162:163], v[162:163], v[8:9], v[6:7]
    v_pk_fma_f32 v[164:165], v[164:165], v[8:9], v[6:7]
    v_pk_fma_f32 v[166:167], v[166:167], v[8:9], v[6:7]
    v_pk_fma_f32 v[168:169], v[168:169], v[8:9], v[6:7]
    v_pk_fma_f32 v[170:171], v[170:171], v[8:9], v[6:7]
    v_pk_fma_f32 v[172:173], v[172:173], v[8:9], v[6:7]
    v_pk_fma_f32 v[174:175], v[174:175], v[8:9], v[6:7]
    v_pk_mul_f32 v[160:161], v[160:161], v[96:97]
    v_pk_mul_f32 v[162:163], v[162:163], v[98:99]
    v_pk_mul_f32 v[164:165], v[164:165], v[100:101]
    v_pk_mul_f32 v[166:167], v[166:167], v[102:103]
    v_pk_mul_f32 v[168:169], v[168:169], v[104:105]
    v_pk_mul_f32 v[170:171], v[170:171], v[106:107]
    v_pk_mul_f32 v[172:173], v[172:173], v[108:109]
    v_pk_mul_f32 v[174:175], v[174:175], v[110:111]
    v_exp_f32 v160, v160
    v_exp_f32 v161, v161
    v_exp_f32 v162, v162
    v_exp_f32 v163, v163
    v_exp_f32 v164, v164
    v_exp_f32 v165, v165
    v_exp_f32 v166, v166
    v_exp_f32 v167, v167
    v_exp_f32 v168, v168
    v_exp_f32 v169, v169
    v_exp_f32 v170, v170
    v_exp_f32 v171, v171
    v_exp_f32 v172, v172
    v_exp_f32 v173, v173
    v_exp_f32 v174, v174
    v_exp_f32 v175, v175
    v_pk_fma_f32 v[160:161], v[160:161], v[10:11], v[10:11]
    v_pk_fma_f32 v[162:163], v[162:163], v[10:11], v[10:11]
    v_pk_fma_f32 v[164:165], v[164:165], v[10:11], v[10:11]
    v_pk_fma_f32 v[166:167], v[166:167], v[10:11], v[10:11]
    v_pk_fma_f32 v[168:169], v[168:169], v[10:11], v[10:11]
    v_pk_fma_f32 v[170:171], v[170:171], v[10:11], v[10:11]
    v_pk_fma_f32 v[172:173], v[172:173], v[10:11], v[10:11]
    v_pk_fma_f32 v[174:175], v[174:175], v[10:11], v[10:11]
    v_rcp_f32 v160, v160
    v_rcp_f32 v161, v161
    v_rcp_f32 v162, v162
    v_rcp_f32 v163, v163
    v_rcp_f32 v164, v164
    v_rcp_f32 v165, v165
    v_rcp_f32 v166, v166
    v_rcp_f32 v167, v167
    v_rcp_f32 v168, v168
    v_rcp_f32 v169, v169
    v_rcp_f32 v170, v170
    v_rcp_f32 v171, v171
    v_rcp_f32 v172, v172
    v_rcp_f32 v173, v173
    v_rcp_f32 v174, v174
    v_rcp_f32 v175, v175
    v_pk_mul_f32 v[160:161], v[160:161], v[96:97]
    v_pk_mul_f32 v[162:163], v[162:163], v[98:99]
    v_pk_mul_f32 v[164:165], v[164:165], v[100:101]
    v_pk_mul_f32 v[166:167], v[166:167], v[102:103]
    v_pk_mul_f32 v[168:169], v[168:169], v[104:105]
    v_pk_mul_f32 v[170:171], v[170:171], v[106:107]
    v_pk_mul_f32 v[172:173], v[172:173], v[108:109]
    v_pk_mul_f32 v[174:175], v[174:175], v[110:111]
    v_cvt_pk_bf16_f32 v184, v160, v161
    v_cvt_pk_bf16_f32 v185, v162, v163
    v_cvt_pk_bf16_f32 v186, v164, v165
    v_cvt_pk_bf16_f32 v187, v166, v167
    v_cvt_pk_bf16_f32 v188, v168, v169
    v_cvt_pk_bf16_f32 v189, v170, v171
    v_cvt_pk_bf16_f32 v190, v172, v173
    v_cvt_pk_bf16_f32 v191, v174, v175
    buffer_store_dwordx4 v[184:187], v2, s[24:27], s36 offen offset:2048 sc1
    buffer_store_dwordx4 v[188:191], v2, s[24:27], s36 offen offset:3072 sc1
    v_pk_mul_f32 v[160:161], v[112:113], v[112:113]
    v_pk_mul_f32 v[162:163], v[114:115], v[114:115]
    v_pk_mul_f32 v[164:165], v[116:117], v[116:117]
    v_pk_mul_f32 v[166:167], v[118:119], v[118:119]
    v_pk_mul_f32 v[168:169], v[120:121], v[120:121]
    v_pk_mul_f32 v[170:171], v[122:123], v[122:123]
    v_pk_mul_f32 v[172:173], v[124:125], v[124:125]
    v_pk_mul_f32 v[174:175], v[126:127], v[126:127]
    v_pk_fma_f32 v[160:161], v[160:161], v[8:9], v[6:7]
    v_pk_fma_f32 v[162:163], v[162:163], v[8:9], v[6:7]
    v_pk_fma_f32 v[164:165], v[164:165], v[8:9], v[6:7]
    v_pk_fma_f32 v[166:167], v[166:167], v[8:9], v[6:7]
    v_pk_fma_f32 v[168:169], v[168:169], v[8:9], v[6:7]
    v_pk_fma_f32 v[170:171], v[170:171], v[8:9], v[6:7]
    v_pk_fma_f32 v[172:173], v[172:173], v[8:9], v[6:7]
    v_pk_fma_f32 v[174:175], v[174:175], v[8:9], v[6:7]
    v_pk_mul_f32 v[160:161], v[160:161], v[112:113]
    v_pk_mul_f32 v[162:163], v[162:163], v[114:115]
    v_pk_mul_f32 v[164:165], v[164:165], v[116:117]
    v_pk_mul_f32 v[166:167], v[166:167], v[118:119]
    v_pk_mul_f32 v[168:169], v[168:169], v[120:121]
    v_pk_mul_f32 v[170:171], v[170:171], v[122:123]
    v_pk_mul_f32 v[172:173], v[172:173], v[124:125]
    v_pk_mul_f32 v[174:175], v[174:175], v[126:127]
    v_exp_f32 v160, v160
    v_exp_f32 v161, v161
    v_exp_f32 v162, v162
    v_exp_f32 v163, v163
    v_exp_f32 v164, v164
    v_exp_f32 v165, v165
    v_exp_f32 v166, v166
    v_exp_f32 v167, v167
    v_exp_f32 v168, v168
    v_exp_f32 v169, v169
    v_exp_f32 v170, v170
    v_exp_f32 v171, v171
    v_exp_f32 v172, v172
    v_exp_f32 v173, v173
    v_exp_f32 v174, v174
    v_exp_f32 v175, v175
    v_pk_fma_f32 v[160:161], v[160:161], v[10:11], v[10:11]
    v_pk_fma_f32 v[162:163], v[162:163], v[10:11], v[10:11]
    v_pk_fma_f32 v[164:165], v[164:165], v[10:11], v[10:11]
    v_pk_fma_f32 v[166:167], v[166:167], v[10:11], v[10:11]
    v_pk_fma_f32 v[168:169], v[168:169], v[10:11], v[10:11]
    v_pk_fma_f32 v[170:171], v[170:171], v[10:11], v[10:11]
    v_pk_fma_f32 v[172:173], v[172:173], v[10:11], v[10:11]
    v_pk_fma_f32 v[174:175], v[174:175], v[10:11], v[10:11]
    v_rcp_f32 v160, v160
    v_rcp_f32 v161, v161
    v_rcp_f32 v162, v162
    v_rcp_f32 v163, v163
    v_rcp_f32 v164, v164
    v_rcp_f32 v165, v165
    v_rcp_f32 v166, v166
    v_rcp_f32 v167, v167
    v_rcp_f32 v168, v168
    v_rcp_f32 v169, v169
    v_rcp_f32 v170, v170
    v_rcp_f32 v171, v171
    v_rcp_f32 v172, v172
    v_rcp_f32 v173, v173
    v_rcp_f32 v174, v174
    v_rcp_f32 v175, v175
    v_pk_mul_f32 v[160:161], v[160:161], v[112:113]
    v_pk_mul_f32 v[162:163], v[162:163], v[114:115]
    v_pk_mul_f32 v[164:165], v[164:165], v[116:117]
    v_pk_mul_f32 v[166:167], v[166:167], v[118:119]
    v_pk_mul_f32 v[168:169], v[168:169], v[120:121]
    v_pk_mul_f32 v[170:171], v[170:171], v[122:123]
    v_pk_mul_f32 v[172:173], v[172:173], v[124:125]
    v_pk_mul_f32 v[174:175], v[174:175], v[126:127]
    v_cvt_pk_bf16_f32 v176, v160, v161
    v_cvt_pk_bf16_f32 v177, v162, v163
    v_cvt_pk_bf16_f32 v178, v164, v165
    v_cvt_pk_bf16_f32 v179, v166, v167
    v_cvt_pk_bf16_f32 v180, v168, v169
    v_cvt_pk_bf16_f32 v181, v170, v171
    v_cvt_pk_bf16_f32 v182, v172, v173
    v_cvt_pk_bf16_f32 v183, v174, v175
    s_add_u32 s36, s36, 4096
    buffer_store_dwordx4 v[176:179], v2, s[24:27], s36 offen offset:0 sc1
    buffer_store_dwordx4 v[180:183], v2, s[24:27], s36 offen offset:1024 sc1
    s_lshl_b32 s101, s28, 4
    s_add_u32 s101, s101, s29
    s_branch P4_DONE
P4_LOADER:
    s_setprio 2
    s_sub_u32 s31, s30, 4
    s_mul_i32 s36, s31, 28
    v_lshrrev_b32 v5, 4, v1
    v_add_u32 v5, s36, v5
    v_bfe_u32 v6, v1, 2, 2
    v_and_b32 v7, 3, v1
    v_add_u32 v8, 0, v5
    v_mul_u32_u24 v9, 9363, v8
    v_lshrrev_b32 v9, 16, v9
    v_mul_u32_u24 v10, 7, v9
    v_sub_u32 v10, v8, v10
    v_lshl_add_u32 v9, v9, 2, v6
    v_mul_u32_u24 v9, 7168, v9
    v_lshl_add_u32 v9, v10, 6, v9
    v_lshl_add_u32 v16, v7, 4, v9
    v_add_u32 v8, 4, v5
    v_mul_u32_u24 v9, 9363, v8
    v_lshrrev_b32 v9, 16, v9
    v_mul_u32_u24 v10, 7, v9
    v_sub_u32 v10, v8, v10
    v_lshl_add_u32 v9, v9, 2, v6
    v_mul_u32_u24 v9, 7168, v9
    v_lshl_add_u32 v9, v10, 6, v9
    v_lshl_add_u32 v17, v7, 4, v9
    v_add_u32 v8, 8, v5
    v_mul_u32_u24 v9, 9363, v8
    v_lshrrev_b32 v9, 16, v9
    v_mul_u32_u24 v10, 7, v9
    v_sub_u32 v10, v8, v10
    v_lshl_add_u32 v9, v9, 2, v6
    v_mul_u32_u24 v9, 7168, v9
    v_lshl_add_u32 v9, v10, 6, v9
    v_lshl_add_u32 v18, v7, 4, v9
    v_add_u32 v8, 12, v5
    v_mul_u32_u24 v9, 9363, v8
    v_lshrrev_b32 v9, 16, v9
    v_mul_u32_u24 v10, 7, v9
    v_sub_u32 v10, v8, v10
    v_lshl_add_u32 v9, v9, 2, v6
    v_mul_u32_u24 v9, 7168, v9
    v_lshl_add_u32 v9, v10, 6, v9
    v_lshl_add_u32 v19, v7, 4, v9
    v_add_u32 v8, 16, v5
    v_mul_u32_u24 v9, 9363, v8
    v_lshrrev_b32 v9, 16, v9
    v_mul_u32_u24 v10, 7, v9
    v_sub_u32 v10, v8, v10
    v_lshl_add_u32 v9, v9, 2, v6
    v_mul_u32_u24 v9, 7168, v9
    v_lshl_add_u32 v9, v10, 6, v9
    v_lshl_add_u32 v20, v7, 4, v9
    v_add_u32 v8, 20, v5
    v_mul_u32_u24 v9, 9363, v8
    v_lshrrev_b32 v9, 16, v9
    v_mul_u32_u24 v10, 7, v9
    v_sub_u32 v10, v8, v10
    v_lshl_add_u32 v9, v9, 2, v6
    v_mul_u32_u24 v9, 7168, v9
    v_lshl_add_u32 v9, v10, 6, v9
    v_lshl_add_u32 v21, v7, 4, v9
    v_add_u32 v8, 24, v5
    v_mul_u32_u24 v9, 9363, v8
    v_lshrrev_b32 v9, 16, v9
    v_mul_u32_u24 v10, 7, v9
    v_sub_u32 v10, v8, v10
    v_lshl_add_u32 v9, v9, 2, v6
    v_mul_u32_u24 v9, 7168, v9
    v_lshl_add_u32 v9, v10, 6, v9
    v_lshl_add_u32 v22, v7, 4, v9
    s_mul_i32 s33, s29, 448
    s_mul_i32 s39, s31, 7168
    s_add_u32 m0, s39, 0
    s_nop 0
    buffer_load_dwordx4 v16, s[8:11], s33 offen lds
    s_add_u32 m0, s39, 1024
    s_nop 0
    buffer_load_dwordx4 v17, s[8:11], s33 offen lds
    s_add_u32 m0, s39, 2048
    s_nop 0
    buffer_load_dwordx4 v18, s[8:11], s33 offen lds
    s_add_u32 m0, s39, 3072
    s_nop 0
    buffer_load_dwordx4 v19, s[8:11], s33 offen lds
    s_add_u32 m0, s39, 4096
    s_nop 0
    buffer_load_dwordx4 v20, s[8:11], s33 offen lds
    s_add_u32 m0, s39, 5120
    s_nop 0
    buffer_load_dwordx4 v21, s[8:11], s33 offen lds
    s_add_u32 m0, s39, 6144
    s_nop 0
    buffer_load_dwordx4 v22, s[8:11], s33 offen lds
    s_add_u32 s33, s33, 458752
    s_add_u32 m0, s39, 28672
    s_nop 0
    buffer_load_dwordx4 v16, s[8:11], s33 offen lds
    s_add_u32 m0, s39, 29696
    s_nop 0
    buffer_load_dwordx4 v17, s[8:11], s33 offen lds
    s_add_u32 m0, s39, 30720
    s_nop 0
    buffer_load_dwordx4 v18, s[8:11], s33 offen lds
    s_add_u32 m0, s39, 31744
    s_nop 0
    buffer_load_dwordx4 v19, s[8:11], s33 offen lds
    s_add_u32 m0, s39, 32768
    s_nop 0
    buffer_load_dwordx4 v20, s[8:11], s33 offen lds
    s_add_u32 m0, s39, 33792
    s_nop 0
    buffer_load_dwordx4 v21, s[8:11], s33 offen lds
    s_add_u32 m0, s39, 34816
    s_nop 0
    buffer_load_dwordx4 v22, s[8:11], s33 offen lds
    s_add_u32 s33, s33, 458752
    s_barrier
    s_cmp_eq_u32 s30, 7
    s_cbranch_scc0 PB19
    s_lshl_b32 s56, s28, 11
    s_add_u32 s56, s56, 106496
    s_mov_b32 s57, 0
POLL20:
    v_min_u32 v248, 15, v1
    v_lshlrev_b32 v248, 7, v248
    buffer_load_dword v248, v248, s[96:99], s56 offen sc1
    s_waitcnt vmcnt(0)
    s_mov_b64 s[58:59], -1
    v_cmp_eq_u32 vcc, s100, v248
    s_and_b64 s[58:59], s[58:59], vcc
    s_cmp_eq_u64 s[58:59], -1
    s_cbranch_scc1 POLLD20
    s_add_u32 s57, s57, 1
    s_cmp_gt_u32 s57, 400000
    s_cbranch_scc1 POLLD20
    s_sleep 1
    s_branch POLL20
POLLD20:
PB19:
    s_waitcnt vmcnt(7)
    s_barrier
    s_add_u32 m0, s39, 57344
    s_nop 0
    buffer_load_dwordx4 v16, s[8:11], s33 offen lds
    s_add_u32 m0, s39, 58368
    s_nop 0
    buffer_load_dwordx4 v17, s[8:11], s33 offen lds
    s_add_u32 m0, s39, 59392
    s_nop 0
    buffer_load_dwordx4 v18, s[8:11], s33 offen lds
    s_add_u32 m0, s39, 60416
    s_nop 0
    buffer_load_dwordx4 v19, s[8:11], s33 offen lds
    s_add_u32 m0, s39, 61440
    s_nop 0
    buffer_load_dwordx4 v20, s[8:11], s33 offen lds
    s_add_u32 m0, s39, 62464
    s_nop 0
    buffer_load_dwordx4 v21, s[8:11], s33 offen lds
    s_add_u32 m0, s39, 63488
    s_nop 0
    buffer_load_dwordx4 v22, s[8:11], s33 offen lds
    s_add_u32 s33, s33, 458752
    s_add_u32 s44, s20, 0x2300000
    s_addc_u32 s45, s21, 0
    s_mov_b32 s46, 0x10000
    s_mov_b32 s47, 0x00020000
    s_add_u32 s48, s20, 0x28000
    s_addc_u32 s49, s21, 0
    s_mov_b32 s50, 0x15080
    s_mov_b32 s51, 0x00020000
    v_and_b32 v8, 31, v1
    s_mul_i32 s36, s29, 224
    s_lshl_b32 s37, s31, 5
    s_add_u32 s36, s36, s37
    v_add_u32 v9, s36, v8
    v_lshlrev_b32 v14, 2, v9
    v_lshlrev_b32 v15, 1, v9
    v_mov_b32 v236, 0
    s_lshl_b32 s52, s28, 2
    s_add_u32 s52, s52, s31
    s_lshl_b32 s52, s52, 10
    v_lshlrev_b32 v237, 5, v8
    s_waitcnt vmcnt(7)
    s_barrier
    s_add_u32 m0, s39, 86016
    s_nop 0
    buffer_load_dwordx4 v16, s[8:11], s33 offen lds
    s_add_u32 m0, s39, 87040
    s_nop 0
    buffer_load_dwordx4 v17, s[8:11], s33 offen lds
    s_add_u32 m0, s39, 88064
    s_nop 0
    buffer_load_dwordx4 v18, s[8:11], s33 offen lds
    s_add_u32 m0, s39, 89088
    s_nop 0
    buffer_load_dwordx4 v19, s[8:11], s33 offen lds
    s_add_u32 m0, s39, 90112
    s_nop 0
    buffer_load_dwordx4 v20, s[8:11], s33 offen lds
    s_add_u32 m0, s39, 91136
    s_nop 0
    buffer_load_dwordx4 v21, s[8:11], s33 offen lds
    s_add_u32 m0, s39, 92160
    s_nop 0
    buffer_load_dwordx4 v22, s[8:11], s33 offen lds
    s_add_u32 s33, s33, 458752
    s_waitcnt vmcnt(7)
    s_barrier
    s_add_u32 m0, s39, 0
    s_nop 0
    buffer_load_dwordx4 v16, s[8:11], s33 offen lds
    s_add_u32 m0, s39, 1024
    s_nop 0
    buffer_load_dwordx4 v17, s[8:11], s33 offen lds
    s_add_u32 m0, s39, 2048
    s_nop 0
    buffer_load_dwordx4 v18, s[8:11], s33 offen lds
    s_add_u32 m0, s39, 3072
    s_nop 0
    buffer_load_dwordx4 v19, s[8:11], s33 offen lds
    s_add_u32 m0, s39, 4096
    s_nop 0
    buffer_load_dwordx4 v20, s[8:11], s33 offen lds
    s_add_u32 m0, s39, 5120
    s_nop 0
    buffer_load_dwordx4 v21, s[8:11], s33 offen lds
    s_add_u32 m0, s39, 6144
    s_nop 0
    buffer_load_dwordx4 v22, s[8:11], s33 offen lds
    s_add_u32 s33, s33, 458752
    s_waitcnt vmcnt(7)
    s_barrier
    s_add_u32 m0, s39, 28672
    s_nop 0
    buffer_load_dwordx4 v16, s[8:11], s33 offen lds
    s_add_u32 m0, s39, 29696
    s_nop 0
    buffer_load_dwordx4 v17, s[8:11], s33 offen lds
    s_add_u32 m0, s39, 30720
    s_nop 0
    buffer_load_dwordx4 v18, s[8:11], s33 offen lds
    s_add_u32 m0, s39, 31744
    s_nop 0
    buffer_load_dwordx4 v19, s[8:11], s33 offen lds
    s_add_u32 m0, s39, 32768
    s_nop 0
    buffer_load_dwordx4 v20, s[8:11], s33 offen lds
    s_add_u32 m0, s39, 33792
    s_nop 0
    buffer_load_dwordx4 v21, s[8:11], s33 offen lds
    s_add_u32 m0, s39, 34816
    s_nop 0
    buffer_load_dwordx4 v22, s[8:11], s33 offen lds
    s_add_u32 s33, s33, 458752
    s_waitcnt vmcnt(7)
    s_barrier
    s_add_u32 m0, s39, 57344
    s_nop 0
    buffer_load_dwordx4 v16, s[8:11], s33 offen lds
    s_add_u32 m0, s39, 58368
    s_nop 0
    buffer_load_dwordx4 v17, s[8:11], s33 offen lds
    s_add_u32 m0, s39, 59392
    s_nop 0
    buffer_load_dwordx4 v18, s[8:11], s33 offen lds
    s_add_u32 m0, s39, 60416
    s_nop 0
    buffer_load_dwordx4 v19, s[8:11], s33 offen lds
    s_add_u32 m0, s39, 61440
    s_nop 0
    buffer_load_dwordx4 v20, s[8:11], s33 offen lds
    s_add_u32 m0, s39, 62464
    s_nop 0
    buffer_load_dwordx4 v21, s[8:11], s33 offen lds
    s_add_u32 m0, s39, 63488
    s_nop 0
    buffer_load_dwordx4 v22, s[8:11], s33 offen lds
    s_add_u32 s33, s33, 458752
    s_waitcnt vmcnt(7)
    s_barrier
    s_add_u32 m0, s39, 86016
    s_nop 0
    buffer_load_dwordx4 v16, s[8:11], s33 offen lds
    s_add_u32 m0, s39, 87040
    s_nop 0
    buffer_load_dwordx4 v17, s[8:11], s33 offen lds
    s_add_u32 m0, s39, 88064
    s_nop 0
    buffer_load_dwordx4 v18, s[8:11], s33 offen lds
    s_add_u32 m0, s39, 89088
    s_nop 0
    buffer_load_dwordx4 v19, s[8:11], s33 offen lds
    s_add_u32 m0, s39, 90112
    s_nop 0
    buffer_load_dwordx4 v20, s[8:11], s33 offen lds
    s_add_u32 m0, s39, 91136
    s_nop 0
    buffer_load_dwordx4 v21, s[8:11], s33 offen lds
    s_add_u32 m0, s39, 92160
    s_nop 0
    buffer_load_dwordx4 v22, s[8:11], s33 offen lds
    s_add_u32 s33, s33, 458752
    s_mov_b32 s4, s94
    s_mov_b32 s5, s95
    s_mov_b32 s6, 256
    s_mov_b32 s7, 0x00020000
    v_mov_b32 v249, 64
    buffer_load_dword v249, v249, s[4:7], 0 offen sc1
    v_min_u32 v248, 15, v1
    v_lshlrev_b32 v248, 7, v248
    s_lshl_b32 s56, s28, 11
    s_add_u32 s56, s56, 172032
    buffer_load_dword v248, v248, s[96:99], s56 offen sc1
    s_waitcnt vmcnt(9)
    s_barrier
    s_add_u32 m0, s39, 0
    s_nop 0
    buffer_load_dwordx4 v16, s[8:11], s33 offen lds
    s_add_u32 m0, s39, 1024
    s_nop 0
    buffer_load_dwordx4 v17, s[8:11], s33 offen lds
    s_add_u32 m0, s39, 2048
    s_nop 0
    buffer_load_dwordx4 v18, s[8:11], s33 offen lds
    s_add_u32 m0, s39, 3072
    s_nop 0
    buffer_load_dwordx4 v19, s[8:11], s33 offen lds
    s_add_u32 m0, s39, 4096
    s_nop 0
    buffer_load_dwordx4 v20, s[8:11], s33 offen lds
    s_add_u32 m0, s39, 5120
    s_nop 0
    buffer_load_dwordx4 v21, s[8:11], s33 offen lds
    s_add_u32 m0, s39, 6144
    s_nop 0
    buffer_load_dwordx4 v22, s[8:11], s33 offen lds
    s_add_u32 s33, s33, 458752
    s_waitcnt vmcnt(9)
    s_barrier
    s_add_u32 m0, s39, 28672
    s_nop 0
    buffer_load_dwordx4 v16, s[8:11], s33 offen lds
    s_add_u32 m0, s39, 29696
    s_nop 0
    buffer_load_dwordx4 v17, s[8:11], s33 offen lds
    s_add_u32 m0, s39, 30720
    s_nop 0
    buffer_load_dwordx4 v18, s[8:11], s33 offen lds
    s_add_u32 m0, s39, 31744
    s_nop 0
    buffer_load_dwordx4 v19, s[8:11], s33 offen lds
    s_add_u32 m0, s39, 32768
    s_nop 0
    buffer_load_dwordx4 v20, s[8:11], s33 offen lds
    s_add_u32 m0, s39, 33792
    s_nop 0
    buffer_load_dwordx4 v21, s[8:11], s33 offen lds
    s_add_u32 m0, s39, 34816
    s_nop 0
    buffer_load_dwordx4 v22, s[8:11], s33 offen lds
    s_add_u32 s33, s33, 458752
    s_waitcnt vmcnt(14)
    v_cmp_eq_u32 vcc, s100, v248
    s_cmp_eq_u64 vcc, -1
    s_cbranch_scc1 STOK21
    s_mov_b32 s57, 0
POLL22:
    v_min_u32 v248, 15, v1
    v_lshlrev_b32 v248, 7, v248
    buffer_load_dword v248, v248, s[96:99], s56 offen sc1
    s_waitcnt vmcnt(0)
    s_mov_b64 s[58:59], -1
    v_cmp_eq_u32 vcc, s100, v248
    s_and_b64 s[58:59], s[58:59], vcc
    s_cmp_eq_u64 s[58:59], -1
    s_cbranch_scc1 POLLD22
    s_add_u32 s57, s57, 1
    s_cmp_gt_u32 s57, 400000
    s_cbranch_scc1 POLLD22
    s_sleep 1
    s_branch POLL22
POLLD22:
STOK21:
    s_mov_b32 s57, 0
CCK23:
    s_mov_b32 s58, 1
    v_readfirstlane_b32 s59, v249
    s_nop 3
    s_cmp_ge_u32 s59, 224
    s_cselect_b32 s58, s58, 0
    s_cmp_eq_u32 s58, 1
    s_cbranch_scc1 CCD23
    s_add_u32 s57, s57, 1
    s_cmp_gt_u32 s57, 400000
    s_cbranch_scc1 CCD23
    s_sleep 2
    v_mov_b32 v249, 64
    buffer_load_dword v249, v249, s[4:7], 0 offen sc1
    s_waitcnt vmcnt(0)
    s_branch CCK23
CCD23:
    buffer_load_dwordx4 v[32:35], v237, s[44:47], s52 offen sc1
    buffer_load_dwordx4 v[36:39], v237, s[44:47], s52 offen offset:16 sc1
    s_mov_b32 s53, 0
    buffer_load_dword v140, v14, s[48:51], s53 offen offset:0 sc1
    s_mov_b32 s53, 14336
    buffer_load_dword v141, v14, s[48:51], s53 offen offset:0 sc1
    s_mov_b32 s53, 28672
    buffer_load_dword v142, v14, s[48:51], s53 offen offset:0 sc1
    s_mov_b32 s53, 43008
    buffer_load_dword v144, v14, s[48:51], s53 offen offset:0 sc1
    s_mov_b32 s53, 57344
    buffer_load_dword v145, v14, s[48:51], s53 offen offset:0 sc1
    s_mov_b32 s53, 71680
    buffer_load_dword v146, v14, s[48:51], s53 offen offset:0 sc1
    buffer_load_ushort v143, v15, s[16:19], 0 offen offset:0
    s_waitcnt vmcnt(16)
    s_barrier
    s_add_u32 m0, s39, 57344
    s_nop 0
    buffer_load_dwordx4 v16, s[8:11], s33 offen lds
    s_add_u32 m0, s39, 58368
    s_nop 0
    buffer_load_dwordx4 v17, s[8:11], s33 offen lds
    s_add_u32 m0, s39, 59392
    s_nop 0
    buffer_load_dwordx4 v18, s[8:11], s33 offen lds
    s_add_u32 m0, s39, 60416
    s_nop 0
    buffer_load_dwordx4 v19, s[8:11], s33 offen lds
    s_add_u32 m0, s39, 61440
    s_nop 0
    buffer_load_dwordx4 v20, s[8:11], s33 offen lds
    s_add_u32 m0, s39, 62464
    s_nop 0
    buffer_load_dwordx4 v21, s[8:11], s33 offen lds
    s_add_u32 m0, s39, 63488
    s_nop 0
    buffer_load_dwordx4 v22, s[8:11], s33 offen lds
    s_add_u32 s33, s33, 458752
    s_mov_b32 s53, 0
    buffer_load_dword v148, v14, s[48:51], s53 offen offset:512 sc1
    s_mov_b32 s53, 14336
    buffer_load_dword v149, v14, s[48:51], s53 offen offset:512 sc1
    s_mov_b32 s53, 28672
    buffer_load_dword v150, v14, s[48:51], s53 offen offset:512 sc1
    s_mov_b32 s53, 43008
    buffer_load_dword v152, v14, s[48:51], s53 offen offset:512 sc1
    s_mov_b32 s53, 57344
    buffer_load_dword v153, v14, s[48:51], s53 offen offset:512 sc1
    s_mov_b32 s53, 71680
    buffer_load_dword v154, v14, s[48:51], s53 offen offset:512 sc1
    buffer_load_ushort v151, v15, s[16:19], 0 offen offset:256
    s_mov_b32 s53, 86016
    buffer_load_dwordx4 v[104:107], v236, s[48:51], s53 offen sc1
    s_mov_b32 s53, 86016
    buffer_load_dwordx4 v[108:111], v236, s[48:51], s53 offen offset:16 sc1
    s_mov_b32 s53, 86080
    buffer_load_dwordx4 v[112:115], v236, s[48:51], s53 offen sc1
    s_mov_b32 s53, 86080
    buffer_load_dwordx4 v[116:119], v236, s[48:51], s53 offen offset:16 sc1
    s_waitcnt vmcnt(27)
    s_barrier
    s_add_u32 m0, s39, 86016
    s_nop 0
    buffer_load_dwordx4 v16, s[8:11], s33 offen lds
    s_add_u32 m0, s39, 87040
    s_nop 0
    buffer_load_dwordx4 v17, s[8:11], s33 offen lds
    s_add_u32 m0, s39, 88064
    s_nop 0
    buffer_load_dwordx4 v18, s[8:11], s33 offen lds
    s_add_u32 m0, s39, 89088
    s_nop 0
    buffer_load_dwordx4 v19, s[8:11], s33 offen lds
    s_add_u32 m0, s39, 90112
    s_nop 0
    buffer_load_dwordx4 v20, s[8:11], s33 offen lds
    s_add_u32 m0, s39, 91136
    s_nop 0
    buffer_load_dwordx4 v21, s[8:11], s33 offen lds
    s_add_u32 m0, s39, 92160
    s_nop 0
    buffer_load_dwordx4 v22, s[8:11], s33 offen lds
    s_add_u32 s33, s33, 458752
    s_waitcnt vmcnt(18)
    s_barrier
    s_add_u32 m0, s39, 0
    s_nop 0
    buffer_load_dwordx4 v16, s[8:11], s33 offen lds
    s_add_u32 m0, s39, 1024
    s_nop 0
    buffer_load_dwordx4 v17, s[8:11], s33 offen lds
    s_add_u32 m0, s39, 2048
    s_nop 0
    buffer_load_dwordx4 v18, s[8:11], s33 offen lds
    s_add_u32 m0, s39, 3072
    s_nop 0
    buffer_load_dwordx4 v19, s[8:11], s33 offen lds
    s_add_u32 m0, s39, 4096
    s_nop 0
    buffer_load_dwordx4 v20, s[8:11], s33 offen lds
    s_add_u32 m0, s39, 5120
    s_nop 0
    buffer_load_dwordx4 v21, s[8:11], s33 offen lds
    s_add_u32 m0, s39, 6144
    s_nop 0
    buffer_load_dwordx4 v22, s[8:11], s33 offen lds
    s_add_u32 s33, s33, 458752
    s_waitcnt vmcnt(14)
    v_add_f32 v104, v104, v112
    v_add_f32 v105, v105, v113
    v_add_f32 v106, v106, v114
    v_add_f32 v107, v107, v115
    v_add_f32 v108, v108, v116
    v_add_f32 v109, v109, v117
    v_add_f32 v110, v110, v118
    v_add_f32 v111, v111, v119
    v_add_f32 v140, v140, v144
    v_add_f32 v141, v141, v145
    v_add_f32 v142, v142, v146
    v_add_f32 v148, v148, v152
    v_add_f32 v149, v149, v153
    v_add_f32 v150, v150, v154
    v_mul_f32 v112, 0x3a800000, v32
    v_mul_f32 v113, 0x3a800000, v33
    v_fma_f32 v113, -v112, v112, v113
    v_add_f32 v113, 0x3727c5ac, v113
    v_rsq_f32 v114, v113
    s_nop 0
    v_mul_f32 v115, v113, v114
    v_fma_f32 v116, -v112, v106, v34
    v_fma_f32 v116, v116, v114, v110
    v_mul_f32 v116, 0x3a800000, v116
    v_mul_f32 v117, v112, v104
    v_fma_f32 v117, -2.0, v35, v117
    v_fma_f32 v117, v117, v112, v36
    v_mul_f32 v117, v117, v114
    v_fma_f32 v118, -v112, v105, v37
    v_fma_f32 v117, 2.0, v118, v117
    v_fma_f32 v117, v117, v114, v109
    v_mul_f32 v117, 0x3a800000, v117
    v_fma_f32 v117, -v116, v116, v117
    v_add_f32 v117, 0x3727c5ac, v117
    v_rsq_f32 v118, v117
    s_nop 0
    v_mul_f32 v119, v117, v118
    v_mul_f32 v120, v114, v118
    v_sub_f32 v121, 0, v112
    v_mul_f32 v122, v116, v115
    v_sub_f32 v122, 0, v122
    v_mul_f32 v123, v115, v119
    s_waitcnt vmcnt(7)
    s_barrier
    s_add_u32 m0, s39, 28672
    s_nop 0
    buffer_load_dwordx4 v16, s[8:11], s33 offen lds
    s_add_u32 m0, s39, 29696
    s_nop 0
    buffer_load_dwordx4 v17, s[8:11], s33 offen lds
    s_add_u32 m0, s39, 30720
    s_nop 0
    buffer_load_dwordx4 v18, s[8:11], s33 offen lds
    s_add_u32 m0, s39, 31744
    s_nop 0
    buffer_load_dwordx4 v19, s[8:11], s33 offen lds
    s_add_u32 m0, s39, 32768
    s_nop 0
    buffer_load_dwordx4 v20, s[8:11], s33 offen lds
    s_add_u32 m0, s39, 33792
    s_nop 0
    buffer_load_dwordx4 v21, s[8:11], s33 offen lds
    s_add_u32 m0, s39, 34816
    s_nop 0
    buffer_load_dwordx4 v22, s[8:11], s33 offen lds
    s_add_u32 s33, s33, 458752
    v_cvt_pk_bf16_f32 v8, v121, v121
    v_and_b32 v124, 0xffff0000, v8
    v_sub_f32 v125, v121, v124
    v_cvt_pk_bf16_f32 v8, v125, v125
    v_and_b32 v125, 0xffff0000, v8
    v_cvt_pk_bf16_f32 v8, v115, v115
    v_and_b32 v126, 0xffff0000, v8
    v_sub_f32 v127, v115, v126
    v_cvt_pk_bf16_f32 v8, v127, v127
    v_and_b32 v127, 0xffff0000, v8
    v_cvt_pk_bf16_f32 v8, v122, v122
    v_and_b32 v128, 0xffff0000, v8
    v_sub_f32 v129, v122, v128
    v_cvt_pk_bf16_f32 v8, v129, v129
    v_and_b32 v129, 0xffff0000, v8
    v_cvt_pk_bf16_f32 v8, v123, v123
    v_and_b32 v130, 0xffff0000, v8
    v_sub_f32 v131, v123, v130
    v_cvt_pk_bf16_f32 v8, v131, v131
    v_and_b32 v131, 0xffff0000, v8
    v_lshrrev_b32 v132, 16, v124
    v_or_b32 v132, v132, v124
    v_lshrrev_b32 v133, 16, v125
    v_or_b32 v133, v133, v126
    v_lshrrev_b32 v134, 16, v126
    v_or_b32 v134, v134, v127
    v_lshrrev_b32 v135, 16, v128
    v_or_b32 v135, v135, v128
    v_lshrrev_b32 v136, 16, v129
    v_or_b32 v136, v136, v130
    v_lshrrev_b32 v137, 16, v131
    v_mov_b32 v138, 0
    v_mov_b32 v139, 0
    v_cmp_lt_u32 vcc, 31, v1
    s_nop 1
    v_cndmask_b32 v132, v132, v136, vcc
    v_cndmask_b32 v133, v133, v137, vcc
    v_cndmask_b32 v134, v134, v138, vcc
    v_cndmask_b32 v135, v135, v139, vcc
    s_lshl_b32 s36, s31, 10
    v_add_u32 v10, s36, v2
    v_add_u32 v10, 121856, v10
    ds_write_b128 v10, v[132:135]
    v_and_b32 v10, 31, v1
    v_lshlrev_b32 v10, 2, v10
    s_lshl_b32 s36, s31, 7
    v_add_u32 v10, s36, v10
    v_add_u32 v10, 125952, v10
    ds_write_b32 v10, v120
    s_waitcnt lgkmcnt(0)
    s_waitcnt vmcnt(7)
    s_barrier
    s_add_u32 m0, s39, 57344
    s_nop 0
    buffer_load_dwordx4 v16, s[8:11], s33 offen lds
    s_add_u32 m0, s39, 58368
    s_nop 0
    buffer_load_dwordx4 v17, s[8:11], s33 offen lds
    s_add_u32 m0, s39, 59392
    s_nop 0
    buffer_load_dwordx4 v18, s[8:11], s33 offen lds
    s_add_u32 m0, s39, 60416
    s_nop 0
    buffer_load_dwordx4 v19, s[8:11], s33 offen lds
    s_add_u32 m0, s39, 61440
    s_nop 0
    buffer_load_dwordx4 v20, s[8:11], s33 offen lds
    s_add_u32 m0, s39, 62464
    s_nop 0
    buffer_load_dwordx4 v21, s[8:11], s33 offen lds
    s_add_u32 m0, s39, 63488
    s_nop 0
    buffer_load_dwordx4 v22, s[8:11], s33 offen lds
    s_add_u32 s33, s33, 458752
    v_cvt_pk_bf16_f32 v8, v140, v140
    v_and_b32 v124, 0xffff0000, v8
    v_sub_f32 v125, v140, v124
    v_cvt_pk_bf16_f32 v8, v125, v125
    v_and_b32 v125, 0xffff0000, v8
    v_cvt_pk_bf16_f32 v8, v141, v141
    v_and_b32 v126, 0xffff0000, v8
    v_sub_f32 v127, v141, v126
    v_cvt_pk_bf16_f32 v8, v127, v127
    v_and_b32 v127, 0xffff0000, v8
    v_cvt_pk_bf16_f32 v8, v142, v142
    v_and_b32 v128, 0xffff0000, v8
    v_sub_f32 v129, v142, v128
    v_cvt_pk_bf16_f32 v8, v129, v129
    v_and_b32 v129, 0xffff0000, v8
    v_lshlrev_b32 v130, 16, v143
    v_lshrrev_b32 v132, 16, v124
    v_or_b32 v132, v132, v125
    v_lshrrev_b32 v133, 16, v124
    v_or_b32 v133, v133, v126
    v_lshrrev_b32 v134, 16, v127
    v_or_b32 v134, v134, v126
    v_lshrrev_b32 v135, 16, v128
    v_or_b32 v135, v135, v129
    v_lshrrev_b32 v136, 16, v128
    v_or_b32 v136, v136, v130
    v_lshrrev_b32 v137, 16, v130
    v_mov_b32 v138, 0
    v_mov_b32 v139, 0
    v_cndmask_b32 v132, v132, v136, vcc
    v_cndmask_b32 v133, v133, v137, vcc
    v_cndmask_b32 v134, v134, v138, vcc
    v_cndmask_b32 v135, v135, v139, vcc
    s_add_u32 s36, s31, 0
    s_cmp_lt_u32 s36, 7
    s_cbranch_scc0 P4_NOAX0
    s_lshl_b32 s36, s36, 10
    v_add_u32 v10, s36, v2
    v_add_u32 v10, 114688, v10
    ds_write_b128 v10, v[132:135]
P4_NOAX0:
    s_waitcnt vmcnt(7)
    s_barrier
    s_add_u32 m0, s39, 86016
    s_nop 0
    buffer_load_dwordx4 v16, s[8:11], s33 offen lds
    s_add_u32 m0, s39, 87040
    s_nop 0
    buffer_load_dwordx4 v17, s[8:11], s33 offen lds
    s_add_u32 m0, s39, 88064
    s_nop 0
    buffer_load_dwordx4 v18, s[8:11], s33 offen lds
    s_add_u32 m0, s39, 89088
    s_nop 0
    buffer_load_dwordx4 v19, s[8:11], s33 offen lds
    s_add_u32 m0, s39, 90112
    s_nop 0
    buffer_load_dwordx4 v20, s[8:11], s33 offen lds
    s_add_u32 m0, s39, 91136
    s_nop 0
    buffer_load_dwordx4 v21, s[8:11], s33 offen lds
    s_add_u32 m0, s39, 92160
    s_nop 0
    buffer_load_dwordx4 v22, s[8:11], s33 offen lds
    s_add_u32 s33, s33, 458752
    v_cvt_pk_bf16_f32 v8, v148, v148
    v_and_b32 v124, 0xffff0000, v8
    v_sub_f32 v125, v148, v124
    v_cvt_pk_bf16_f32 v8, v125, v125
    v_and_b32 v125, 0xffff0000, v8
    v_cvt_pk_bf16_f32 v8, v149, v149
    v_and_b32 v126, 0xffff0000, v8
    v_sub_f32 v127, v149, v126
    v_cvt_pk_bf16_f32 v8, v127, v127
    v_and_b32 v127, 0xffff0000, v8
    v_cvt_pk_bf16_f32 v8, v150, v150
    v_and_b32 v128, 0xffff0000, v8
    v_sub_f32 v129, v150, v128
    v_cvt_pk_bf16_f32 v8, v129, v129
    v_and_b32 v129, 0xffff0000, v8
    v_lshlrev_b32 v130, 16, v151
    v_lshrrev_b32 v132, 16, v124
    v_or_b32 v132, v132, v125
    v_lshrrev_b32 v133, 16, v124
    v_or_b32 v133, v133, v126
    v_lshrrev_b32 v134, 16, v127
    v_or_b32 v134, v134, v126
    v_lshrrev_b32 v135, 16, v128
    v_or_b32 v135, v135, v129
    v_lshrrev_b32 v136, 16, v128
    v_or_b32 v136, v136, v130
    v_lshrrev_b32 v137, 16, v130
    v_mov_b32 v138, 0
    v_mov_b32 v139, 0
    v_cndmask_b32 v132, v132, v136, vcc
    v_cndmask_b32 v133, v133, v137, vcc
    v_cndmask_b32 v134, v134, v138, vcc
    v_cndmask_b32 v135, v135, v139, vcc
    s_add_u32 s36, s31, 4
    s_cmp_lt_u32 s36, 7
    s_cbranch_scc0 P4_NOAX1
    s_lshl_b32 s36, s36, 10
    v_add_u32 v10, s36, v2
    v_add_u32 v10, 114688, v10
    ds_write_b128 v10, v[132:135]
P4_NOAX1:
    s_waitcnt lgkmcnt(0)
    s_waitcnt vmcnt(7)
    s_barrier
    s_waitcnt vmcnt(0)
    s_barrier
    s_barrier
    s_barrier
    s_setprio 0
    s_and_b32 s26, s2, 7
    s_lshr_b32 s27, s2, 3
    s_and_b32 s28, s26, 3
    s_lshl_b32 s28, s28, 2
    s_and_b32 s29, s27, 3
    s_add_u32 s28, s28, s29
    s_lshr_b32 s29, s26, 2
    s_lshl_b32 s29, s29, 3
    s_lshr_b32 s27, s27, 2
    s_add_u32 s29, s29, s27
    s_mov_b32 s8, s80
    s_mov_b32 s9, s81
    s_mov_b32 s10, 0x700000
    s_mov_b32 s11, 0x00020000
    v_bfe_u32 v6, v1, 2, 2
    v_lshlrev_b32 v3, 11, v6
    v_lshrrev_b32 v5, 4, v1
    v_lshl_add_u32 v3, v5, 6, v3
    v_and_b32 v7, 3, v1
    v_lshl_add_u32 v3, v7, 4, v3
    s_and_b32 s36, s29, 1
    s_mul_i32 s33, s36, 1792
    s_add_u32 s33, s33, 0
    s_lshl_b32 s36, s31, 4
    s_add_u32 s33, s33, s36
    s_lshl_b32 s33, s33, 11
    s_lshr_b32 s36, s29, 1
    s_lshl_b32 s36, s36, 8
    s_add_u32 s33, s33, s36
    s_lshl_b32 s39, s31, 12
    s_add_u32 s39, s39, 0
    s_add_u32 s37, s33, 0
    s_add_u32 m0, s39, 0
    s_nop 0
    buffer_load_dwordx4 v3, s[8:11], s37 offen lds
    s_add_u32 s37, s33, 8192
    s_add_u32 m0, s39, 1024
    s_nop 0
    buffer_load_dwordx4 v3, s[8:11], s37 offen lds
    s_add_u32 s37, s33, 16384
    s_add_u32 m0, s39, 2048
    s_nop 0
    buffer_load_dwordx4 v3, s[8:11], s37 offen lds
    s_add_u32 s37, s33, 24576
    s_add_u32 m0, s39, 3072
    s_nop 0
    buffer_load_dwordx4 v3, s[8:11], s37 offen lds
    s_add_u32 s33, s33, 131072
    s_add_u32 s37, s33, 0
    s_add_u32 m0, s39, 32768
    s_nop 0
    buffer_load_dwordx4 v3, s[8:11], s37 offen lds
    s_add_u32 s37, s33, 8192
    s_add_u32 m0, s39, 33792
    s_nop 0
    buffer_load_dwordx4 v3, s[8:11], s37 offen lds
    s_add_u32 s37, s33, 16384
    s_add_u32 m0, s39, 34816
    s_nop 0
    buffer_load_dwordx4 v3, s[8:11], s37 offen lds
    s_add_u32 s37, s33, 24576
    s_add_u32 m0, s39, 35840
    s_nop 0
    buffer_load_dwordx4 v3, s[8:11], s37 offen lds
    s_add_u32 s33, s33, 131072
    s_add_u32 s37, s33, 0
    s_add_u32 m0, s39, 65536
    s_nop 0
    buffer_load_dwordx4 v3, s[8:11], s37 offen lds
    s_add_u32 s37, s33, 8192
    s_add_u32 m0, s39, 66560
    s_nop 0
    buffer_load_dwordx4 v3, s[8:11], s37 offen lds
    s_add_u32 s37, s33, 16384
    s_add_u32 m0, s39, 67584
    s_nop 0
    buffer_load_dwordx4 v3, s[8:11], s37 offen lds
    s_add_u32 s37, s33, 24576
    s_add_u32 m0, s39, 68608
    s_nop 0
    buffer_load_dwordx4 v3, s[8:11], s37 offen lds
    s_add_u32 s33, s33, 131072
    s_and_b32 s36, s29, 1
    s_mul_i32 s33, s36, 1792
    s_add_u32 s33, s33, 896
    s_lshl_b32 s36, s31, 4
    s_add_u32 s33, s33, s36
    s_lshl_b32 s33, s33, 11
    s_lshr_b32 s36, s29, 1
    s_lshl_b32 s36, s36, 8
    s_add_u32 s33, s33, s36
    s_lshl_b32 s39, s31, 12
    s_add_u32 s39, s39, 16384
    s_add_u32 s37, s33, 0
    s_add_u32 m0, s39, 0
    s_nop 0
    buffer_load_dwordx4 v3, s[8:11], s37 offen lds
    s_add_u32 s37, s33, 8192
    s_add_u32 m0, s39, 1024
    s_nop 0
    buffer_load_dwordx4 v3, s[8:11], s37 offen lds
    s_add_u32 s37, s33, 16384
    s_add_u32 m0, s39, 2048
    s_nop 0
    buffer_load_dwordx4 v3, s[8:11], s37 offen lds
    s_add_u32 s37, s33, 24576
    s_add_u32 m0, s39, 3072
    s_nop 0
    buffer_load_dwordx4 v3, s[8:11], s37 offen lds
    s_add_u32 s33, s33, 131072
    s_add_u32 s37, s33, 0
    s_add_u32 m0, s39, 32768
    s_nop 0
    buffer_load_dwordx4 v3, s[8:11], s37 offen lds
    s_add_u32 s37, s33, 8192
    s_add_u32 m0, s39, 33792
    s_nop 0
    buffer_load_dwordx4 v3, s[8:11], s37 offen lds
    s_add_u32 s37, s33, 16384
    s_add_u32 m0, s39, 34816
    s_nop 0
    buffer_load_dwordx4 v3, s[8:11], s37 offen lds
    s_add_u32 s37, s33, 24576
    s_add_u32 m0, s39, 35840
    s_nop 0
    buffer_load_dwordx4 v3, s[8:11], s37 offen lds
    s_add_u32 s33, s33, 131072
    s_add_u32 s37, s33, 0
    s_add_u32 m0, s39, 65536
    s_nop 0
    buffer_load_dwordx4 v3, s[8:11], s37 offen lds
    s_add_u32 s37, s33, 8192
    s_add_u32 m0, s39, 66560
    s_nop 0
    buffer_load_dwordx4 v3, s[8:11], s37 offen lds
    s_add_u32 s37, s33, 16384
    s_add_u32 m0, s39, 67584
    s_nop 0
    buffer_load_dwordx4 v3, s[8:11], s37 offen lds
    s_add_u32 s37, s33, 24576
    s_add_u32 m0, s39, 68608
    s_nop 0
    buffer_load_dwordx4 v3, s[8:11], s37 offen lds
    s_add_u32 s33, s33, 131072
P4_DONE:
    s_waitcnt vmcnt(0)
    s_barrier
    s_cmp_eq_u32 s30, 0
    s_cbranch_scc0 SIG24
    s_lshl_b32 s36, s101, 7
    s_add_u32 s36, s36, 139264
    v_mov_b32 v250, s100
    v_mov_b32 v251, 0
    v_cmp_eq_u32 vcc, 0, v1
    s_and_saveexec_b64 s[54:55], vcc
    buffer_store_dword v250, v251, s[96:99], s36 offen sc1
    s_mov_b64 exec, s[54:55]
SIG24:
    s_and_b32 s26, s2, 7
    s_lshr_b32 s27, s2, 3
    s_and_b32 s28, s26, 3
    s_lshl_b32 s28, s28, 2
    s_and_b32 s29, s27, 3
    s_add_u32 s28, s28, s29
    s_lshr_b32 s29, s26, 2
    s_lshl_b32 s29, s29, 3
    s_lshr_b32 s27, s27, 2
    s_add_u32 s29, s29, s27
    v_and_b32 v1, 63, v0
    v_lshrrev_b32 v5, 6, v0
    v_lshlrev_b32 v2, 4, v1
    v_readfirstlane_b32 s30, v5
    s_nop 3
    s_and_b32 s31, s30, 3
    s_lshr_b32 s32, s30, 2
    s_mov_b32 s8, s80
    s_mov_b32 s9, s81
    s_mov_b32 s10, 0x700000
    s_mov_b32 s11, 0x00020000
    s_add_u32 s12, s20, 0x1100000
    s_addc_u32 s13, s21, 0
    s_mov_b32 s14, 0xe00000
    s_mov_b32 s15, 0x00020000
    s_mov_b32 s16, s82
    s_mov_b32 s17, s83
    s_mov_b32 s18, 0x800
    s_mov_b32 s19, 0x00020000
    s_mov_b32 s24, s88
    s_mov_b32 s25, s89
    s_mov_b32 s26, 0x400000
    s_mov_b32 s27, 0x00020000
    s_mov_b32 s44, s20
    s_mov_b32 s45, s21
    s_mov_b32 s46, 0x18000
    s_mov_b32 s47, 0x00020000
    s_add_u32 s48, s20, 0x2800000
    s_addc_u32 s49, s21, 0
    s_mov_b32 s50, 0x800000
    s_mov_b32 s51, 0x00020000
    v_bfe_u32 v6, v1, 2, 2
    v_lshlrev_b32 v3, 11, v6
    v_lshrrev_b32 v5, 4, v1
    v_lshl_add_u32 v3, v5, 6, v3
    v_and_b32 v7, 3, v1
    v_lshl_add_u32 v3, v7, 4, v3
    v_bfe_u32 v6, v1, 2, 2
    v_lshlrev_b32 v4, 6, v6
    v_bfe_u32 v5, v1, 4, 1
    v_lshl_add_u32 v4, v5, 5, v4
    v_and_b32 v7, 3, v1
    v_lshl_add_u32 v4, v7, 3, v4
    v_lshrrev_b32 v5, 5, v1
    v_lshl_add_u32 v4, v5, 10, v4
    s_lshl_b32 s36, s32, 14
    v_add_u32 v4, s36, v4
    v_add_u32 v5, 65536, v4
    s_and_b32 s36, s29, 1
    s_mul_i32 s33, s36, 1792
    s_mul_i32 s37, s32, 896
    s_add_u32 s33, s33, s37
    s_lshr_b32 s34, s33, 4
    s_lshl_b32 s37, s31, 4
    s_add_u32 s33, s33, s37
    s_add_u32 s33, s33, 192
    s_lshl_b32 s33, s33, 11
    s_lshr_b32 s37, s29, 1
    s_lshl_b32 s37, s37, 8
    s_add_u32 s33, s33, s37
    s_lshl_b32 s39, s32, 14
    s_lshl_b32 s37, s31, 12
    s_add_u32 s39, s39, s37
    s_lshl_b32 s37, s28, 2
    s_add_u32 s37, s37, s31
    s_mul_i32 s37, s37, 224
    s_add_u32 s34, s34, s37
    s_lshl_b32 s34, s34, 10
    s_cmp_eq_u32 s30, 7
    s_cbranch_scc0 PB25
    s_lshl_b32 s56, s28, 11
    s_add_u32 s56, s56, 139264
    s_mov_b32 s57, 0
POLL26:
    v_min_u32 v248, 15, v1
    v_lshlrev_b32 v248, 7, v248
    buffer_load_dword v248, v248, s[96:99], s56 offen sc1
    s_waitcnt vmcnt(0)
    s_mov_b64 s[58:59], -1
    v_cmp_eq_u32 vcc, s100, v248
    s_and_b64 s[58:59], s[58:59], vcc
    s_cmp_eq_u64 s[58:59], -1
    s_cbranch_scc1 POLLD26
    s_add_u32 s57, s57, 1
    s_cmp_gt_u32 s57, 400000
    s_cbranch_scc1 POLLD26
    s_sleep 1
    s_branch POLL26
POLLD26:
PB25:
    s_barrier
    buffer_load_dwordx4 v[112:115], v2, s[12:15], s34 offen offset:0 sc1
    buffer_load_dwordx4 v[116:119], v2, s[12:15], s34 offen offset:1024 sc1
    buffer_load_dwordx4 v[120:123], v2, s[12:15], s34 offen offset:2048 sc1
    buffer_load_dwordx4 v[124:127], v2, s[12:15], s34 offen offset:3072 sc1
    s_add_u32 s34, s34, 4096
    buffer_load_dwordx4 v[128:131], v2, s[12:15], s34 offen offset:0 sc1
    buffer_load_dwordx4 v[132:135], v2, s[12:15], s34 offen offset:1024 sc1
    buffer_load_dwordx4 v[136:139], v2, s[12:15], s34 offen offset:2048 sc1
    buffer_load_dwordx4 v[140:143], v2, s[12:15], s34 offen offset:3072 sc1
    s_add_u32 s34, s34, 4096
    buffer_load_dwordx4 v[144:147], v2, s[12:15], s34 offen offset:0 sc1
    buffer_load_dwordx4 v[148:151], v2, s[12:15], s34 offen offset:1024 sc1
    buffer_load_dwordx4 v[152:155], v2, s[12:15], s34 offen offset:2048 sc1
    buffer_load_dwordx4 v[156:159], v2, s[12:15], s34 offen offset:3072 sc1
    s_add_u32 s34, s34, 4096
    v_mov_b32 v16, 0
    v_mov_b32 v17, 0
    v_mov_b32 v18, 0
    v_mov_b32 v19, 0
    v_mov_b32 v20, 0
    v_mov_b32 v21, 0
    v_mov_b32 v22, 0
    v_mov_b32 v23, 0
    v_mov_b32 v24, 0
    v_mov_b32 v25, 0
    v_mov_b32 v26, 0
    v_mov_b32 v27, 0
    v_mov_b32 v28, 0
    v_mov_b32 v29, 0
    v_mov_b32 v30, 0
    v_mov_b32 v31, 0
    v_mov_b32 v32, 0
    v_mov_b32 v33, 0
    v_mov_b32 v34, 0
    v_mov_b32 v35, 0
    v_mov_b32 v36, 0
    v_mov_b32 v37, 0
    v_mov_b32 v38, 0
    v_mov_b32 v39, 0
    v_mov_b32 v40, 0
    v_mov_b32 v41, 0
    v_mov_b32 v42, 0
    v_mov_b32 v43, 0
    v_mov_b32 v44, 0
    v_mov_b32 v45, 0
    v_mov_b32 v46, 0
    v_mov_b32 v47, 0
    v_mov_b32 v48, 0
    v_mov_b32 v49, 0
    v_mov_b32 v50, 0
    v_mov_b32 v51, 0
    v_mov_b32 v52, 0
    v_mov_b32 v53, 0
    v_mov_b32 v54, 0
    v_mov_b32 v55, 0
    v_mov_b32 v56, 0
    v_mov_b32 v57, 0
    v_mov_b32 v58, 0
    v_mov_b32 v59, 0
    v_mov_b32 v60, 0
    v_mov_b32 v61, 0
    v_mov_b32 v62, 0
    v_mov_b32 v63, 0
    v_mov_b32 v64, 0
    v_mov_b32 v65, 0
    v_mov_b32 v66, 0
    v_mov_b32 v67, 0
    v_mov_b32 v68, 0
    v_mov_b32 v69, 0
    v_mov_b32 v70, 0
    v_mov_b32 v71, 0
    v_mov_b32 v72, 0
    v_mov_b32 v73, 0
    v_mov_b32 v74, 0
    v_mov_b32 v75, 0
    v_mov_b32 v76, 0
    v_mov_b32 v77, 0
    v_mov_b32 v78, 0
    v_mov_b32 v79, 0
    s_waitcnt vmcnt(8)
    s_barrier
    ds_read_b64_tr_b16 v[80:81], v4 offset:0
    ds_read_b64_tr_b16 v[82:83], v4 offset:2048
    ds_read_b64_tr_b16 v[84:85], v4 offset:256
    ds_read_b64_tr_b16 v[86:87], v4 offset:2304
    ds_read_b64_tr_b16 v[88:89], v4 offset:512
    ds_read_b64_tr_b16 v[90:91], v4 offset:2560
    ds_read_b64_tr_b16 v[92:93], v4 offset:768
    ds_read_b64_tr_b16 v[94:95], v4 offset:2816
    ds_read_b64_tr_b16 v[96:97], v4 offset:4096
    ds_read_b64_tr_b16 v[98:99], v4 offset:6144
    ds_read_b64_tr_b16 v[100:101], v4 offset:4352
    ds_read_b64_tr_b16 v[102:103], v4 offset:6400
    ds_read_b64_tr_b16 v[104:105], v4 offset:4608
    ds_read_b64_tr_b16 v[106:107], v4 offset:6656
    ds_read_b64_tr_b16 v[108:109], v4 offset:4864
    ds_read_b64_tr_b16 v[110:111], v4 offset:6912
    s_waitcnt lgkmcnt(8)
    v_mfma_f32_32x32x16_bf16 v[16:31], v[80:83], v[112:115], v[16:31]
    v_mfma_f32_32x32x16_bf16 v[32:47], v[84:87], v[112:115], v[32:47]
    v_mfma_f32_32x32x16_bf16 v[48:63], v[88:91], v[112:115], v[48:63]
    v_mfma_f32_32x32x16_bf16 v[64:79], v[92:95], v[112:115], v[64:79]
    s_add_u32 s37, s33, 0
    s_add_u32 m0, s39, 98304
    s_nop 0
    buffer_load_dwordx4 v3, s[8:11], s37 offen lds
    s_add_u32 s37, s33, 8192
    s_add_u32 m0, s39, 99328
    s_nop 0
    buffer_load_dwordx4 v3, s[8:11], s37 offen lds
    ds_read_b64_tr_b16 v[80:81], v4 offset:8192
    ds_read_b64_tr_b16 v[82:83], v4 offset:10240
    ds_read_b64_tr_b16 v[84:85], v4 offset:8448
    ds_read_b64_tr_b16 v[86:87], v4 offset:10496
    ds_read_b64_tr_b16 v[88:89], v4 offset:8704
    ds_read_b64_tr_b16 v[90:91], v4 offset:10752
    ds_read_b64_tr_b16 v[92:93], v4 offset:8960
    ds_read_b64_tr_b16 v[94:95], v4 offset:11008
    s_waitcnt lgkmcnt(8)
    v_mfma_f32_32x32x16_bf16 v[16:31], v[96:99], v[116:119], v[16:31]
    v_mfma_f32_32x32x16_bf16 v[32:47], v[100:103], v[116:119], v[32:47]
    v_mfma_f32_32x32x16_bf16 v[48:63], v[104:107], v[116:119], v[48:63]
    v_mfma_f32_32x32x16_bf16 v[64:79], v[108:111], v[116:119], v[64:79]
    s_add_u32 s37, s33, 16384
    s_add_u32 m0, s39, 100352
    s_nop 0
    buffer_load_dwordx4 v3, s[8:11], s37 offen lds
    s_add_u32 s37, s33, 24576
    s_add_u32 m0, s39, 101376
    s_nop 0
    buffer_load_dwordx4 v3, s[8:11], s37 offen lds
    s_add_u32 s33, s33, 131072
    ds_read_b64_tr_b16 v[96:97], v4 offset:12288
    ds_read_b64_tr_b16 v[98:99], v4 offset:14336
    ds_read_b64_tr_b16 v[100:101], v4 offset:12544
    ds_read_b64_tr_b16 v[102:103], v4 offset:14592
    ds_read_b64_tr_b16 v[104:105], v4 offset:12800
    ds_read_b64_tr_b16 v[106:107], v4 offset:14848
    ds_read_b64_tr_b16 v[108:109], v4 offset:13056
    ds_read_b64_tr_b16 v[110:111], v4 offset:15104
    s_waitcnt lgkmcnt(8)
    v_mfma_f32_32x32x16_bf16 v[16:31], v[80:83], v[120:123], v[16:31]
    v_mfma_f32_32x32x16_bf16 v[32:47], v[84:87], v[120:123], v[32:47]
    v_mfma_f32_32x32x16_bf16 v[48:63], v[88:91], v[120:123], v[48:63]
    v_mfma_f32_32x32x16_bf16 v[64:79], v[92:95], v[120:123], v[64:79]
    buffer_load_dwordx4 v[160:163], v2, s[12:15], s34 offen offset:0 sc1
    buffer_load_dwordx4 v[164:167], v2, s[12:15], s34 offen offset:1024 sc1
    s_waitcnt lgkmcnt(0)
    v_mfma_f32_32x32x16_bf16 v[16:31], v[96:99], v[124:127], v[16:31]
    v_mfma_f32_32x32x16_bf16 v[32:47], v[100:103], v[124:127], v[32:47]
    v_mfma_f32_32x32x16_bf16 v[48:63], v[104:107], v[124:127], v[48:63]
    v_mfma_f32_32x32x16_bf16 v[64:79], v[108:111], v[124:127], v[64:79]
    buffer_load_dwordx4 v[168:171], v2, s[12:15], s34 offen offset:2048 sc1
    buffer_load_dwordx4 v[172:175], v2, s[12:15], s34 offen offset:3072 sc1
    s_add_u32 s34, s34, 4096
    s_waitcnt vmcnt(12)
    s_barrier
    ds_read_b64_tr_b16 v[80:81], v4 offset:32768
    ds_read_b64_tr_b16 v[82:83], v4 offset:34816
    ds_read_b64_tr_b16 v[84:85], v4 offset:33024
    ds_read_b64_tr_b16 v[86:87], v4 offset:35072
    ds_read_b64_tr_b16 v[88:89], v4 offset:33280
    ds_read_b64_tr_b16 v[90:91], v4 offset:35328
    ds_read_b64_tr_b16 v[92:93], v4 offset:33536
    ds_read_b64_tr_b16 v[94:95], v4 offset:35584
    ds_read_b64_tr_b16 v[96:97], v4 offset:36864
    ds_read_b64_tr_b16 v[98:99], v4 offset:38912
    ds_read_b64_tr_b16 v[100:101], v4 offset:37120
    ds_read_b64_tr_b16 v[102:103], v4 offset:39168
    ds_read_b64_tr_b16 v[104:105], v4 offset:37376
    ds_read_b64_tr_b16 v[106:107], v4 offset:39424
    ds_read_b64_tr_b16 v[108:109], v4 offset:37632
    ds_read_b64_tr_b16 v[110:111], v4 offset:39680
    s_waitcnt lgkmcnt(8)
    v_mfma_f32_32x32x16_bf16 v[16:31], v[80:83], v[128:131], v[16:31]
    v_mfma_f32_32x32x16_bf16 v[32:47], v[84:87], v[128:131], v[32:47]
    v_mfma_f32_32x32x16_bf16 v[48:63], v[88:91], v[128:131], v[48:63]
    v_mfma_f32_32x32x16_bf16 v[64:79], v[92:95], v[128:131], v[64:79]
    s_add_u32 s37, s33, 0
    s_add_u32 m0, s39, 0
    s_nop 0
    buffer_load_dwordx4 v3, s[8:11], s37 offen lds
    s_add_u32 s37, s33, 8192
    s_add_u32 m0, s39, 1024
    s_nop 0
    buffer_load_dwordx4 v3, s[8:11], s37 offen lds
    ds_read_b64_tr_b16 v[80:81], v4 offset:40960
    ds_read_b64_tr_b16 v[82:83], v4 offset:43008
    ds_read_b64_tr_b16 v[84:85], v4 offset:41216
    ds_read_b64_tr_b16 v[86:87], v4 offset:43264
    ds_read_b64_tr_b16 v[88:89], v4 offset:41472
    ds_read_b64_tr_b16 v[90:91], v4 offset:43520
    ds_read_b64_tr_b16 v[92:93], v4 offset:41728
    ds_read_b64_tr_b16 v[94:95], v4 offset:43776
    s_waitcnt lgkmcnt(8)
    v_mfma_f32_32x32x16_bf16 v[16:31], v[96:99], v[132:135], v[16:31]
    v_mfma_f32_32x32x16_bf16 v[32:47], v[100:103], v[132:135], v[32:47]
    v_mfma_f32_32x32x16_bf16 v[48:63], v[104:107], v[132:135], v[48:63]
    v_mfma_f32_32x32x16_bf16 v[64:79], v[108:111], v[132:135], v[64:79]
    s_add_u32 s37, s33, 16384
    s_add_u32 m0, s39, 2048
    s_nop 0
    buffer_load_dwordx4 v3, s[8:11], s37 offen lds
    s_add_u32 s37, s33, 24576
    s_add_u32 m0, s39, 3072
    s_nop 0
    buffer_load_dwordx4 v3, s[8:11], s37 offen lds
    s_add_u32 s33, s33, 131072
    ds_read_b64_tr_b16 v[96:97], v4 offset:45056
    ds_read_b64_tr_b16 v[98:99], v4 offset:47104
    ds_read_b64_tr_b16 v[100:101], v4 offset:45312
    ds_read_b64_tr_b16 v[102:103], v4 offset:47360
    ds_read_b64_tr_b16 v[104:105], v4 offset:45568
    ds_read_b64_tr_b16 v[106:107], v4 offset:47616
    ds_read_b64_tr_b16 v[108:109], v4 offset:45824
    ds_read_b64_tr_b16 v[110:111], v4 offset:47872
    s_waitcnt lgkmcnt(8)
    v_mfma_f32_32x32x16_bf16 v[16:31], v[80:83], v[136:139], v[16:31]
    v_mfma_f32_32x32x16_bf16 v[32:47], v[84:87], v[136:139], v[32:47]
    v_mfma_f32_32x32x16_bf16 v[48:63], v[88:91], v[136:139], v[48:63]
    v_mfma_f32_32x32x16_bf16 v[64:79], v[92:95], v[136:139], v[64:79]
    buffer_load_dwordx4 v[112:115], v2, s[12:15], s34 offen offset:0 sc1
    buffer_load_dwordx4 v[116:119], v2, s[12:15], s34 offen offset:1024 sc1
    s_waitcnt lgkmcnt(0)
    v_mfma_f32_32x32x16_bf16 v[16:31], v[96:99], v[140:143], v[16:31]
    v_mfma_f32_32x32x16_bf16 v[32:47], v[100:103], v[140:143], v[32:47]
    v_mfma_f32_32x32x16_bf16 v[48:63], v[104:107], v[140:143], v[48:63]
    v_mfma_f32_32x32x16_bf16 v[64:79], v[108:111], v[140:143], v[64:79]
    buffer_load_dwordx4 v[120:123], v2, s[12:15], s34 offen offset:2048 sc1
    buffer_load_dwordx4 v[124:127], v2, s[12:15], s34 offen offset:3072 sc1
    s_add_u32 s34, s34, 4096
    s_waitcnt vmcnt(16)
    s_barrier
    ds_read_b64_tr_b16 v[80:81], v5 offset:0
    ds_read_b64_tr_b16 v[82:83], v5 offset:2048
    ds_read_b64_tr_b16 v[84:85], v5 offset:256
    ds_read_b64_tr_b16 v[86:87], v5 offset:2304
    ds_read_b64_tr_b16 v[88:89], v5 offset:512
    ds_read_b64_tr_b16 v[90:91], v5 offset:2560
    ds_read_b64_tr_b16 v[92:93], v5 offset:768
    ds_read_b64_tr_b16 v[94:95], v5 offset:2816
    ds_read_b64_tr_b16 v[96:97], v5 offset:4096
    ds_read_b64_tr_b16 v[98:99], v5 offset:6144
    ds_read_b64_tr_b16 v[100:101], v5 offset:4352
    ds_read_b64_tr_b16 v[102:103], v5 offset:6400
    ds_read_b64_tr_b16 v[104:105], v5 offset:4608
    ds_read_b64_tr_b16 v[106:107], v5 offset:6656
    ds_read_b64_tr_b16 v[108:109], v5 offset:4864
    ds_read_b64_tr_b16 v[110:111], v5 offset:6912
    s_waitcnt lgkmcnt(8)
    v_mfma_f32_32x32x16_bf16 v[16:31], v[80:83], v[144:147], v[16:31]
    v_mfma_f32_32x32x16_bf16 v[32:47], v[84:87], v[144:147], v[32:47]
    v_mfma_f32_32x32x16_bf16 v[48:63], v[88:91], v[144:147], v[48:63]
    v_mfma_f32_32x32x16_bf16 v[64:79], v[92:95], v[144:147], v[64:79]
    s_add_u32 s37, s33, 0
    s_add_u32 m0, s39, 32768
    s_nop 0
    buffer_load_dwordx4 v3, s[8:11], s37 offen lds
    s_add_u32 s37, s33, 8192
    s_add_u32 m0, s39, 33792
    s_nop 0
    buffer_load_dwordx4 v3, s[8:11], s37 offen lds
    ds_read_b64_tr_b16 v[80:81], v5 offset:8192
    ds_read_b64_tr_b16 v[82:83], v5 offset:10240
    ds_read_b64_tr_b16 v[84:85], v5 offset:8448
    ds_read_b64_tr_b16 v[86:87], v5 offset:10496
    ds_read_b64_tr_b16 v[88:89], v5 offset:8704
    ds_read_b64_tr_b16 v[90:91], v5 offset:10752
    ds_read_b64_tr_b16 v[92:93], v5 offset:8960
    ds_read_b64_tr_b16 v[94:95], v5 offset:11008
    s_waitcnt lgkmcnt(8)
    v_mfma_f32_32x32x16_bf16 v[16:31], v[96:99], v[148:151], v[16:31]
    v_mfma_f32_32x32x16_bf16 v[32:47], v[100:103], v[148:151], v[32:47]
    v_mfma_f32_32x32x16_bf16 v[48:63], v[104:107], v[148:151], v[48:63]
    v_mfma_f32_32x32x16_bf16 v[64:79], v[108:111], v[148:151], v[64:79]
    s_add_u32 s37, s33, 16384
    s_add_u32 m0, s39, 34816
    s_nop 0
    buffer_load_dwordx4 v3, s[8:11], s37 offen lds
    s_add_u32 s37, s33, 24576
    s_add_u32 m0, s39, 35840
    s_nop 0
    buffer_load_dwordx4 v3, s[8:11], s37 offen lds
    s_add_u32 s33, s33, 131072
    ds_read_b64_tr_b16 v[96:97], v5 offset:12288
    ds_read_b64_tr_b16 v[98:99], v5 offset:14336
    ds_read_b64_tr_b16 v[100:101], v5 offset:12544
    ds_read_b64_tr_b16 v[102:103], v5 offset:14592
    ds_read_b64_tr_b16 v[104:105], v5 offset:12800
    ds_read_b64_tr_b16 v[106:107], v5 offset:14848
    ds_read_b64_tr_b16 v[108:109], v5 offset:13056
    ds_read_b64_tr_b16 v[110:111], v5 offset:15104
    s_waitcnt lgkmcnt(8)
    v_mfma_f32_32x32x16_bf16 v[16:31], v[80:83], v[152:155], v[16:31]
    v_mfma_f32_32x32x16_bf16 v[32:47], v[84:87], v[152:155], v[32:47]
    v_mfma_f32_32x32x16_bf16 v[48:63], v[88:91], v[152:155], v[48:63]
    v_mfma_f32_32x32x16_bf16 v[64:79], v[92:95], v[152:155], v[64:79]
    buffer_load_dwordx4 v[128:131], v2, s[12:15], s34 offen offset:0 sc1
    buffer_load_dwordx4 v[132:135], v2, s[12:15], s34 offen offset:1024 sc1
    s_waitcnt lgkmcnt(0)
    v_mfma_f32_32x32x16_bf16 v[16:31], v[96:99], v[156:159], v[16:31]
    v_mfma_f32_32x32x16_bf16 v[32:47], v[100:103], v[156:159], v[32:47]
    v_mfma_f32_32x32x16_bf16 v[48:63], v[104:107], v[156:159], v[48:63]
    v_mfma_f32_32x32x16_bf16 v[64:79], v[108:111], v[156:159], v[64:79]
    buffer_load_dwordx4 v[136:139], v2, s[12:15], s34 offen offset:2048 sc1
    buffer_load_dwordx4 v[140:143], v2, s[12:15], s34 offen offset:3072 sc1
    s_add_u32 s34, s34, 4096
    s_waitcnt vmcnt(16)
    s_barrier
    ds_read_b64_tr_b16 v[80:81], v5 offset:32768
    ds_read_b64_tr_b16 v[82:83], v5 offset:34816
    ds_read_b64_tr_b16 v[84:85], v5 offset:33024
    ds_read_b64_tr_b16 v[86:87], v5 offset:35072
    ds_read_b64_tr_b16 v[88:89], v5 offset:33280
    ds_read_b64_tr_b16 v[90:91], v5 offset:35328
    ds_read_b64_tr_b16 v[92:93], v5 offset:33536
    ds_read_b64_tr_b16 v[94:95], v5 offset:35584
    ds_read_b64_tr_b16 v[96:97], v5 offset:36864
    ds_read_b64_tr_b16 v[98:99], v5 offset:38912
    ds_read_b64_tr_b16 v[100:101], v5 offset:37120
    ds_read_b64_tr_b16 v[102:103], v5 offset:39168
    ds_read_b64_tr_b16 v[104:105], v5 offset:37376
    ds_read_b64_tr_b16 v[106:107], v5 offset:39424
    ds_read_b64_tr_b16 v[108:109], v5 offset:37632
    ds_read_b64_tr_b16 v[110:111], v5 offset:39680
    s_waitcnt lgkmcnt(8)
    v_mfma_f32_32x32x16_bf16 v[16:31], v[80:83], v[160:163], v[16:31]
    v_mfma_f32_32x32x16_bf16 v[32:47], v[84:87], v[160:163], v[32:47]
    v_mfma_f32_32x32x16_bf16 v[48:63], v[88:91], v[160:163], v[48:63]
    v_mfma_f32_32x32x16_bf16 v[64:79], v[92:95], v[160:163], v[64:79]
    s_add_u32 s37, s33, 0
    s_add_u32 m0, s39, 65536
    s_nop 0
    buffer_load_dwordx4 v3, s[8:11], s37 offen lds
    s_add_u32 s37, s33, 8192
    s_add_u32 m0, s39, 66560
    s_nop 0
    buffer_load_dwordx4 v3, s[8:11], s37 offen lds
    ds_read_b64_tr_b16 v[80:81], v5 offset:40960
    ds_read_b64_tr_b16 v[82:83], v5 offset:43008
    ds_read_b64_tr_b16 v[84:85], v5 offset:41216
    ds_read_b64_tr_b16 v[86:87], v5 offset:43264
    ds_read_b64_tr_b16 v[88:89], v5 offset:41472
    ds_read_b64_tr_b16 v[90:91], v5 offset:43520
    ds_read_b64_tr_b16 v[92:93], v5 offset:41728
    ds_read_b64_tr_b16 v[94:95], v5 offset:43776
    s_waitcnt lgkmcnt(8)
    v_mfma_f32_32x32x16_bf16 v[16:31], v[96:99], v[164:167], v[16:31]
    v_mfma_f32_32x32x16_bf16 v[32:47], v[100:103], v[164:167], v[32:47]
    v_mfma_f32_32x32x16_bf16 v[48:63], v[104:107], v[164:167], v[48:63]
    v_mfma_f32_32x32x16_bf16 v[64:79], v[108:111], v[164:167], v[64:79]
    s_add_u32 s37, s33, 16384
    s_add_u32 m0, s39, 67584
    s_nop 0
    buffer_load_dwordx4 v3, s[8:11], s37 offen lds
    s_add_u32 s37, s33, 24576
    s_add_u32 m0, s39, 68608
    s_nop 0
    buffer_load_dwordx4 v3, s[8:11], s37 offen lds
    s_add_u32 s33, s33, 131072
    ds_read_b64_tr_b16 v[96:97], v5 offset:45056
    ds_read_b64_tr_b16 v[98:99], v5 offset:47104
    ds_read_b64_tr_b16 v[100:101], v5 offset:45312
    ds_read_b64_tr_b16 v[102:103], v5 offset:47360
    ds_read_b64_tr_b16 v[104:105], v5 offset:45568
    ds_read_b64_tr_b16 v[106:107], v5 offset:47616
    ds_read_b64_tr_b16 v[108:109], v5 offset:45824
    ds_read_b64_tr_b16 v[110:111], v5 offset:47872
    s_waitcnt lgkmcnt(8)
    v_mfma_f32_32x32x16_bf16 v[16:31], v[80:83], v[168:171], v[16:31]
    v_mfma_f32_32x32x16_bf16 v[32:47], v[84:87], v[168:171], v[32:47]
    v_mfma_f32_32x32x16_bf16 v[48:63], v[88:91], v[168:171], v[48:63]
    v_mfma_f32_32x32x16_bf16 v[64:79], v[92:95], v[168:171], v[64:79]
    buffer_load_dwordx4 v[144:147], v2, s[12:15], s34 offen offset:0 sc1
    buffer_load_dwordx4 v[148:151], v2, s[12:15], s34 offen offset:1024 sc1
    s_waitcnt lgkmcnt(0)
    v_mfma_f32_32x32x16_bf16 v[16:31], v[96:99], v[172:175], v[16:31]
    v_mfma_f32_32x32x16_bf16 v[32:47], v[100:103], v[172:175], v[32:47]
    v_mfma_f32_32x32x16_bf16 v[48:63], v[104:107], v[172:175], v[48:63]
    v_mfma_f32_32x32x16_bf16 v[64:79], v[108:111], v[172:175], v[64:79]
    buffer_load_dwordx4 v[152:155], v2, s[12:15], s34 offen offset:2048 sc1
    buffer_load_dwordx4 v[156:159], v2, s[12:15], s34 offen offset:3072 sc1
    s_add_u32 s34, s34, 4096
    s_waitcnt vmcnt(16)
    s_barrier
    ds_read_b64_tr_b16 v[80:81], v4 offset:0
    ds_read_b64_tr_b16 v[82:83], v4 offset:2048
    ds_read_b64_tr_b16 v[84:85], v4 offset:256
    ds_read_b64_tr_b16 v[86:87], v4 offset:2304
    ds_read_b64_tr_b16 v[88:89], v4 offset:512
    ds_read_b64_tr_b16 v[90:91], v4 offset:2560
    ds_read_b64_tr_b16 v[92:93], v4 offset:768
    ds_read_b64_tr_b16 v[94:95], v4 offset:2816
    ds_read_b64_tr_b16 v[96:97], v4 offset:4096
    ds_read_b64_tr_b16 v[98:99], v4 offset:6144
    ds_read_b64_tr_b16 v[100:101], v4 offset:4352
    ds_read_b64_tr_b16 v[102:103], v4 offset:6400
    ds_read_b64_tr_b16 v[104:105], v4 offset:4608
    ds_read_b64_tr_b16 v[106:107], v4 offset:6656
    ds_read_b64_tr_b16 v[108:109], v4 offset:4864
    ds_read_b64_tr_b16 v[110:111], v4 offset:6912
    s_waitcnt lgkmcnt(8)
    v_mfma_f32_32x32x16_bf16 v[16:31], v[80:83], v[112:115], v[16:31]
    v_mfma_f32_32x32x16_bf16 v[32:47], v[84:87], v[112:115], v[32:47]
    v_mfma_f32_32x32x16_bf16 v[48:63], v[88:91], v[112:115], v[48:63]
    v_mfma_f32_32x32x16_bf16 v[64:79], v[92:95], v[112:115], v[64:79]
    s_add_u32 s37, s33, 0
    s_add_u32 m0, s39, 98304
    s_nop 0
    buffer_load_dwordx4 v3, s[8:11], s37 offen lds
    s_add_u32 s37, s33, 8192
    s_add_u32 m0, s39, 99328
    s_nop 0
    buffer_load_dwordx4 v3, s[8:11], s37 offen lds
    ds_read_b64_tr_b16 v[80:81], v4 offset:8192
    ds_read_b64_tr_b16 v[82:83], v4 offset:10240
    ds_read_b64_tr_b16 v[84:85], v4 offset:8448
    ds_read_b64_tr_b16 v[86:87], v4 offset:10496
    ds_read_b64_tr_b16 v[88:89], v4 offset:8704
    ds_read_b64_tr_b16 v[90:91], v4 offset:10752
    ds_read_b64_tr_b16 v[92:93], v4 offset:8960
    ds_read_b64_tr_b16 v[94:95], v4 offset:11008
    s_waitcnt lgkmcnt(8)
    v_mfma_f32_32x32x16_bf16 v[16:31], v[96:99], v[116:119], v[16:31]
    v_mfma_f32_32x32x16_bf16 v[32:47], v[100:103], v[116:119], v[32:47]
    v_mfma_f32_32x32x16_bf16 v[48:63], v[104:107], v[116:119], v[48:63]
    v_mfma_f32_32x32x16_bf16 v[64:79], v[108:111], v[116:119], v[64:79]
    s_add_u32 s37, s33, 16384
    s_add_u32 m0, s39, 100352
    s_nop 0
    buffer_load_dwordx4 v3, s[8:11], s37 offen lds
    s_add_u32 s37, s33, 24576
    s_add_u32 m0, s39, 101376
    s_nop 0
    buffer_load_dwordx4 v3, s[8:11], s37 offen lds
    s_add_u32 s33, s33, 131072
    ds_read_b64_tr_b16 v[96:97], v4 offset:12288
    ds_read_b64_tr_b16 v[98:99], v4 offset:14336
    ds_read_b64_tr_b16 v[100:101], v4 offset:12544
    ds_read_b64_tr_b16 v[102:103], v4 offset:14592
    ds_read_b64_tr_b16 v[104:105], v4 offset:12800
    ds_read_b64_tr_b16 v[106:107], v4 offset:14848
    ds_read_b64_tr_b16 v[108:109], v4 offset:13056
    ds_read_b64_tr_b16 v[110:111], v4 offset:15104
    s_waitcnt lgkmcnt(8)
    v_mfma_f32_32x32x16_bf16 v[16:31], v[80:83], v[120:123], v[16:31]
    v_mfma_f32_32x32x16_bf16 v[32:47], v[84:87], v[120:123], v[32:47]
    v_mfma_f32_32x32x16_bf16 v[48:63], v[88:91], v[120:123], v[48:63]
    v_mfma_f32_32x32x16_bf16 v[64:79], v[92:95], v[120:123], v[64:79]
    buffer_load_dwordx4 v[160:163], v2, s[12:15], s34 offen offset:0 sc1
    buffer_load_dwordx4 v[164:167], v2, s[12:15], s34 offen offset:1024 sc1
    s_waitcnt lgkmcnt(0)
    v_mfma_f32_32x32x16_bf16 v[16:31], v[96:99], v[124:127], v[16:31]
    v_mfma_f32_32x32x16_bf16 v[32:47], v[100:103], v[124:127], v[32:47]
    v_mfma_f32_32x32x16_bf16 v[48:63], v[104:107], v[124:127], v[48:63]
    v_mfma_f32_32x32x16_bf16 v[64:79], v[108:111], v[124:127], v[64:79]
    buffer_load_dwordx4 v[168:171], v2, s[12:15], s34 offen offset:2048 sc1
    buffer_load_dwordx4 v[172:175], v2, s[12:15], s34 offen offset:3072 sc1
    s_add_u32 s34, s34, 4096
    s_waitcnt vmcnt(16)
    s_barrier
    ds_read_b64_tr_b16 v[80:81], v4 offset:32768
    ds_read_b64_tr_b16 v[82:83], v4 offset:34816
    ds_read_b64_tr_b16 v[84:85], v4 offset:33024
    ds_read_b64_tr_b16 v[86:87], v4 offset:35072
    ds_read_b64_tr_b16 v[88:89], v4 offset:33280
    ds_read_b64_tr_b16 v[90:91], v4 offset:35328
    ds_read_b64_tr_b16 v[92:93], v4 offset:33536
    ds_read_b64_tr_b16 v[94:95], v4 offset:35584
    ds_read_b64_tr_b16 v[96:97], v4 offset:36864
    ds_read_b64_tr_b16 v[98:99], v4 offset:38912
    ds_read_b64_tr_b16 v[100:101], v4 offset:37120
    ds_read_b64_tr_b16 v[102:103], v4 offset:39168
    ds_read_b64_tr_b16 v[104:105], v4 offset:37376
    ds_read_b64_tr_b16 v[106:107], v4 offset:39424
    ds_read_b64_tr_b16 v[108:109], v4 offset:37632
    ds_read_b64_tr_b16 v[110:111], v4 offset:39680
    s_waitcnt lgkmcnt(8)
    v_mfma_f32_32x32x16_bf16 v[16:31], v[80:83], v[128:131], v[16:31]
    v_mfma_f32_32x32x16_bf16 v[32:47], v[84:87], v[128:131], v[32:47]
    v_mfma_f32_32x32x16_bf16 v[48:63], v[88:91], v[128:131], v[48:63]
    v_mfma_f32_32x32x16_bf16 v[64:79], v[92:95], v[128:131], v[64:79]
    s_add_u32 s37, s33, 0
    s_add_u32 m0, s39, 0
    s_nop 0
    buffer_load_dwordx4 v3, s[8:11], s37 offen lds
    s_add_u32 s37, s33, 8192
    s_add_u32 m0, s39, 1024
    s_nop 0
    buffer_load_dwordx4 v3, s[8:11], s37 offen lds
    ds_read_b64_tr_b16 v[80:81], v4 offset:40960
    ds_read_b64_tr_b16 v[82:83], v4 offset:43008
    ds_read_b64_tr_b16 v[84:85], v4 offset:41216
    ds_read_b64_tr_b16 v[86:87], v4 offset:43264
    ds_read_b64_tr_b16 v[88:89], v4 offset:41472
    ds_read_b64_tr_b16 v[90:91], v4 offset:43520
    ds_read_b64_tr_b16 v[92:93], v4 offset:41728
    ds_read_b64_tr_b16 v[94:95], v4 offset:43776
    s_waitcnt lgkmcnt(8)
    v_mfma_f32_32x32x16_bf16 v[16:31], v[96:99], v[132:135], v[16:31]
    v_mfma_f32_32x32x16_bf16 v[32:47], v[100:103], v[132:135], v[32:47]
    v_mfma_f32_32x32x16_bf16 v[48:63], v[104:107], v[132:135], v[48:63]
    v_mfma_f32_32x32x16_bf16 v[64:79], v[108:111], v[132:135], v[64:79]
    s_add_u32 s37, s33, 16384
    s_add_u32 m0, s39, 2048
    s_nop 0
    buffer_load_dwordx4 v3, s[8:11], s37 offen lds
    s_add_u32 s37, s33, 24576
    s_add_u32 m0, s39, 3072
    s_nop 0
    buffer_load_dwordx4 v3, s[8:11], s37 offen lds
    s_add_u32 s33, s33, 131072
    ds_read_b64_tr_b16 v[96:97], v4 offset:45056
    ds_read_b64_tr_b16 v[98:99], v4 offset:47104
    ds_read_b64_tr_b16 v[100:101], v4 offset:45312
    ds_read_b64_tr_b16 v[102:103], v4 offset:47360
    ds_read_b64_tr_b16 v[104:105], v4 offset:45568
    ds_read_b64_tr_b16 v[106:107], v4 offset:47616
    ds_read_b64_tr_b16 v[108:109], v4 offset:45824
    ds_read_b64_tr_b16 v[110:111], v4 offset:47872
    s_waitcnt lgkmcnt(8)
    v_mfma_f32_32x32x16_bf16 v[16:31], v[80:83], v[136:139], v[16:31]
    v_mfma_f32_32x32x16_bf16 v[32:47], v[84:87], v[136:139], v[32:47]
    v_mfma_f32_32x32x16_bf16 v[48:63], v[88:91], v[136:139], v[48:63]
    v_mfma_f32_32x32x16_bf16 v[64:79], v[92:95], v[136:139], v[64:79]
    buffer_load_dwordx4 v[112:115], v2, s[12:15], s34 offen offset:0 sc1
    buffer_load_dwordx4 v[116:119], v2, s[12:15], s34 offen offset:1024 sc1
    s_waitcnt lgkmcnt(0)
    v_mfma_f32_32x32x16_bf16 v[16:31], v[96:99], v[140:143], v[16:31]
    v_mfma_f32_32x32x16_bf16 v[32:47], v[100:103], v[140:143], v[32:47]
    v_mfma_f32_32x32x16_bf16 v[48:63], v[104:107], v[140:143], v[48:63]
    v_mfma_f32_32x32x16_bf16 v[64:79], v[108:111], v[140:143], v[64:79]
    buffer_load_dwordx4 v[120:123], v2, s[12:15], s34 offen offset:2048 sc1
    buffer_load_dwordx4 v[124:127], v2, s[12:15], s34 offen offset:3072 sc1
    s_add_u32 s34, s34, 4096
    s_waitcnt vmcnt(16)
    s_barrier
    ds_read_b64_tr_b16 v[80:81], v5 offset:0
    ds_read_b64_tr_b16 v[82:83], v5 offset:2048
    ds_read_b64_tr_b16 v[84:85], v5 offset:256
    ds_read_b64_tr_b16 v[86:87], v5 offset:2304
    ds_read_b64_tr_b16 v[88:89], v5 offset:512
    ds_read_b64_tr_b16 v[90:91], v5 offset:2560
    ds_read_b64_tr_b16 v[92:93], v5 offset:768
    ds_read_b64_tr_b16 v[94:95], v5 offset:2816
    ds_read_b64_tr_b16 v[96:97], v5 offset:4096
    ds_read_b64_tr_b16 v[98:99], v5 offset:6144
    ds_read_b64_tr_b16 v[100:101], v5 offset:4352
    ds_read_b64_tr_b16 v[102:103], v5 offset:6400
    ds_read_b64_tr_b16 v[104:105], v5 offset:4608
    ds_read_b64_tr_b16 v[106:107], v5 offset:6656
    ds_read_b64_tr_b16 v[108:109], v5 offset:4864
    ds_read_b64_tr_b16 v[110:111], v5 offset:6912
    s_waitcnt lgkmcnt(8)
    v_mfma_f32_32x32x16_bf16 v[16:31], v[80:83], v[144:147], v[16:31]
    v_mfma_f32_32x32x16_bf16 v[32:47], v[84:87], v[144:147], v[32:47]
    v_mfma_f32_32x32x16_bf16 v[48:63], v[88:91], v[144:147], v[48:63]
    v_mfma_f32_32x32x16_bf16 v[64:79], v[92:95], v[144:147], v[64:79]
    s_add_u32 s37, s33, 0
    s_add_u32 m0, s39, 32768
    s_nop 0
    buffer_load_dwordx4 v3, s[8:11], s37 offen lds
    s_add_u32 s37, s33, 8192
    s_add_u32 m0, s39, 33792
    s_nop 0
    buffer_load_dwordx4 v3, s[8:11], s37 offen lds
    ds_read_b64_tr_b16 v[80:81], v5 offset:8192
    ds_read_b64_tr_b16 v[82:83], v5 offset:10240
    ds_read_b64_tr_b16 v[84:85], v5 offset:8448
    ds_read_b64_tr_b16 v[86:87], v5 offset:10496
    ds_read_b64_tr_b16 v[88:89], v5 offset:8704
    ds_read_b64_tr_b16 v[90:91], v5 offset:10752
    ds_read_b64_tr_b16 v[92:93], v5 offset:8960
    ds_read_b64_tr_b16 v[94:95], v5 offset:11008
    s_waitcnt lgkmcnt(8)
    v_mfma_f32_32x32x16_bf16 v[16:31], v[96:99], v[148:151], v[16:31]
    v_mfma_f32_32x32x16_bf16 v[32:47], v[100:103], v[148:151], v[32:47]
    v_mfma_f32_32x32x16_bf16 v[48:63], v[104:107], v[148:151], v[48:63]
    v_mfma_f32_32x32x16_bf16 v[64:79], v[108:111], v[148:151], v[64:79]
    s_add_u32 s37, s33, 16384
    s_add_u32 m0, s39, 34816
    s_nop 0
    buffer_load_dwordx4 v3, s[8:11], s37 offen lds
    s_add_u32 s37, s33, 24576
    s_add_u32 m0, s39, 35840
    s_nop 0
    buffer_load_dwordx4 v3, s[8:11], s37 offen lds
    s_add_u32 s33, s33, 131072
    ds_read_b64_tr_b16 v[96:97], v5 offset:12288
    ds_read_b64_tr_b16 v[98:99], v5 offset:14336
    ds_read_b64_tr_b16 v[100:101], v5 offset:12544
    ds_read_b64_tr_b16 v[102:103], v5 offset:14592
    ds_read_b64_tr_b16 v[104:105], v5 offset:12800
    ds_read_b64_tr_b16 v[106:107], v5 offset:14848
    ds_read_b64_tr_b16 v[108:109], v5 offset:13056
    ds_read_b64_tr_b16 v[110:111], v5 offset:15104
    s_waitcnt lgkmcnt(8)
    v_mfma_f32_32x32x16_bf16 v[16:31], v[80:83], v[152:155], v[16:31]
    v_mfma_f32_32x32x16_bf16 v[32:47], v[84:87], v[152:155], v[32:47]
    v_mfma_f32_32x32x16_bf16 v[48:63], v[88:91], v[152:155], v[48:63]
    v_mfma_f32_32x32x16_bf16 v[64:79], v[92:95], v[152:155], v[64:79]
    buffer_load_dwordx4 v[128:131], v2, s[12:15], s34 offen offset:0 sc1
    buffer_load_dwordx4 v[132:135], v2, s[12:15], s34 offen offset:1024 sc1
    s_waitcnt lgkmcnt(0)
    v_mfma_f32_32x32x16_bf16 v[16:31], v[96:99], v[156:159], v[16:31]
    v_mfma_f32_32x32x16_bf16 v[32:47], v[100:103], v[156:159], v[32:47]
    v_mfma_f32_32x32x16_bf16 v[48:63], v[104:107], v[156:159], v[48:63]
    v_mfma_f32_32x32x16_bf16 v[64:79], v[108:111], v[156:159], v[64:79]
    buffer_load_dwordx4 v[136:139], v2, s[12:15], s34 offen offset:2048 sc1
    buffer_load_dwordx4 v[140:143], v2, s[12:15], s34 offen offset:3072 sc1
    s_add_u32 s34, s34, 4096
    s_waitcnt vmcnt(16)
    s_barrier
    ds_read_b64_tr_b16 v[80:81], v5 offset:32768
    ds_read_b64_tr_b16 v[82:83], v5 offset:34816
    ds_read_b64_tr_b16 v[84:85], v5 offset:33024
    ds_read_b64_tr_b16 v[86:87], v5 offset:35072
    ds_read_b64_tr_b16 v[88:89], v5 offset:33280
    ds_read_b64_tr_b16 v[90:91], v5 offset:35328
    ds_read_b64_tr_b16 v[92:93], v5 offset:33536
    ds_read_b64_tr_b16 v[94:95], v5 offset:35584
    ds_read_b64_tr_b16 v[96:97], v5 offset:36864
    ds_read_b64_tr_b16 v[98:99], v5 offset:38912
    ds_read_b64_tr_b16 v[100:101], v5 offset:37120
    ds_read_b64_tr_b16 v[102:103], v5 offset:39168
    ds_read_b64_tr_b16 v[104:105], v5 offset:37376
    ds_read_b64_tr_b16 v[106:107], v5 offset:39424
    ds_read_b64_tr_b16 v[108:109], v5 offset:37632
    ds_read_b64_tr_b16 v[110:111], v5 offset:39680
    s_waitcnt lgkmcnt(8)
    v_mfma_f32_32x32x16_bf16 v[16:31], v[80:83], v[160:163], v[16:31]
    v_mfma_f32_32x32x16_bf16 v[32:47], v[84:87], v[160:163], v[32:47]
    v_mfma_f32_32x32x16_bf16 v[48:63], v[88:91], v[160:163], v[48:63]
    v_mfma_f32_32x32x16_bf16 v[64:79], v[92:95], v[160:163], v[64:79]
    s_add_u32 s37, s33, 0
    s_add_u32 m0, s39, 65536
    s_nop 0
    buffer_load_dwordx4 v3, s[8:11], s37 offen lds
    s_add_u32 s37, s33, 8192
    s_add_u32 m0, s39, 66560
    s_nop 0
    buffer_load_dwordx4 v3, s[8:11], s37 offen lds
    ds_read_b64_tr_b16 v[80:81], v5 offset:40960
    ds_read_b64_tr_b16 v[82:83], v5 offset:43008
    ds_read_b64_tr_b16 v[84:85], v5 offset:41216
    ds_read_b64_tr_b16 v[86:87], v5 offset:43264
    ds_read_b64_tr_b16 v[88:89], v5 offset:41472
    ds_read_b64_tr_b16 v[90:91], v5 offset:43520
    ds_read_b64_tr_b16 v[92:93], v5 offset:41728
    ds_read_b64_tr_b16 v[94:95], v5 offset:43776
    s_waitcnt lgkmcnt(8)
    v_mfma_f32_32x32x16_bf16 v[16:31], v[96:99], v[164:167], v[16:31]
    v_mfma_f32_32x32x16_bf16 v[32:47], v[100:103], v[164:167], v[32:47]
    v_mfma_f32_32x32x16_bf16 v[48:63], v[104:107], v[164:167], v[48:63]
    v_mfma_f32_32x32x16_bf16 v[64:79], v[108:111], v[164:167], v[64:79]
    s_add_u32 s37, s33, 16384
    s_add_u32 m0, s39, 67584
    s_nop 0
    buffer_load_dwordx4 v3, s[8:11], s37 offen lds
    s_add_u32 s37, s33, 24576
    s_add_u32 m0, s39, 68608
    s_nop 0
    buffer_load_dwordx4 v3, s[8:11], s37 offen lds
    s_add_u32 s33, s33, 131072
    ds_read_b64_tr_b16 v[96:97], v5 offset:45056
    ds_read_b64_tr_b16 v[98:99], v5 offset:47104
    ds_read_b64_tr_b16 v[100:101], v5 offset:45312
    ds_read_b64_tr_b16 v[102:103], v5 offset:47360
    ds_read_b64_tr_b16 v[104:105], v5 offset:45568
    ds_read_b64_tr_b16 v[106:107], v5 offset:47616
    ds_read_b64_tr_b16 v[108:109], v5 offset:45824
    ds_read_b64_tr_b16 v[110:111], v5 offset:47872
    s_waitcnt lgkmcnt(8)
    v_mfma_f32_32x32x16_bf16 v[16:31], v[80:83], v[168:171], v[16:31]
    v_mfma_f32_32x32x16_bf16 v[32:47], v[84:87], v[168:171], v[32:47]
    v_mfma_f32_32x32x16_bf16 v[48:63], v[88:91], v[168:171], v[48:63]
    v_mfma_f32_32x32x16_bf16 v[64:79], v[92:95], v[168:171], v[64:79]
    buffer_load_dwordx4 v[144:147], v2, s[12:15], s34 offen offset:0 sc1
    buffer_load_dwordx4 v[148:151], v2, s[12:15], s34 offen offset:1024 sc1
    s_waitcnt lgkmcnt(0)
    v_mfma_f32_32x32x16_bf16 v[16:31], v[96:99], v[172:175], v[16:31]
    v_mfma_f32_32x32x16_bf16 v[32:47], v[100:103], v[172:175], v[32:47]
    v_mfma_f32_32x32x16_bf16 v[48:63], v[104:107], v[172:175], v[48:63]
    v_mfma_f32_32x32x16_bf16 v[64:79], v[108:111], v[172:175], v[64:79]
    buffer_load_dwordx4 v[152:155], v2, s[12:15], s34 offen offset:2048 sc1
    buffer_load_dwordx4 v[156:159], v2, s[12:15], s34 offen offset:3072 sc1
    s_add_u32 s34, s34, 4096
    s_waitcnt vmcnt(16)
    s_barrier
    ds_read_b64_tr_b16 v[80:81], v4 offset:0
    ds_read_b64_tr_b16 v[82:83], v4 offset:2048
    ds_read_b64_tr_b16 v[84:85], v4 offset:256
    ds_read_b64_tr_b16 v[86:87], v4 offset:2304
    ds_read_b64_tr_b16 v[88:89], v4 offset:512
    ds_read_b64_tr_b16 v[90:91], v4 offset:2560
    ds_read_b64_tr_b16 v[92:93], v4 offset:768
    ds_read_b64_tr_b16 v[94:95], v4 offset:2816
    ds_read_b64_tr_b16 v[96:97], v4 offset:4096
    ds_read_b64_tr_b16 v[98:99], v4 offset:6144
    ds_read_b64_tr_b16 v[100:101], v4 offset:4352
    ds_read_b64_tr_b16 v[102:103], v4 offset:6400
    ds_read_b64_tr_b16 v[104:105], v4 offset:4608
    ds_read_b64_tr_b16 v[106:107], v4 offset:6656
    ds_read_b64_tr_b16 v[108:109], v4 offset:4864
    ds_read_b64_tr_b16 v[110:111], v4 offset:6912
    s_waitcnt lgkmcnt(8)
    v_mfma_f32_32x32x16_bf16 v[16:31], v[80:83], v[112:115], v[16:31]
    v_mfma_f32_32x32x16_bf16 v[32:47], v[84:87], v[112:115], v[32:47]
    v_mfma_f32_32x32x16_bf16 v[48:63], v[88:91], v[112:115], v[48:63]
    v_mfma_f32_32x32x16_bf16 v[64:79], v[92:95], v[112:115], v[64:79]
    s_add_u32 s37, s33, 0
    s_add_u32 m0, s39, 98304
    s_nop 0
    buffer_load_dwordx4 v3, s[8:11], s37 offen lds
    s_add_u32 s37, s33, 8192
    s_add_u32 m0, s39, 99328
    s_nop 0
    buffer_load_dwordx4 v3, s[8:11], s37 offen lds
    ds_read_b64_tr_b16 v[80:81], v4 offset:8192
    ds_read_b64_tr_b16 v[82:83], v4 offset:10240
    ds_read_b64_tr_b16 v[84:85], v4 offset:8448
    ds_read_b64_tr_b16 v[86:87], v4 offset:10496
    ds_read_b64_tr_b16 v[88:89], v4 offset:8704
    ds_read_b64_tr_b16 v[90:91], v4 offset:10752
    ds_read_b64_tr_b16 v[92:93], v4 offset:8960
    ds_read_b64_tr_b16 v[94:95], v4 offset:11008
    s_waitcnt lgkmcnt(8)
    v_mfma_f32_32x32x16_bf16 v[16:31], v[96:99], v[116:119], v[16:31]
    v_mfma_f32_32x32x16_bf16 v[32:47], v[100:103], v[116:119], v[32:47]
    v_mfma_f32_32x32x16_bf16 v[48:63], v[104:107], v[116:119], v[48:63]
    v_mfma_f32_32x32x16_bf16 v[64:79], v[108:111], v[116:119], v[64:79]
    s_add_u32 s37, s33, 16384
    s_add_u32 m0, s39, 100352
    s_nop 0
    buffer_load_dwordx4 v3, s[8:11], s37 offen lds
    s_add_u32 s37, s33, 24576
    s_add_u32 m0, s39, 101376
    s_nop 0
    buffer_load_dwordx4 v3, s[8:11], s37 offen lds
    s_add_u32 s33, s33, 131072
    ds_read_b64_tr_b16 v[96:97], v4 offset:12288
    ds_read_b64_tr_b16 v[98:99], v4 offset:14336
    ds_read_b64_tr_b16 v[100:101], v4 offset:12544
    ds_read_b64_tr_b16 v[102:103], v4 offset:14592
    ds_read_b64_tr_b16 v[104:105], v4 offset:12800
    ds_read_b64_tr_b16 v[106:107], v4 offset:14848
    ds_read_b64_tr_b16 v[108:109], v4 offset:13056
    ds_read_b64_tr_b16 v[110:111], v4 offset:15104
    s_waitcnt lgkmcnt(8)
    v_mfma_f32_32x32x16_bf16 v[16:31], v[80:83], v[120:123], v[16:31]
    v_mfma_f32_32x32x16_bf16 v[32:47], v[84:87], v[120:123], v[32:47]
    v_mfma_f32_32x32x16_bf16 v[48:63], v[88:91], v[120:123], v[48:63]
    v_mfma_f32_32x32x16_bf16 v[64:79], v[92:95], v[120:123], v[64:79]
    buffer_load_dwordx4 v[160:163], v2, s[12:15], s34 offen offset:0 sc1
    buffer_load_dwordx4 v[164:167], v2, s[12:15], s34 offen offset:1024 sc1
    s_waitcnt lgkmcnt(0)
    v_mfma_f32_32x32x16_bf16 v[16:31], v[96:99], v[124:127], v[16:31]
    v_mfma_f32_32x32x16_bf16 v[32:47], v[100:103], v[124:127], v[32:47]
    v_mfma_f32_32x32x16_bf16 v[48:63], v[104:107], v[124:127], v[48:63]
    v_mfma_f32_32x32x16_bf16 v[64:79], v[108:111], v[124:127], v[64:79]
    buffer_load_dwordx4 v[168:171], v2, s[12:15], s34 offen offset:2048 sc1
    buffer_load_dwordx4 v[172:175], v2, s[12:15], s34 offen offset:3072 sc1
    s_add_u32 s34, s34, 4096
    s_waitcnt vmcnt(16)
    s_barrier
    ds_read_b64_tr_b16 v[80:81], v4 offset:32768
    ds_read_b64_tr_b16 v[82:83], v4 offset:34816
    ds_read_b64_tr_b16 v[84:85], v4 offset:33024
    ds_read_b64_tr_b16 v[86:87], v4 offset:35072
    ds_read_b64_tr_b16 v[88:89], v4 offset:33280
    ds_read_b64_tr_b16 v[90:91], v4 offset:35328
    ds_read_b64_tr_b16 v[92:93], v4 offset:33536
    ds_read_b64_tr_b16 v[94:95], v4 offset:35584
    ds_read_b64_tr_b16 v[96:97], v4 offset:36864
    ds_read_b64_tr_b16 v[98:99], v4 offset:38912
    ds_read_b64_tr_b16 v[100:101], v4 offset:37120
    ds_read_b64_tr_b16 v[102:103], v4 offset:39168
    ds_read_b64_tr_b16 v[104:105], v4 offset:37376
    ds_read_b64_tr_b16 v[106:107], v4 offset:39424
    ds_read_b64_tr_b16 v[108:109], v4 offset:37632
    ds_read_b64_tr_b16 v[110:111], v4 offset:39680
    s_waitcnt lgkmcnt(8)
    v_mfma_f32_32x32x16_bf16 v[16:31], v[80:83], v[128:131], v[16:31]
    v_mfma_f32_32x32x16_bf16 v[32:47], v[84:87], v[128:131], v[32:47]
    v_mfma_f32_32x32x16_bf16 v[48:63], v[88:91], v[128:131], v[48:63]
    v_mfma_f32_32x32x16_bf16 v[64:79], v[92:95], v[128:131], v[64:79]
    s_add_u32 s37, s33, 0
    s_add_u32 m0, s39, 0
    s_nop 0
    buffer_load_dwordx4 v3, s[8:11], s37 offen lds
    s_add_u32 s37, s33, 8192
    s_add_u32 m0, s39, 1024
    s_nop 0
    buffer_load_dwordx4 v3, s[8:11], s37 offen lds
    ds_read_b64_tr_b16 v[80:81], v4 offset:40960
    ds_read_b64_tr_b16 v[82:83], v4 offset:43008
    ds_read_b64_tr_b16 v[84:85], v4 offset:41216
    ds_read_b64_tr_b16 v[86:87], v4 offset:43264
    ds_read_b64_tr_b16 v[88:89], v4 offset:41472
    ds_read_b64_tr_b16 v[90:91], v4 offset:43520
    ds_read_b64_tr_b16 v[92:93], v4 offset:41728
    ds_read_b64_tr_b16 v[94:95], v4 offset:43776
    s_waitcnt lgkmcnt(8)
    v_mfma_f32_32x32x16_bf16 v[16:31], v[96:99], v[132:135], v[16:31]
    v_mfma_f32_32x32x16_bf16 v[32:47], v[100:103], v[132:135], v[32:47]
    v_mfma_f32_32x32x16_bf16 v[48:63], v[104:107], v[132:135], v[48:63]
    v_mfma_f32_32x32x16_bf16 v[64:79], v[108:111], v[132:135], v[64:79]
    s_add_u32 s37, s33, 16384
    s_add_u32 m0, s39, 2048
    s_nop 0
    buffer_load_dwordx4 v3, s[8:11], s37 offen lds
    s_add_u32 s37, s33, 24576
    s_add_u32 m0, s39, 3072
    s_nop 0
    buffer_load_dwordx4 v3, s[8:11], s37 offen lds
    s_add_u32 s33, s33, 131072
    ds_read_b64_tr_b16 v[96:97], v4 offset:45056
    ds_read_b64_tr_b16 v[98:99], v4 offset:47104
    ds_read_b64_tr_b16 v[100:101], v4 offset:45312
    ds_read_b64_tr_b16 v[102:103], v4 offset:47360
    ds_read_b64_tr_b16 v[104:105], v4 offset:45568
    ds_read_b64_tr_b16 v[106:107], v4 offset:47616
    ds_read_b64_tr_b16 v[108:109], v4 offset:45824
    ds_read_b64_tr_b16 v[110:111], v4 offset:47872
    s_waitcnt lgkmcnt(8)
    v_mfma_f32_32x32x16_bf16 v[16:31], v[80:83], v[136:139], v[16:31]
    v_mfma_f32_32x32x16_bf16 v[32:47], v[84:87], v[136:139], v[32:47]
    v_mfma_f32_32x32x16_bf16 v[48:63], v[88:91], v[136:139], v[48:63]
    v_mfma_f32_32x32x16_bf16 v[64:79], v[92:95], v[136:139], v[64:79]
    buffer_load_dwordx4 v[112:115], v2, s[12:15], s34 offen offset:0 sc1
    buffer_load_dwordx4 v[116:119], v2, s[12:15], s34 offen offset:1024 sc1
    s_waitcnt lgkmcnt(0)
    v_mfma_f32_32x32x16_bf16 v[16:31], v[96:99], v[140:143], v[16:31]
    v_mfma_f32_32x32x16_bf16 v[32:47], v[100:103], v[140:143], v[32:47]
    v_mfma_f32_32x32x16_bf16 v[48:63], v[104:107], v[140:143], v[48:63]
    v_mfma_f32_32x32x16_bf16 v[64:79], v[108:111], v[140:143], v[64:79]
    buffer_load_dwordx4 v[120:123], v2, s[12:15], s34 offen offset:2048 sc1
    buffer_load_dwordx4 v[124:127], v2, s[12:15], s34 offen offset:3072 sc1
    s_add_u32 s34, s34, 4096
    s_waitcnt vmcnt(16)
    s_barrier
    ds_read_b64_tr_b16 v[80:81], v5 offset:0
    ds_read_b64_tr_b16 v[82:83], v5 offset:2048
    ds_read_b64_tr_b16 v[84:85], v5 offset:256
    ds_read_b64_tr_b16 v[86:87], v5 offset:2304
    ds_read_b64_tr_b16 v[88:89], v5 offset:512
    ds_read_b64_tr_b16 v[90:91], v5 offset:2560
    ds_read_b64_tr_b16 v[92:93], v5 offset:768
    ds_read_b64_tr_b16 v[94:95], v5 offset:2816
    ds_read_b64_tr_b16 v[96:97], v5 offset:4096
    ds_read_b64_tr_b16 v[98:99], v5 offset:6144
    ds_read_b64_tr_b16 v[100:101], v5 offset:4352
    ds_read_b64_tr_b16 v[102:103], v5 offset:6400
    ds_read_b64_tr_b16 v[104:105], v5 offset:4608
    ds_read_b64_tr_b16 v[106:107], v5 offset:6656
    ds_read_b64_tr_b16 v[108:109], v5 offset:4864
    ds_read_b64_tr_b16 v[110:111], v5 offset:6912
    s_waitcnt lgkmcnt(8)
    v_mfma_f32_32x32x16_bf16 v[16:31], v[80:83], v[144:147], v[16:31]
    v_mfma_f32_32x32x16_bf16 v[32:47], v[84:87], v[144:147], v[32:47]
    v_mfma_f32_32x32x16_bf16 v[48:63], v[88:91], v[144:147], v[48:63]
    v_mfma_f32_32x32x16_bf16 v[64:79], v[92:95], v[144:147], v[64:79]
    s_add_u32 s37, s33, 0
    s_add_u32 m0, s39, 32768
    s_nop 0
    buffer_load_dwordx4 v3, s[8:11], s37 offen lds
    s_add_u32 s37, s33, 8192
    s_add_u32 m0, s39, 33792
    s_nop 0
    buffer_load_dwordx4 v3, s[8:11], s37 offen lds
    ds_read_b64_tr_b16 v[80:81], v5 offset:8192
    ds_read_b64_tr_b16 v[82:83], v5 offset:10240
    ds_read_b64_tr_b16 v[84:85], v5 offset:8448
    ds_read_b64_tr_b16 v[86:87], v5 offset:10496
    ds_read_b64_tr_b16 v[88:89], v5 offset:8704
    ds_read_b64_tr_b16 v[90:91], v5 offset:10752
    ds_read_b64_tr_b16 v[92:93], v5 offset:8960
    ds_read_b64_tr_b16 v[94:95], v5 offset:11008
    s_waitcnt lgkmcnt(8)
    v_mfma_f32_32x32x16_bf16 v[16:31], v[96:99], v[148:151], v[16:31]
    v_mfma_f32_32x32x16_bf16 v[32:47], v[100:103], v[148:151], v[32:47]
    v_mfma_f32_32x32x16_bf16 v[48:63], v[104:107], v[148:151], v[48:63]
    v_mfma_f32_32x32x16_bf16 v[64:79], v[108:111], v[148:151], v[64:79]
    s_add_u32 s37, s33, 16384
    s_add_u32 m0, s39, 34816
    s_nop 0
    buffer_load_dwordx4 v3, s[8:11], s37 offen lds
    s_add_u32 s37, s33, 24576
    s_add_u32 m0, s39, 35840
    s_nop 0
    buffer_load_dwordx4 v3, s[8:11], s37 offen lds
    s_add_u32 s33, s33, 131072
    ds_read_b64_tr_b16 v[96:97], v5 offset:12288
    ds_read_b64_tr_b16 v[98:99], v5 offset:14336
    ds_read_b64_tr_b16 v[100:101], v5 offset:12544
    ds_read_b64_tr_b16 v[102:103], v5 offset:14592
    ds_read_b64_tr_b16 v[104:105], v5 offset:12800
    ds_read_b64_tr_b16 v[106:107], v5 offset:14848
    ds_read_b64_tr_b16 v[108:109], v5 offset:13056
    ds_read_b64_tr_b16 v[110:111], v5 offset:15104
    s_waitcnt lgkmcnt(8)
    v_mfma_f32_32x32x16_bf16 v[16:31], v[80:83], v[152:155], v[16:31]
    v_mfma_f32_32x32x16_bf16 v[32:47], v[84:87], v[152:155], v[32:47]
    v_mfma_f32_32x32x16_bf16 v[48:63], v[88:91], v[152:155], v[48:63]
    v_mfma_f32_32x32x16_bf16 v[64:79], v[92:95], v[152:155], v[64:79]
    buffer_load_dwordx4 v[128:131], v2, s[12:15], s34 offen offset:0 sc1
    buffer_load_dwordx4 v[132:135], v2, s[12:15], s34 offen offset:1024 sc1
    s_waitcnt lgkmcnt(0)
    v_mfma_f32_32x32x16_bf16 v[16:31], v[96:99], v[156:159], v[16:31]
    v_mfma_f32_32x32x16_bf16 v[32:47], v[100:103], v[156:159], v[32:47]
    v_mfma_f32_32x32x16_bf16 v[48:63], v[104:107], v[156:159], v[48:63]
    v_mfma_f32_32x32x16_bf16 v[64:79], v[108:111], v[156:159], v[64:79]
    buffer_load_dwordx4 v[136:139], v2, s[12:15], s34 offen offset:2048 sc1
    buffer_load_dwordx4 v[140:143], v2, s[12:15], s34 offen offset:3072 sc1
    s_add_u32 s34, s34, 4096
    s_waitcnt vmcnt(16)
    s_barrier
    ds_read_b64_tr_b16 v[80:81], v5 offset:32768
    ds_read_b64_tr_b16 v[82:83], v5 offset:34816
    ds_read_b64_tr_b16 v[84:85], v5 offset:33024
    ds_read_b64_tr_b16 v[86:87], v5 offset:35072
    ds_read_b64_tr_b16 v[88:89], v5 offset:33280
    ds_read_b64_tr_b16 v[90:91], v5 offset:35328
    ds_read_b64_tr_b16 v[92:93], v5 offset:33536
    ds_read_b64_tr_b16 v[94:95], v5 offset:35584
    ds_read_b64_tr_b16 v[96:97], v5 offset:36864
    ds_read_b64_tr_b16 v[98:99], v5 offset:38912
    ds_read_b64_tr_b16 v[100:101], v5 offset:37120
    ds_read_b64_tr_b16 v[102:103], v5 offset:39168
    ds_read_b64_tr_b16 v[104:105], v5 offset:37376
    ds_read_b64_tr_b16 v[106:107], v5 offset:39424
    ds_read_b64_tr_b16 v[108:109], v5 offset:37632
    ds_read_b64_tr_b16 v[110:111], v5 offset:39680
    s_waitcnt lgkmcnt(8)
    v_mfma_f32_32x32x16_bf16 v[16:31], v[80:83], v[160:163], v[16:31]
    v_mfma_f32_32x32x16_bf16 v[32:47], v[84:87], v[160:163], v[32:47]
    v_mfma_f32_32x32x16_bf16 v[48:63], v[88:91], v[160:163], v[48:63]
    v_mfma_f32_32x32x16_bf16 v[64:79], v[92:95], v[160:163], v[64:79]
    v_lshlrev_b32 v11, 2, v1
    s_lshl_b32 s36, s29, 8
    s_add_u32 s36, s36, 69632
    buffer_load_dword v176, v11, s[44:47], s36 offen sc1
    s_add_u32 s36, s36, 8192
    buffer_load_dword v177, v11, s[44:47], s36 offen sc1
    s_add_u32 s36, s36, 8192
    buffer_load_dword v178, v11, s[44:47], s36 offen sc1
    s_add_u32 s36, s36, 8192
    buffer_load_dword v179, v11, s[44:47], s36 offen sc1
    v_lshlrev_b32 v11, 1, v1
    s_lshl_b32 s36, s29, 7
    buffer_load_ushort v180, v11, s[16:19], s36 offen
    ds_read_b64_tr_b16 v[80:81], v5 offset:40960
    ds_read_b64_tr_b16 v[82:83], v5 offset:43008
    ds_read_b64_tr_b16 v[84:85], v5 offset:41216
    ds_read_b64_tr_b16 v[86:87], v5 offset:43264
    ds_read_b64_tr_b16 v[88:89], v5 offset:41472
    ds_read_b64_tr_b16 v[90:91], v5 offset:43520
    ds_read_b64_tr_b16 v[92:93], v5 offset:41728
    ds_read_b64_tr_b16 v[94:95], v5 offset:43776
    s_waitcnt lgkmcnt(8)
    v_mfma_f32_32x32x16_bf16 v[16:31], v[96:99], v[164:167], v[16:31]
    v_mfma_f32_32x32x16_bf16 v[32:47], v[100:103], v[164:167], v[32:47]
    v_mfma_f32_32x32x16_bf16 v[48:63], v[104:107], v[164:167], v[48:63]
    v_mfma_f32_32x32x16_bf16 v[64:79], v[108:111], v[164:167], v[64:79]
    ds_read_b64_tr_b16 v[96:97], v5 offset:45056
    ds_read_b64_tr_b16 v[98:99], v5 offset:47104
    ds_read_b64_tr_b16 v[100:101], v5 offset:45312
    ds_read_b64_tr_b16 v[102:103], v5 offset:47360
    ds_read_b64_tr_b16 v[104:105], v5 offset:45568
    ds_read_b64_tr_b16 v[106:107], v5 offset:47616
    ds_read_b64_tr_b16 v[108:109], v5 offset:45824
    ds_read_b64_tr_b16 v[110:111], v5 offset:47872
    s_waitcnt lgkmcnt(8)
    v_mfma_f32_32x32x16_bf16 v[16:31], v[80:83], v[168:171], v[16:31]
    v_mfma_f32_32x32x16_bf16 v[32:47], v[84:87], v[168:171], v[32:47]
    v_mfma_f32_32x32x16_bf16 v[48:63], v[88:91], v[168:171], v[48:63]
    v_mfma_f32_32x32x16_bf16 v[64:79], v[92:95], v[168:171], v[64:79]
    s_waitcnt lgkmcnt(0)
    v_mfma_f32_32x32x16_bf16 v[16:31], v[96:99], v[172:175], v[16:31]
    v_mfma_f32_32x32x16_bf16 v[32:47], v[100:103], v[172:175], v[32:47]
    v_mfma_f32_32x32x16_bf16 v[48:63], v[104:107], v[172:175], v[48:63]
    v_mfma_f32_32x32x16_bf16 v[64:79], v[108:111], v[172:175], v[64:79]
    s_waitcnt vmcnt(13)
    s_barrier
    ds_read_b64_tr_b16 v[80:81], v4 offset:0
    ds_read_b64_tr_b16 v[82:83], v4 offset:2048
    ds_read_b64_tr_b16 v[84:85], v4 offset:256
    ds_read_b64_tr_b16 v[86:87], v4 offset:2304
    ds_read_b64_tr_b16 v[88:89], v4 offset:512
    ds_read_b64_tr_b16 v[90:91], v4 offset:2560
    ds_read_b64_tr_b16 v[92:93], v4 offset:768
    ds_read_b64_tr_b16 v[94:95], v4 offset:2816
    ds_read_b64_tr_b16 v[96:97], v4 offset:4096
    ds_read_b64_tr_b16 v[98:99], v4 offset:6144
    ds_read_b64_tr_b16 v[100:101], v4 offset:4352
    ds_read_b64_tr_b16 v[102:103], v4 offset:6400
    ds_read_b64_tr_b16 v[104:105], v4 offset:4608
    ds_read_b64_tr_b16 v[106:107], v4 offset:6656
    ds_read_b64_tr_b16 v[108:109], v4 offset:4864
    ds_read_b64_tr_b16 v[110:111], v4 offset:6912
    s_waitcnt lgkmcnt(8)
    v_mfma_f32_32x32x16_bf16 v[16:31], v[80:83], v[112:115], v[16:31]
    v_mfma_f32_32x32x16_bf16 v[32:47], v[84:87], v[112:115], v[32:47]
    v_mfma_f32_32x32x16_bf16 v[48:63], v[88:91], v[112:115], v[48:63]
    v_mfma_f32_32x32x16_bf16 v[64:79], v[92:95], v[112:115], v[64:79]
    ds_read_b64_tr_b16 v[80:81], v4 offset:8192
    ds_read_b64_tr_b16 v[82:83], v4 offset:10240
    ds_read_b64_tr_b16 v[84:85], v4 offset:8448
    ds_read_b64_tr_b16 v[86:87], v4 offset:10496
    ds_read_b64_tr_b16 v[88:89], v4 offset:8704
    ds_read_b64_tr_b16 v[90:91], v4 offset:10752
    ds_read_b64_tr_b16 v[92:93], v4 offset:8960
    ds_read_b64_tr_b16 v[94:95], v4 offset:11008
    s_waitcnt lgkmcnt(8)
    v_mfma_f32_32x32x16_bf16 v[16:31], v[96:99], v[116:119], v[16:31]
    v_mfma_f32_32x32x16_bf16 v[32:47], v[100:103], v[116:119], v[32:47]
    v_mfma_f32_32x32x16_bf16 v[48:63], v[104:107], v[116:119], v[48:63]
    v_mfma_f32_32x32x16_bf16 v[64:79], v[108:111], v[116:119], v[64:79]
    ds_read_b64_tr_b16 v[96:97], v4 offset:12288
    ds_read_b64_tr_b16 v[98:99], v4 offset:14336
    ds_read_b64_tr_b16 v[100:101], v4 offset:12544
    ds_read_b64_tr_b16 v[102:103], v4 offset:14592
    ds_read_b64_tr_b16 v[104:105], v4 offset:12800
    ds_read_b64_tr_b16 v[106:107], v4 offset:14848
    ds_read_b64_tr_b16 v[108:109], v4 offset:13056
    ds_read_b64_tr_b16 v[110:111], v4 offset:15104
    s_waitcnt lgkmcnt(8)
    v_mfma_f32_32x32x16_bf16 v[16:31], v[80:83], v[120:123], v[16:31]
    v_mfma_f32_32x32x16_bf16 v[32:47], v[84:87], v[120:123], v[32:47]
    v_mfma_f32_32x32x16_bf16 v[48:63], v[88:91], v[120:123], v[48:63]
    v_mfma_f32_32x32x16_bf16 v[64:79], v[92:95], v[120:123], v[64:79]
    s_waitcnt lgkmcnt(0)
    v_mfma_f32_32x32x16_bf16 v[16:31], v[96:99], v[124:127], v[16:31]
    v_mfma_f32_32x32x16_bf16 v[32:47], v[100:103], v[124:127], v[32:47]
    v_mfma_f32_32x32x16_bf16 v[48:63], v[104:107], v[124:127], v[48:63]
    v_mfma_f32_32x32x16_bf16 v[64:79], v[108:111], v[124:127], v[64:79]
    s_waitcnt vmcnt(5)
    s_barrier
    ds_read_b64_tr_b16 v[80:81], v4 offset:32768
    ds_read_b64_tr_b16 v[82:83], v4 offset:34816
    ds_read_b64_tr_b16 v[84:85], v4 offset:33024
    ds_read_b64_tr_b16 v[86:87], v4 offset:35072
    ds_read_b64_tr_b16 v[88:89], v4 offset:33280
    ds_read_b64_tr_b16 v[90:91], v4 offset:35328
    ds_read_b64_tr_b16 v[92:93], v4 offset:33536
    ds_read_b64_tr_b16 v[94:95], v4 offset:35584
    ds_read_b64_tr_b16 v[96:97], v4 offset:36864
    ds_read_b64_tr_b16 v[98:99], v4 offset:38912
    ds_read_b64_tr_b16 v[100:101], v4 offset:37120
    ds_read_b64_tr_b16 v[102:103], v4 offset:39168
    ds_read_b64_tr_b16 v[104:105], v4 offset:37376
    ds_read_b64_tr_b16 v[106:107], v4 offset:39424
    ds_read_b64_tr_b16 v[108:109], v4 offset:37632
    ds_read_b64_tr_b16 v[110:111], v4 offset:39680
    s_waitcnt lgkmcnt(8)
    v_mfma_f32_32x32x16_bf16 v[16:31], v[80:83], v[128:131], v[16:31]
    v_mfma_f32_32x32x16_bf16 v[32:47], v[84:87], v[128:131], v[32:47]
    v_mfma_f32_32x32x16_bf16 v[48:63], v[88:91], v[128:131], v[48:63]
    v_mfma_f32_32x32x16_bf16 v[64:79], v[92:95], v[128:131], v[64:79]
    ds_read_b64_tr_b16 v[80:81], v4 offset:40960
    ds_read_b64_tr_b16 v[82:83], v4 offset:43008
    ds_read_b64_tr_b16 v[84:85], v4 offset:41216
    ds_read_b64_tr_b16 v[86:87], v4 offset:43264
    ds_read_b64_tr_b16 v[88:89], v4 offset:41472
    ds_read_b64_tr_b16 v[90:91], v4 offset:43520
    ds_read_b64_tr_b16 v[92:93], v4 offset:41728
    ds_read_b64_tr_b16 v[94:95], v4 offset:43776
    s_waitcnt lgkmcnt(8)
    v_mfma_f32_32x32x16_bf16 v[16:31], v[96:99], v[132:135], v[16:31]
    v_mfma_f32_32x32x16_bf16 v[32:47], v[100:103], v[132:135], v[32:47]
    v_mfma_f32_32x32x16_bf16 v[48:63], v[104:107], v[132:135], v[48:63]
    v_mfma_f32_32x32x16_bf16 v[64:79], v[108:111], v[132:135], v[64:79]
    ds_read_b64_tr_b16 v[96:97], v4 offset:45056
    ds_read_b64_tr_b16 v[98:99], v4 offset:47104
    ds_read_b64_tr_b16 v[100:101], v4 offset:45312
    ds_read_b64_tr_b16 v[102:103], v4 offset:47360
    ds_read_b64_tr_b16 v[104:105], v4 offset:45568
    ds_read_b64_tr_b16 v[106:107], v4 offset:47616
    ds_read_b64_tr_b16 v[108:109], v4 offset:45824
    ds_read_b64_tr_b16 v[110:111], v4 offset:47872
    s_waitcnt lgkmcnt(8)
    v_mfma_f32_32x32x16_bf16 v[16:31], v[80:83], v[136:139], v[16:31]
    v_mfma_f32_32x32x16_bf16 v[32:47], v[84:87], v[136:139], v[32:47]
    v_mfma_f32_32x32x16_bf16 v[48:63], v[88:91], v[136:139], v[48:63]
    v_mfma_f32_32x32x16_bf16 v[64:79], v[92:95], v[136:139], v[64:79]
    s_waitcnt lgkmcnt(0)
    v_mfma_f32_32x32x16_bf16 v[16:31], v[96:99], v[140:143], v[16:31]
    v_mfma_f32_32x32x16_bf16 v[32:47], v[100:103], v[140:143], v[32:47]
    v_mfma_f32_32x32x16_bf16 v[48:63], v[104:107], v[140:143], v[48:63]
    v_mfma_f32_32x32x16_bf16 v[64:79], v[108:111], v[140:143], v[64:79]
    s_waitcnt vmcnt(0)
    s_barrier
    s_nop 15
    v_add_f32 v176, v176, v177
    v_add_f32 v178, v178, v179
    v_add_f32 v176, v176, v178
    v_cvt_pk_bf16_f32 v176, v176, v176
    v_lshlrev_b32 v176, 16, v176
    v_lshlrev_b32 v180, 16, v180
    v_lshlrev_b32 v11, 2, v1
    v_add_u32 v11, 65536, v11
    ds_write_b32 v11, v176
    ds_write_b32 v11, v180 offset:256
    s_lshl_b32 s36, s31, 14
    v_add_u32 v5, s36, v2
    s_cmp_eq_u32 s32, 0
    s_cbranch_scc0 P5_X1
    ds_write_b128 v5, v[32:35] offset:4096
    ds_write_b128 v5, v[64:67] offset:12288
    ds_write_b128 v5, v[36:39] offset:5120
    ds_write_b128 v5, v[68:71] offset:13312
    ds_write_b128 v5, v[40:43] offset:6144
    ds_write_b128 v5, v[72:75] offset:14336
    ds_write_b128 v5, v[44:47] offset:7168
    ds_write_b128 v5, v[76:79] offset:15360
    s_branch P5_X2
P5_X1:
    ds_write_b128 v5, v[16:19] offset:0
    ds_write_b128 v5, v[48:51] offset:8192
    ds_write_b128 v5, v[20:23] offset:1024
    ds_write_b128 v5, v[52:55] offset:9216
    ds_write_b128 v5, v[24:27] offset:2048
    ds_write_b128 v5, v[56:59] offset:10240
    ds_write_b128 v5, v[28:31] offset:3072
    ds_write_b128 v5, v[60:63] offset:11264
    s_nop 1
    v_mov_b32 v16, v32
    v_mov_b32 v48, v64
    v_mov_b32 v17, v33
    v_mov_b32 v49, v65
    v_mov_b32 v18, v34
    v_mov_b32 v50, v66
    v_mov_b32 v19, v35
    v_mov_b32 v51, v67
    v_mov_b32 v20, v36
    v_mov_b32 v52, v68
    v_mov_b32 v21, v37
    v_mov_b32 v53, v69
    v_mov_b32 v22, v38
    v_mov_b32 v54, v70
    v_mov_b32 v23, v39
    v_mov_b32 v55, v71
    v_mov_b32 v24, v40
    v_mov_b32 v56, v72
    v_mov_b32 v25, v41
    v_mov_b32 v57, v73
    v_mov_b32 v26, v42
    v_mov_b32 v58, v74
    v_mov_b32 v27, v43
    v_mov_b32 v59, v75
    v_mov_b32 v28, v44
    v_mov_b32 v60, v76
    v_mov_b32 v29, v45
    v_mov_b32 v61, v77
    v_mov_b32 v30, v46
    v_mov_b32 v62, v78
    v_mov_b32 v31, v47
    v_mov_b32 v63, v79
P5_X2:
    s_waitcnt lgkmcnt(0)
    s_barrier
    s_lshl_b32 s36, s32, 12
    v_add_u32 v5, s36, v5
    ds_read_b128 v[32:35], v5 offset:0
    ds_read_b128 v[64:67], v5 offset:8192
    ds_read_b128 v[36:39], v5 offset:1024
    ds_read_b128 v[68:71], v5 offset:9216
    ds_read_b128 v[40:43], v5 offset:2048
    ds_read_b128 v[72:75], v5 offset:10240
    ds_read_b128 v[44:47], v5 offset:3072
    ds_read_b128 v[76:79], v5 offset:11264
    s_waitcnt lgkmcnt(0)
    s_and_b32 s38, s29, 1
    s_cmp_eq_u32 s38, 0
    s_cbranch_scc0 P5_K1
    v_add_f32 v64, v48, v64
    v_add_f32 v65, v49, v65
    v_add_f32 v66, v50, v66
    v_add_f32 v67, v51, v67
    v_add_f32 v68, v52, v68
    v_add_f32 v69, v53, v69
    v_add_f32 v70, v54, v70
    v_add_f32 v71, v55, v71
    v_add_f32 v72, v56, v72
    v_add_f32 v73, v57, v73
    v_add_f32 v74, v58, v74
    v_add_f32 v75, v59, v75
    v_add_f32 v76, v60, v76
    v_add_f32 v77, v61, v77
    v_add_f32 v78, v62, v78
    v_add_f32 v79, v63, v79
    v_add_f32 v16, v16, v32
    v_add_f32 v17, v17, v33
    v_add_f32 v18, v18, v34
    v_add_f32 v19, v19, v35
    v_add_f32 v20, v20, v36
    v_add_f32 v21, v21, v37
    v_add_f32 v22, v22, v38
    v_add_f32 v23, v23, v39
    v_add_f32 v24, v24, v40
    v_add_f32 v25, v25, v41
    v_add_f32 v26, v26, v42
    v_add_f32 v27, v27, v43
    v_add_f32 v28, v28, v44
    v_add_f32 v29, v29, v45
    v_add_f32 v30, v30, v46
    v_add_f32 v31, v31, v47
    s_branch P5_K2
P5_K1:
    v_add_f32 v32, v16, v32
    v_add_f32 v33, v17, v33
    v_add_f32 v34, v18, v34
    v_add_f32 v35, v19, v35
    v_add_f32 v36, v20, v36
    v_add_f32 v37, v21, v37
    v_add_f32 v38, v22, v38
    v_add_f32 v39, v23, v39
    v_add_f32 v40, v24, v40
    v_add_f32 v41, v25, v41
    v_add_f32 v42, v26, v42
    v_add_f32 v43, v27, v43
    v_add_f32 v44, v28, v44
    v_add_f32 v45, v29, v45
    v_add_f32 v46, v30, v46
    v_add_f32 v47, v31, v47
    v_add_f32 v16, v48, v64
    v_add_f32 v17, v49, v65
    v_add_f32 v18, v50, v66
    v_add_f32 v19, v51, v67
    v_add_f32 v20, v52, v68
    v_add_f32 v21, v53, v69
    v_add_f32 v22, v54, v70
    v_add_f32 v23, v55, v71
    v_add_f32 v24, v56, v72
    v_add_f32 v25, v57, v73
    v_add_f32 v26, v58, v74
    v_add_f32 v27, v59, v75
    v_add_f32 v28, v60, v76
    v_add_f32 v29, v61, v77
    v_add_f32 v30, v62, v78
    v_add_f32 v31, v63, v79
    v_mov_b32 v64, v32
    v_mov_b32 v65, v33
    v_mov_b32 v66, v34
    v_mov_b32 v67, v35
    v_mov_b32 v68, v36
    v_mov_b32 v69, v37
    v_mov_b32 v70, v38
    v_mov_b32 v71, v39
    v_mov_b32 v72, v40
    v_mov_b32 v73, v41
    v_mov_b32 v74, v42
    v_mov_b32 v75, v43
    v_mov_b32 v76, v44
    v_mov_b32 v77, v45
    v_mov_b32 v78, v46
    v_mov_b32 v79, v47
P5_K2:
    s_lshl_b32 s101, s28, 4
    s_add_u32 s101, s101, s29
    s_lshl_b32 s37, s31, 1
    s_add_u32 s37, s37, s32
    s_lshl_b32 s37, s37, 12
    s_lshl_b32 s36, s101, 15
    s_add_u32 s36, s36, s37
    buffer_store_dwordx4 v[64:67], v2, s[48:51], s36 offen offset:0 sc1
    buffer_store_dwordx4 v[68:71], v2, s[48:51], s36 offen offset:1024 sc1
    buffer_store_dwordx4 v[72:75], v2, s[48:51], s36 offen offset:2048 sc1
    buffer_store_dwordx4 v[76:79], v2, s[48:51], s36 offen offset:3072 sc1
    v_lshrrev_b32 v9, 5, v1
    v_lshlrev_b32 v9, 4, v9
    s_lshl_b32 s38, s32, 7
    s_add_u32 s38, s38, 65536
    v_add_u32 v9, s38, v9
    ds_read_b128 v[152:155], v9 offset:0
    ds_read_b128 v[168:171], v9 offset:256
    ds_read_b128 v[156:159], v9 offset:32
    ds_read_b128 v[172:175], v9 offset:288
    ds_read_b128 v[160:163], v9 offset:64
    ds_read_b128 v[176:179], v9 offset:320
    ds_read_b128 v[164:167], v9 offset:96
    ds_read_b128 v[180:183], v9 offset:352
    s_waitcnt vmcnt(0) lgkmcnt(0)
    s_barrier
    s_cmp_eq_u32 s30, 0
    s_cbranch_scc0 SIG27
    s_lshl_b32 s36, s101, 7
    s_add_u32 s36, s36, 204800
    v_mov_b32 v250, s100
    v_mov_b32 v251, 0
    v_cmp_eq_u32 vcc, 0, v1
    s_and_saveexec_b64 s[54:55], vcc
    buffer_store_dword v250, v251, s[96:99], s36 offen sc1
    s_mov_b64 exec, s[54:55]
SIG27:
    s_xor_b32 s38, s101, 1
    s_cmp_eq_u32 s30, 7
    s_cbranch_scc0 PB28
    s_lshl_b32 s56, s38, 7
    s_add_u32 s56, s56, 204800
    s_mov_b32 s57, 0
POLL29:
    v_min_u32 v248, 0, v1
    v_lshlrev_b32 v248, 7, v248
    buffer_load_dword v248, v248, s[96:99], s56 offen sc1
    s_waitcnt vmcnt(0)
    s_mov_b64 s[58:59], -1
    v_cmp_eq_u32 vcc, s100, v248
    s_and_b64 s[58:59], s[58:59], vcc
    s_cmp_eq_u64 s[58:59], -1
    s_cbranch_scc1 POLLD29
    s_add_u32 s57, s57, 1
    s_cmp_gt_u32 s57, 400000
    s_cbranch_scc1 POLLD29
    s_sleep 1
    s_branch POLL29
POLLD29:
PB28:
    s_lshl_b32 s36, s38, 15
    s_add_u32 s36, s36, s37
    s_barrier
    buffer_load_dwordx4 v[32:35], v2, s[48:51], s36 offen offset:0 sc1
    buffer_load_dwordx4 v[36:39], v2, s[48:51], s36 offen offset:1024 sc1
    buffer_load_dwordx4 v[40:43], v2, s[48:51], s36 offen offset:2048 sc1
    buffer_load_dwordx4 v[44:47], v2, s[48:51], s36 offen offset:3072 sc1
    v_add_f32 v16, v16, v168
    v_add_f32 v17, v17, v169
    v_add_f32 v18, v18, v170
    v_add_f32 v19, v19, v171
    v_add_f32 v20, v20, v172
    v_add_f32 v21, v21, v173
    v_add_f32 v22, v22, v174
    v_add_f32 v23, v23, v175
    v_add_f32 v24, v24, v176
    v_add_f32 v25, v25, v177
    v_add_f32 v26, v26, v178
    v_add_f32 v27, v27, v179
    v_add_f32 v28, v28, v180
    v_add_f32 v29, v29, v181
    v_add_f32 v30, v30, v182
    v_add_f32 v31, v31, v183
    s_waitcnt vmcnt(0)
    v_add_f32 v16, v16, v32
    v_add_f32 v17, v17, v33
    v_add_f32 v18, v18, v34
    v_add_f32 v19, v19, v35
    v_add_f32 v20, v20, v36
    v_add_f32 v21, v21, v37
    v_add_f32 v22, v22, v38
    v_add_f32 v23, v23, v39
    v_add_f32 v24, v24, v40
    v_add_f32 v25, v25, v41
    v_add_f32 v26, v26, v42
    v_add_f32 v27, v27, v43
    v_add_f32 v28, v28, v44
    v_add_f32 v29, v29, v45
    v_add_f32 v30, v30, v46
    v_add_f32 v31, v31, v47
    v_lshlrev_b32 v8, 16, v240
    v_and_b32 v9, 0xffff0000, v240
    v_fma_f32 v16, v16, v152, v8
    v_fma_f32 v17, v17, v153, v9
    v_lshlrev_b32 v8, 16, v241
    v_and_b32 v9, 0xffff0000, v241
    v_fma_f32 v18, v18, v154, v8
    v_fma_f32 v19, v19, v155, v9
    v_lshlrev_b32 v8, 16, v242
    v_and_b32 v9, 0xffff0000, v242
    v_fma_f32 v20, v20, v156, v8
    v_fma_f32 v21, v21, v157, v9
    v_lshlrev_b32 v8, 16, v243
    v_and_b32 v9, 0xffff0000, v243
    v_fma_f32 v22, v22, v158, v8
    v_fma_f32 v23, v23, v159, v9
    v_lshlrev_b32 v8, 16, v244
    v_and_b32 v9, 0xffff0000, v244
    v_fma_f32 v24, v24, v160, v8
    v_fma_f32 v25, v25, v161, v9
    v_lshlrev_b32 v8, 16, v245
    v_and_b32 v9, 0xffff0000, v245
    v_fma_f32 v26, v26, v162, v8
    v_fma_f32 v27, v27, v163, v9
    v_lshlrev_b32 v8, 16, v246
    v_and_b32 v9, 0xffff0000, v246
    v_fma_f32 v28, v28, v164, v8
    v_fma_f32 v29, v29, v165, v9
    v_lshlrev_b32 v8, 16, v247
    v_and_b32 v9, 0xffff0000, v247
    v_fma_f32 v30, v30, v166, v8
    v_fma_f32 v31, v31, v167, v9
    v_cvt_pk_bf16_f32 v32, v16, v17
    v_cvt_pk_bf16_f32 v33, v18, v19
    v_cvt_pk_bf16_f32 v34, v20, v21
    v_cvt_pk_bf16_f32 v35, v22, v23
    v_cvt_pk_bf16_f32 v36, v24, v25
    v_cvt_pk_bf16_f32 v37, v26, v27
    v_cvt_pk_bf16_f32 v38, v28, v29
    v_cvt_pk_bf16_f32 v39, v30, v31
    s_nop 1
    v_permlane32_swap_b32 v32, v34
    v_permlane32_swap_b32 v33, v35
    v_permlane32_swap_b32 v36, v38
    v_permlane32_swap_b32 v37, v39
    v_and_b32 v8, 31, v1
    v_lshrrev_b32 v9, 5, v1
    v_lshlrev_b32 v10, 11, v8
    v_lshl_add_u32 v10, v9, 4, v10
    s_lshl_b32 s36, s28, 2
    s_add_u32 s36, s36, s31
    s_lshl_b32 s36, s36, 16
    s_lshl_b32 s37, s29, 7
    s_add_u32 s36, s36, s37
    s_lshl_b32 s37, s32, 6
    s_add_u32 s36, s36, s37
    buffer_store_dwordx4 v[32:35], v10, s[24:27], s36 offen
    buffer_store_dwordx4 v[36:39], v10, s[24:27], s36 offen offset:32
MEGA_END:
    s_endpgm
MEGA_CODE_END:
.section .rodata,"a"
.p2align 6
.amdhsa_kernel adaLN_cond__grouped_kv_mqa__mixer_channel_mlp__prompt_kernel
  .amdhsa_next_free_vgpr 256
  .amdhsa_next_free_sgpr 102
  .amdhsa_accum_offset 256
  .amdhsa_group_segment_fixed_size 0
  .amdhsa_kernarg_size 120
  .amdhsa_user_sgpr_count 2
  .amdhsa_user_sgpr_kernarg_segment_ptr 1
  .amdhsa_system_sgpr_workgroup_id_x 1
.end_amdhsa_kernel
```
